```python
import torch

def _softmax(x, axis=-1):
    return torch.softmax(x, dim=axis)
def _gelu(x):
    return torch.nn.functional.gelu(x, approximate="tanh")
def _silu(x):
    return torch.nn.functional.silu(x)
def _sigmoid(x):
    return torch.sigmoid(x)
def _layernorm(x, axis=-1, eps=1e-5):
    m = x.mean(dim=axis, keepdim=True)
    v = x.var(dim=axis, keepdim=True, unbiased=False)
    return (x - m) / torch.sqrt(v + eps)
def _scatter_add(tgt, idx, src, axis=0):
    return tgt.clone().index_add_(axis, idx, src)
def _segment_sum(src, seg, n):
    out = torch.zeros((n,) + src.shape[1:], dtype=src.dtype)
    return out.index_add_(0, seg, src)
def _pad(x, pw):
    flat = tuple(v for pair in reversed(pw) for v in pair)
    return torch.nn.functional.pad(x, flat)

kernel_name = 'parallel_sum__sliding_local_dilated__glu_gated_glu__prompt'

def setup_inputs():

    _w = (lambda a: (lambda t: t.to(torch.bfloat16) if t.is_floating_point() else t)(torch.as_tensor(a)))
    def _A_setup():
        B, S, D = 1, 2048, 640
        return {
            "x": _w((lambda *s: torch.randn(*s, dtype=torch.bfloat16) * 0.05)(B, S, D)),
            "wqkv": _w((lambda *s: torch.randn(*s, dtype=torch.bfloat16) * 0.05)(D, 3 * D)),
            "wo": _w((lambda *s: torch.randn(*s, dtype=torch.bfloat16) * 0.05)(D, D)),
        }
    _A_in = _A_setup()

    def _B_setup():
        B, S, D, F = 1, 2048, 640, 1536
        return {
            "x": _w((lambda *s: torch.randn(*s, dtype=torch.bfloat16) * 0.05)(B, S, D)),
            "w_gate": _w((lambda *s: torch.randn(*s, dtype=torch.bfloat16) * 0.05)(D, F)),
            "w_up": _w((lambda *s: torch.randn(*s, dtype=torch.bfloat16) * 0.05)(D, F)),
            "w_down": _w((lambda *s: torch.randn(*s, dtype=torch.bfloat16) * 0.05)(F, D)),
        }
    _B_in = _B_setup()

    return {
        "A_x": _A_in["x"],
        "A_wqkv": _A_in["wqkv"],
        "A_wo": _A_in["wo"],
        "B_x": _B_in["x"],
        "B_w_gate": _B_in["w_gate"],
        "B_w_up": _B_in["w_up"],
        "B_w_down": _B_in["w_down"],
    }

def reference(A_x, A_wqkv, A_wo, B_x, B_w_gate, B_w_up, B_w_down):
    def _A_ref(x, wqkv, wo):
        B, S, D = x.shape
        H = 32; Dh = D // H
        W, dil = 8, 2
        qkv = (lambda x, *d: x.permute(*d))((x @ wqkv).reshape(B, S, 3, H, Dh), 2, 0, 3, 1, 4)
        q, k, v = qkv[0], qkv[1], qkv[2]
        scale = Dh ** -0.5
        pos = torch.arange(S)
        off = torch.arange(W) * dil
        idx = pos[:, None] - off[None, :]
        mask = idx >= 0
        idx_c = torch.where(mask, idx, 0).reshape(-1)
        kg = k[:, :, idx_c, :].reshape(B, H, S, W, Dh)
        vg = v[:, :, idx_c, :].reshape(B, H, S, W, Dh)
        logits = torch.einsum("bhsd,bhswd->bhsw", q, kg) * scale
        logits = torch.where(mask[None, None, :, :], logits, -1e9)
        attn = _softmax(logits, axis=-1)
        o = torch.einsum("bhsw,bhswd->bhsd", attn, vg)
        return (lambda x, *d: x.permute(*d))(o, 0, 2, 1, 3).reshape(B, S, D) @ wo

    def _B_ref(x, w_gate, w_up, w_down):
        g = torch.einsum("bsd,df->bsf", x, w_gate)
        u = torch.einsum("bsd,df->bsf", x, w_up)
        h = _sigmoid(g) * u
        return torch.einsum("bsf,fd->bsd", h, w_down)

    x = A_x
    xn = _layernorm(x, axis=-1)
    return x + _A_ref(xn, A_wqkv, A_wo) + _B_ref(xn, B_w_gate, B_w_up, B_w_down)
```

```asm
; @launch kernel=g1_kernel grid=(256,1,1) block=(512,1,1) lds=163840
; @launch kernel=g2_kernel grid=(256,1,1) block=(512,1,1) lds=163840
.amdgcn_target "amdgcn-amd-amdhsa--gfx950"
.text
.globl g1_kernel
.type g1_kernel,@function
.globl g2_kernel
.type g2_kernel,@function
.p2align 8
g1_kernel:
    s_cmp_ge_u32 s2, 256
    s_cbranch_scc1 L_g1_done
    s_getpc_b64 s[90:91]
    L_pc_here:
    s_sub_u32 s90, s90, L_pc_here - g1_kernel
    s_subb_u32 s91, s91, 0
    v_lshlrev_b32 v1, 7, v0
    v_min_u32 v1, L_code_end - g1_kernel - 4, v1
    global_load_dword v254, v1, s[90:91]
    s_load_dwordx4 s[4:7], s[0:1], 0
    s_load_dwordx2 s[52:53], s[0:1], 16
    s_load_dwordx4 s[8:11], s[0:1], 32
    s_load_dwordx2 s[54:55], s[0:1], 48
    s_load_dwordx2 s[56:57], s[0:1], 72
    v_lshrrev_b32 v1, 6, v0
    v_and_b32 v0, 63, v0
    s_nop 0
    v_readfirstlane_b32 s32, v1
    s_lshr_b32 s3, s2, 3
    s_and_b32 s33, s3, 7
    s_and_b32 s34, s2, 1
    s_lshl_b32 s34, s34, 3
    s_add_u32 s33, s33, s34
    s_bfe_u32 s34, s3, 65539
    s_and_b32 s35, s2, 6
    s_add_u32 s34, s34, s35
    s_lshr_b32 s3, s3, 4
    s_lshr_b32 s36, s32, 2
    s_and_b32 s37, s32, 3
    v_lshrrev_b32 v2, 4, v0
    v_bfe_u32 v3, v0, 2, 2
    v_and_b32 v4, 3, v0
    v_lshlrev_b32 v5, 4, v0
    v_mov_b32 v228, 0x3f803f80
    v_mov_b32 v229, 0x3f803f80
    v_mov_b32 v230, 0x3f803f80
    v_mov_b32 v231, 0x3f803f80
    s_mov_b32 s69, 0xffff0000
    v_and_b32 v6, 15, v0
    s_waitcnt lgkmcnt(0)
    s_mov_b32 s12, s56
    s_mov_b32 s13, s57
    s_mov_b32 s14, 16777216
    s_mov_b32 s15, 0x00020000
    s_mov_b32 s28, s4
    s_mov_b32 s29, s5
    s_mov_b32 s30, 2621440
    s_mov_b32 s31, 0x00020000
    v_lshrrev_b32 v20, 3, v0
    v_and_b32 v21, 7, v0
    v_xor_b32 v21, v21, v20
    v_mul_u32_u24 v7, 1280, v20
    v_lshl_add_u32 v7, v21, 4, v7
    v_and_b32 v20, 7, v6
    v_xor_b32 v21, v2, v20
    v_lshlrev_b32 v8, 7, v20
    v_lshl_add_u32 v8, v21, 4, v8
    v_lshrrev_b32 v20, 3, v6
    v_lshl_add_u32 v8, v20, 10, v8
    v_and_b32 v20, 1, v2
    v_lshl_add_u32 v20, v20, 2, v3
    v_lshrrev_b32 v21, 1, v2
    v_lshl_add_u32 v9, v21, 4, v20
    s_cmp_eq_u32 s3, 0
    s_cbranch_scc0 L_g1_glu
L_g1_attn:
    s_mov_b32 s16, s6
    s_mov_b32 s17, s7
    s_mov_b32 s18, 2457600
    s_mov_b32 s19, 0x00020000
    s_lshl_b32 s42, s32, 10
    s_add_u32 s40, s42, 55296
    s_add_u32 s41, s42, 63488
    s_mul_i32 s45, s34, 160
    s_lshl_b32 s44, s32, 6
    v_add_u32 v20, s44, v0
    v_mul_u32_u24 v21, 2185, v20
    v_lshrrev_b32 v21, 16, v21
    v_mul_u32_u24 v22, 30, v21
    v_sub_u32 v22, v20, v22
    v_mul_u32_u24 v23, 6554, v22
    v_lshrrev_b32 v23, 16, v23
    v_mul_u32_u24 v24, 10, v23
    v_sub_u32 v22, v22, v24
    v_and_b32 v21, 31, v21
    v_lshrrev_b32 v25, 1, v21
    v_and_b32 v25, 4, v25
    v_lshlrev_b32 v26, 1, v21
    v_and_b32 v26, 8, v26
    v_and_b32 v24, 0x13, v21
    v_or3_b32 v24, v24, v25, v26
    v_mul_u32_u24 v24, 3840, v24
    v_mul_u32_u24 v23, 1280, v23
    v_add_u32 v24, v24, v23
    v_lshl_add_u32 v24, v22, 4, v24
    v_add_u32 v12, s45, v24
    s_add_u32 s46, s32, 8
    s_min_u32 s46, s46, 14
    s_lshl_b32 s44, s46, 6
    v_add_u32 v20, s44, v0
    v_mul_u32_u24 v21, 2185, v20
    v_lshrrev_b32 v21, 16, v21
    v_mul_u32_u24 v22, 30, v21
    v_sub_u32 v22, v20, v22
    v_mul_u32_u24 v23, 6554, v22
    v_lshrrev_b32 v23, 16, v23
    v_mul_u32_u24 v24, 10, v23
    v_sub_u32 v22, v22, v24
    v_and_b32 v21, 31, v21
    v_lshrrev_b32 v25, 1, v21
    v_and_b32 v25, 4, v25
    v_lshlrev_b32 v26, 1, v21
    v_and_b32 v26, 8, v26
    v_and_b32 v24, 0x13, v21
    v_or3_b32 v24, v24, v25, v26
    v_mul_u32_u24 v24, 3840, v24
    v_mul_u32_u24 v23, 1280, v23
    v_add_u32 v24, v24, v23
    v_lshl_add_u32 v24, v22, 4, v24
    v_add_u32 v13, s45, v24
    s_lshl_b32 s44, s33, 4
    s_add_u32 s44, s44, s32
    s_max_u32 s44, s44, 2
    s_sub_u32 s44, s44, 2
    s_mul_i32 s44, s44, 10240
    v_add_u32 v10, s44, v7
    s_add_u32 s46, s32, 8
    s_lshl_b32 s44, s33, 4
    s_add_u32 s44, s44, s46
    s_max_u32 s44, s44, 2
    s_sub_u32 s44, s44, 2
    s_mul_i32 s44, s44, 10240
    v_add_u32 v11, s44, v7
    s_and_b32 s46, s32, 1
    s_add_u32 s46, s46, 16
    s_lshl_b32 s44, s33, 4
    s_add_u32 s44, s44, s46
    s_max_u32 s44, s44, 2
    s_sub_u32 s44, s44, 2
    s_mul_i32 s44, s44, 10240
    v_add_u32 v19, s44, v7
    s_mov_b32 s47, 0
    s_mov_b32 s48, 0
    s_add_u32 m0, s40, 0
    s_nop 0
    buffer_load_dwordx4 v12, s[16:19], s48 offen lds
    s_cmp_eq_u32 s32, 7
    s_cbranch_scc1 L_a_s1_a_0
    s_add_u32 m0, s41, 0
    s_nop 0
    buffer_load_dwordx4 v13, s[16:19], s48 offen lds
L_a_s1_a_0:
    s_add_u32 s48, s48, 122880
    s_cmp_ge_u32 s32, 6
    s_cbranch_scc1 L_a_s4_a_0_o
L_a_s4_a_0:
    s_add_u32 m0, s42, 0
    s_nop 0
    buffer_load_dwordx4 v10, s[28:31], s47 offen lds
    s_add_u32 m0, s42, 8192
    s_nop 0
    buffer_load_dwordx4 v11, s[28:31], s47 offen lds
    s_add_u32 s47, s47, 128
    s_add_u32 m0, s40, 15360
    s_nop 0
    buffer_load_dwordx4 v12, s[16:19], s48 offen lds
    s_cmp_eq_u32 s32, 7
    s_cbranch_scc1 L_a_s1_a_1
    s_add_u32 m0, s41, 15360
    s_nop 0
    buffer_load_dwordx4 v13, s[16:19], s48 offen lds
L_a_s1_a_1:
    s_add_u32 s48, s48, 122880
    s_add_u32 m0, s40, 30720
    s_nop 0
    buffer_load_dwordx4 v12, s[16:19], s48 offen lds
    s_cmp_eq_u32 s32, 7
    s_cbranch_scc1 L_a_s1_a_2
    s_add_u32 m0, s41, 30720
    s_nop 0
    buffer_load_dwordx4 v13, s[16:19], s48 offen lds
L_a_s1_a_2:
    s_add_u32 s48, s48, 122880
    s_cmp_ge_u32 s32, 6
    s_cbranch_scc1 L_a_s4_a_2_o
L_a_s4_a_2:
    s_add_u32 m0, s42, 18432
    s_nop 0
    buffer_load_dwordx4 v10, s[28:31], s47 offen lds
    s_add_u32 m0, s42, 26624
    s_nop 0
    buffer_load_dwordx4 v11, s[28:31], s47 offen lds
    s_add_u32 s47, s47, 128
    s_add_u32 m0, s40, 46080
    s_nop 0
    buffer_load_dwordx4 v12, s[16:19], s48 offen lds
    s_cmp_eq_u32 s32, 7
    s_cbranch_scc1 L_a_s1_a_3
    s_add_u32 m0, s41, 46080
    s_nop 0
    buffer_load_dwordx4 v13, s[16:19], s48 offen lds
L_a_s1_a_3:
    s_add_u32 s48, s48, 122880
    s_add_u32 s44, s37, 0
    s_sub_u32 s46, s44, 5
    s_cmp_ge_u32 s44, 5
    s_cselect_b32 s46, s46, s44
    s_and_b32 s44, s44, 3
    s_add_u32 s44, s44, 5
    s_cmp_eq_u32 s36, 0
    s_cselect_b32 s44, s46, s44
    s_mul_i32 s70, s44, 7808
    s_lshl_b32 s46, s44, 8
    s_add_u32 s75, s46, 159744
    s_lshl_b32 s44, s44, 11
    v_add_u32 v208, s44, v8
    v_xor_b32 v213, 64, v208
    s_add_u32 s44, s37, 1
    s_sub_u32 s46, s44, 5
    s_cmp_ge_u32 s44, 5
    s_cselect_b32 s46, s46, s44
    s_and_b32 s44, s44, 3
    s_add_u32 s44, s44, 5
    s_cmp_eq_u32 s36, 0
    s_cselect_b32 s44, s46, s44
    s_mul_i32 s71, s44, 7808
    s_lshl_b32 s46, s44, 8
    s_add_u32 s76, s46, 159744
    s_lshl_b32 s44, s44, 11
    v_add_u32 v209, s44, v8
    v_xor_b32 v214, 64, v209
    s_add_u32 s44, s37, 2
    s_sub_u32 s46, s44, 5
    s_cmp_ge_u32 s44, 5
    s_cselect_b32 s46, s46, s44
    s_and_b32 s44, s44, 3
    s_add_u32 s44, s44, 5
    s_cmp_eq_u32 s36, 0
    s_cselect_b32 s44, s46, s44
    s_mul_i32 s72, s44, 7808
    s_lshl_b32 s46, s44, 8
    s_add_u32 s77, s46, 159744
    s_lshl_b32 s44, s44, 11
    v_add_u32 v210, s44, v8
    v_xor_b32 v215, 64, v210
    s_add_u32 s44, s37, 3
    s_sub_u32 s46, s44, 5
    s_cmp_ge_u32 s44, 5
    s_cselect_b32 s46, s46, s44
    s_and_b32 s44, s44, 3
    s_add_u32 s44, s44, 5
    s_cmp_eq_u32 s36, 0
    s_cselect_b32 s44, s46, s44
    s_mul_i32 s73, s44, 7808
    s_lshl_b32 s46, s44, 8
    s_add_u32 s78, s46, 159744
    s_lshl_b32 s44, s44, 11
    v_add_u32 v211, s44, v8
    v_xor_b32 v216, 64, v211
    s_add_u32 s44, s37, 4
    s_sub_u32 s46, s44, 5
    s_cmp_ge_u32 s44, 5
    s_cselect_b32 s46, s46, s44
    s_mov_b32 s44, 4
    s_cmp_eq_u32 s36, 0
    s_cselect_b32 s44, s46, s44
    s_mul_i32 s74, s44, 7808
    s_lshl_b32 s46, s44, 8
    s_add_u32 s79, s46, 159744
    s_lshl_b32 s44, s44, 11
    v_add_u32 v212, s44, v8
    v_xor_b32 v217, 64, v212
    v_mul_u32_u24 v20, 480, v9
    v_lshl_add_u32 v20, v4, 3, v20
    v_add_u32 v20, 55296, v20
    s_lshl_b32 s44, s36, 1
    s_add_u32 s44, s44, 0
    s_and_b32 s44, s44, 3
    s_lshl_b32 s46, s37, 2
    s_add_u32 s44, s44, s46
    s_lshl_b32 s44, s44, 5
    v_add_u32 v220, s44, v20
    s_lshl_b32 s44, s36, 1
    s_add_u32 s44, s44, 1
    s_and_b32 s44, s44, 3
    s_lshl_b32 s46, s37, 2
    s_add_u32 s44, s44, s46
    s_mov_b32 s50, s44
    s_lshl_b32 s44, s44, 5
    v_add_u32 v221, s44, v20
    s_lshl_b32 s44, s36, 1
    s_add_u32 s44, s44, 2
    s_and_b32 s44, s44, 3
    s_lshl_b32 s46, s37, 2
    s_add_u32 s44, s44, s46
    s_lshl_b32 s44, s44, 5
    v_add_u32 v222, s44, v20
    s_lshl_b32 s44, s36, 1
    s_add_u32 s44, s44, 3
    s_and_b32 s44, s44, 3
    s_lshl_b32 s46, s37, 2
    s_add_u32 s44, s44, s46
    s_mov_b32 s51, s44
    s_lshl_b32 s44, s44, 5
    v_add_u32 v223, s44, v20
    v_mul_u32_u24 v21, 488, v6
    v_lshl_add_u32 v21, v2, 3, v21
    s_lshl_b32 s44, s36, 1
    s_add_u32 s44, s44, 0
    s_and_b32 s44, s44, 3
    s_lshl_b32 s46, s37, 2
    s_add_u32 s44, s44, s46
    s_lshl_b32 s46, s44, 5
    v_add_u32 v200, s46, v21
    s_lshl_b32 s44, s44, 6
    s_add_u32 s44, s44, 162304
    v_lshl_add_u32 v224, v2, 4, s44
    s_lshl_b32 s44, s36, 1
    s_add_u32 s44, s44, 1
    s_and_b32 s44, s44, 3
    s_lshl_b32 s46, s37, 2
    s_add_u32 s44, s44, s46
    s_lshl_b32 s46, s44, 5
    v_add_u32 v201, s46, v21
    s_lshl_b32 s44, s44, 6
    s_add_u32 s44, s44, 162304
    v_lshl_add_u32 v225, v2, 4, s44
    s_lshl_b32 s44, s36, 1
    s_add_u32 s44, s44, 2
    s_and_b32 s44, s44, 3
    s_lshl_b32 s46, s37, 2
    s_add_u32 s44, s44, s46
    s_lshl_b32 s46, s44, 5
    v_add_u32 v202, s46, v21
    s_lshl_b32 s44, s44, 6
    s_add_u32 s44, s44, 162304
    v_lshl_add_u32 v226, v2, 4, s44
    s_lshl_b32 s44, s36, 1
    s_add_u32 s44, s44, 3
    s_and_b32 s44, s44, 3
    s_lshl_b32 s46, s37, 2
    s_add_u32 s44, s44, s46
    s_lshl_b32 s46, s44, 5
    v_add_u32 v203, s46, v21
    s_lshl_b32 s44, s44, 6
    s_add_u32 s44, s44, 162304
    v_lshl_add_u32 v227, v2, 4, s44
    v_lshl_add_u32 v20, v6, 1, s36
    v_add_u32 v21, 16, v20
    v_subrev_u32 v22, 16, v20
    v_max_i32 v22, 0, v22
    s_mul_i32 s44, s37, 40
    v_mul_u32_u24 v21, 488, v21
    v_mul_u32_u24 v22, 488, v22
    v_lshl_add_u32 v23, v2, 4, s44
    v_add_u32 v204, v21, v23
    v_add_u32 v205, v22, v23
    v_lshl_add_u32 v20, v2, 2, v3
    v_lshl_add_u32 v20, v20, 1, s36
    v_add_u32 v21, 16, v20
    v_subrev_u32 v22, 16, v20
    v_max_i32 v22, 0, v22
    v_mul_u32_u24 v21, 488, v21
    v_mul_u32_u24 v22, 488, v22
    v_lshl_add_u32 v23, v4, 3, s44
    v_add_u32 v206, v21, v23
    v_add_u32 v207, v22, v23
    s_mul_i32 s44, s34, 80
    s_mul_i32 s46, s37, 20
    s_add_u32 s44, s44, s46
    v_lshl_add_u32 v23, v2, 2, s44
    v_lshrrev_b32 v21, 3, v23
    v_lshlrev_b32 v21, 8, v21
    v_and_b32 v23, 4, v23
    v_lshl_add_u32 v21, v23, 1, v21
    v_lshrrev_b32 v23, 3, v6
    s_lshl_b32 s46, s33, 3
    v_add_u32 v23, s46, v23
    v_mul_u32_u24 v23, 69632, v23
    v_and_b32 v22, 7, v6
    v_lshl_add_u32 v22, v22, 1, s36
    v_lshl_add_u32 v23, v22, 4, v23
    v_add_u32 v218, v23, v21
    s_add_u32 s44, s44, 16
    s_lshr_b32 s46, s44, 3
    s_lshl_b32 s46, s46, 8
    s_and_b32 s44, s44, 4
    s_lshl_b32 s44, s44, 1
    s_add_u32 s46, s46, s44
    v_add_u32 v219, s46, v23
    v_lshlrev_b32 v20, 2, v2
    v_add_u32 v21, 9, v6
    v_add_u32 v22, 0, v20
    v_cmp_ge_u32 s[80:81], v22, v21
    v_cmp_le_u32 s[88:89], v22, v6
    v_add_u32 v22, 7, v22
    v_cmp_ge_u32 s[38:39], v22, v6
    s_nop 1
    s_and_b64 s[88:89], s[88:89], s[38:39]
    v_add_u32 v22, 1, v20
    v_cmp_ge_u32 s[82:83], v22, v21
    v_cmp_le_u32 s[90:91], v22, v6
    v_add_u32 v22, 7, v22
    v_cmp_ge_u32 s[38:39], v22, v6
    s_nop 1
    s_and_b64 s[90:91], s[90:91], s[38:39]
    v_add_u32 v22, 2, v20
    v_cmp_ge_u32 s[84:85], v22, v21
    v_cmp_le_u32 s[92:93], v22, v6
    v_add_u32 v22, 7, v22
    v_cmp_ge_u32 s[38:39], v22, v6
    s_nop 1
    s_and_b64 s[92:93], s[92:93], s[38:39]
    v_add_u32 v22, 3, v20
    v_cmp_ge_u32 s[86:87], v22, v21
    v_cmp_le_u32 s[94:95], v22, v6
    v_add_u32 v22, 7, v22
    v_cmp_ge_u32 s[38:39], v22, v6
    s_nop 1
    s_and_b64 s[94:95], s[94:95], s[38:39]
    v_cmp_gt_u32 s[38:39], 3, v2
    v_cmp_gt_u32 s[96:97], 2, v2
    s_cmp_eq_u32 s36, 0
    s_cbranch_scc0 L_a_loop1
    s_waitcnt vmcnt(5)
    s_barrier
    ds_read_b128 v[128:131], v208 offset:0
    ds_read_b128 v[132:135], v209 offset:0
    ds_read_b128 v[136:139], v210 offset:0
    ds_read_b128 v[140:143], v211 offset:0
    ds_read_b128 v[144:147], v212 offset:0
    ds_read_b64_tr_b16 v[148:149], v220 offset:0
    ds_read_b64_tr_b16 v[150:151], v220 offset:3840
    ds_read_b64_tr_b16 v[152:153], v221 offset:0
    ds_read_b64_tr_b16 v[154:155], v221 offset:3840
    ds_read_b64_tr_b16 v[156:157], v222 offset:0
    ds_read_b64_tr_b16 v[158:159], v222 offset:3840
    ds_read_b64_tr_b16 v[160:161], v223 offset:0
    ds_read_b64_tr_b16 v[162:163], v223 offset:3840
    s_waitcnt vmcnt(4) lgkmcnt(0)
    s_barrier
    s_mul_i32 s44, s33, 12
    s_add_u32 s44, s44, 128
    v_min_u32 v20, 11, v0
    v_add_u32 v20, s44, v20
    v_mul_u32_u24 v20, 3840, v20
    v_add_u32 v20, s45, v20
    s_mul_i32 s44, s32, 1280
    s_cmp_lt_u32 s32, 3
    s_cbranch_scc0 L_tlb_a0_a0_0
    buffer_load_dword v244, v20, s[16:19], s44 offen
L_tlb_a0_a0_0:
    s_sub_u32 s44, s32, 3
    s_cmp_lt_u32 s44, 3
    s_cbranch_scc0 L_tlb_a1_a0_0
    s_mul_i32 s44, s44, 1280
    buffer_load_dword v244, v20, s[16:19], s44 offen offset:128
L_tlb_a1_a0_0:
    v_mfma_f32_16x16x32_bf16 v[32:35], v[148:151], v[128:131], 0
    s_add_u32 m0, s40, 0
    s_nop 0
    buffer_load_dwordx4 v12, s[16:19], s48 offen lds
    v_mfma_f32_16x16x32_bf16 v[48:51], v[148:151], v[132:135], 0
    ds_read_b128 v[164:167], v213 offset:0
    v_mfma_f32_16x16x32_bf16 v[64:67], v[148:151], v[136:139], 0
    ds_read_b128 v[168:171], v214 offset:0
    v_mfma_f32_16x16x32_bf16 v[80:83], v[148:151], v[140:143], 0
    v_mfma_f32_16x16x32_bf16 v[96:99], v[148:151], v[144:147], 0
    ds_read_b128 v[172:175], v215 offset:0
    v_mfma_f32_16x16x32_bf16 v[36:39], v[152:155], v[128:131], 0
    ds_read_b128 v[176:179], v216 offset:0
    v_mfma_f32_16x16x32_bf16 v[52:55], v[152:155], v[132:135], 0
    s_cmp_eq_u32 s32, 7
    s_cbranch_scc1 L_a_s1_a0_4
    s_add_u32 m0, s41, 0
    s_nop 0
    buffer_load_dwordx4 v13, s[16:19], s48 offen lds
L_a_s1_a0_4:
    s_add_u32 s48, s48, 122880
    s_cmp_ge_u32 s32, 6
    s_cbranch_scc1 L_a_s4_a0_4_o
L_a_s4_a0_4:
    s_add_u32 m0, s42, 36864
    s_nop 0
    buffer_load_dwordx4 v10, s[28:31], s47 offen lds
    ds_read_b128 v[180:183], v217 offset:0
    v_mfma_f32_16x16x32_bf16 v[68:71], v[152:155], v[136:139], 0
    v_mfma_f32_16x16x32_bf16 v[84:87], v[152:155], v[140:143], 0
    ds_read_b64_tr_b16 v[184:185], v220 offset:15360
    v_mfma_f32_16x16x32_bf16 v[100:103], v[152:155], v[144:147], 0
    ds_read_b64_tr_b16 v[186:187], v220 offset:19200
    v_mfma_f32_16x16x32_bf16 v[40:43], v[156:159], v[128:131], 0
    v_mfma_f32_16x16x32_bf16 v[56:59], v[156:159], v[132:135], 0
    s_add_u32 m0, s42, 45056
    s_nop 0
    buffer_load_dwordx4 v11, s[28:31], s47 offen lds
    ds_read_b64_tr_b16 v[188:189], v221 offset:15360
    v_mfma_f32_16x16x32_bf16 v[72:75], v[156:159], v[136:139], 0
    ds_read_b64_tr_b16 v[190:191], v221 offset:19200
    v_mfma_f32_16x16x32_bf16 v[88:91], v[156:159], v[140:143], 0
    ds_read_b64_tr_b16 v[192:193], v222 offset:15360
    v_mfma_f32_16x16x32_bf16 v[104:107], v[156:159], v[144:147], 0
    v_mfma_f32_16x16x32_bf16 v[44:47], v[160:163], v[128:131], 0
    ds_read_b64_tr_b16 v[194:195], v222 offset:19200
    v_mfma_f32_16x16x32_bf16 v[60:63], v[160:163], v[132:135], 0
    ds_read_b64_tr_b16 v[196:197], v223 offset:15360
    v_mfma_f32_16x16x32_bf16 v[76:79], v[160:163], v[136:139], 0
    s_add_u32 s47, s47, 128
    ds_read_b64_tr_b16 v[198:199], v223 offset:19200
    v_mfma_f32_16x16x32_bf16 v[92:95], v[160:163], v[140:143], 0
    v_mfma_f32_16x16x32_bf16 v[108:111], v[160:163], v[144:147], 0
    v_mfma_f32_16x16x32_bf16 v[232:235], v[148:151], v[228:231], 0
    v_mfma_f32_16x16x32_bf16 v[236:239], v[152:155], v[228:231], 0
    v_mfma_f32_16x16x32_bf16 v[112:115], v[228:231], v[128:131], 0
    v_mfma_f32_16x16x32_bf16 v[116:119], v[128:131], v[128:131], 0
    s_waitcnt vmcnt(4) lgkmcnt(0)
    s_barrier
    v_mfma_f32_16x16x32_bf16 v[32:35], v[184:187], v[164:167], v[32:35]
    s_add_u32 m0, s40, 15360
    s_nop 0
    buffer_load_dwordx4 v12, s[16:19], s48 offen lds
    v_mfma_f32_16x16x32_bf16 v[48:51], v[184:187], v[168:171], v[48:51]
    ds_read_b128 v[128:131], v208 offset:18432
    v_mfma_f32_16x16x32_bf16 v[64:67], v[184:187], v[172:175], v[64:67]
    ds_read_b128 v[132:135], v209 offset:18432
    v_mfma_f32_16x16x32_bf16 v[80:83], v[184:187], v[176:179], v[80:83]
    v_mfma_f32_16x16x32_bf16 v[96:99], v[184:187], v[180:183], v[96:99]
    ds_read_b128 v[136:139], v210 offset:18432
    v_mfma_f32_16x16x32_bf16 v[36:39], v[188:191], v[164:167], v[36:39]
    ds_read_b128 v[140:143], v211 offset:18432
    v_mfma_f32_16x16x32_bf16 v[52:55], v[188:191], v[168:171], v[52:55]
    ds_read_b128 v[144:147], v212 offset:18432
    v_mfma_f32_16x16x32_bf16 v[68:71], v[188:191], v[172:175], v[68:71]
    v_mfma_f32_16x16x32_bf16 v[84:87], v[188:191], v[176:179], v[84:87]
    ds_read_b64_tr_b16 v[148:149], v220 offset:30720
    v_mfma_f32_16x16x32_bf16 v[100:103], v[188:191], v[180:183], v[100:103]
    ds_read_b64_tr_b16 v[150:151], v220 offset:34560
    v_mfma_f32_16x16x32_bf16 v[40:43], v[192:195], v[164:167], v[40:43]
    v_mfma_f32_16x16x32_bf16 v[56:59], v[192:195], v[168:171], v[56:59]
    s_cmp_eq_u32 s32, 7
    s_cbranch_scc1 L_a_s1_a0_5
    s_add_u32 m0, s41, 15360
    s_nop 0
    buffer_load_dwordx4 v13, s[16:19], s48 offen lds
L_a_s1_a0_5:
    s_add_u32 s48, s48, 122880
    ds_read_b64_tr_b16 v[152:153], v221 offset:30720
    v_mfma_f32_16x16x32_bf16 v[72:75], v[192:195], v[172:175], v[72:75]
    ds_read_b64_tr_b16 v[154:155], v221 offset:34560
    v_mfma_f32_16x16x32_bf16 v[88:91], v[192:195], v[176:179], v[88:91]
    ds_read_b64_tr_b16 v[156:157], v222 offset:30720
    v_mfma_f32_16x16x32_bf16 v[104:107], v[192:195], v[180:183], v[104:107]
    v_mfma_f32_16x16x32_bf16 v[44:47], v[196:199], v[164:167], v[44:47]
    ds_read_b64_tr_b16 v[158:159], v222 offset:34560
    v_mfma_f32_16x16x32_bf16 v[60:63], v[196:199], v[168:171], v[60:63]
    ds_read_b64_tr_b16 v[160:161], v223 offset:30720
    v_mfma_f32_16x16x32_bf16 v[76:79], v[196:199], v[172:175], v[76:79]
    ds_read_b64_tr_b16 v[162:163], v223 offset:34560
    v_mfma_f32_16x16x32_bf16 v[92:95], v[196:199], v[176:179], v[92:95]
    v_mfma_f32_16x16x32_bf16 v[108:111], v[196:199], v[180:183], v[108:111]
    v_mfma_f32_16x16x32_bf16 v[232:235], v[184:187], v[228:231], v[232:235]
    v_mfma_f32_16x16x32_bf16 v[236:239], v[188:191], v[228:231], v[236:239]
    v_mfma_f32_16x16x32_bf16 v[112:115], v[228:231], v[164:167], v[112:115]
    v_mfma_f32_16x16x32_bf16 v[116:119], v[164:167], v[164:167], v[116:119]
    s_waitcnt vmcnt(4) lgkmcnt(0)
    s_barrier
    v_mfma_f32_16x16x32_bf16 v[32:35], v[148:151], v[128:131], v[32:35]
    s_add_u32 m0, s40, 30720
    s_nop 0
    buffer_load_dwordx4 v12, s[16:19], s48 offen lds
    v_mfma_f32_16x16x32_bf16 v[48:51], v[148:151], v[132:135], v[48:51]
    ds_read_b128 v[164:167], v213 offset:18432
    v_mfma_f32_16x16x32_bf16 v[64:67], v[148:151], v[136:139], v[64:67]
    ds_read_b128 v[168:171], v214 offset:18432
    v_mfma_f32_16x16x32_bf16 v[80:83], v[148:151], v[140:143], v[80:83]
    v_mfma_f32_16x16x32_bf16 v[96:99], v[148:151], v[144:147], v[96:99]
    ds_read_b128 v[172:175], v215 offset:18432
    v_mfma_f32_16x16x32_bf16 v[36:39], v[152:155], v[128:131], v[36:39]
    ds_read_b128 v[176:179], v216 offset:18432
    v_mfma_f32_16x16x32_bf16 v[52:55], v[152:155], v[132:135], v[52:55]
    s_cmp_eq_u32 s32, 7
    s_cbranch_scc1 L_a_s1_a0_6
    s_add_u32 m0, s41, 30720
    s_nop 0
    buffer_load_dwordx4 v13, s[16:19], s48 offen lds
L_a_s1_a0_6:
    s_add_u32 s48, s48, 122880
    s_cmp_ge_u32 s32, 6
    s_cbranch_scc1 L_a_s4_a0_6_o
L_a_s4_a0_6:
    s_add_u32 m0, s42, 0
    s_nop 0
    buffer_load_dwordx4 v10, s[28:31], s47 offen lds
    ds_read_b128 v[180:183], v217 offset:18432
    v_mfma_f32_16x16x32_bf16 v[68:71], v[152:155], v[136:139], v[68:71]
    v_mfma_f32_16x16x32_bf16 v[84:87], v[152:155], v[140:143], v[84:87]
    ds_read_b64_tr_b16 v[184:185], v220 offset:46080
    v_mfma_f32_16x16x32_bf16 v[100:103], v[152:155], v[144:147], v[100:103]
    ds_read_b64_tr_b16 v[186:187], v220 offset:49920
    v_mfma_f32_16x16x32_bf16 v[40:43], v[156:159], v[128:131], v[40:43]
    v_mfma_f32_16x16x32_bf16 v[56:59], v[156:159], v[132:135], v[56:59]
    s_add_u32 m0, s42, 8192
    s_nop 0
    buffer_load_dwordx4 v11, s[28:31], s47 offen lds
    ds_read_b64_tr_b16 v[188:189], v221 offset:46080
    v_mfma_f32_16x16x32_bf16 v[72:75], v[156:159], v[136:139], v[72:75]
    ds_read_b64_tr_b16 v[190:191], v221 offset:49920
    v_mfma_f32_16x16x32_bf16 v[88:91], v[156:159], v[140:143], v[88:91]
    ds_read_b64_tr_b16 v[192:193], v222 offset:46080
    v_mfma_f32_16x16x32_bf16 v[104:107], v[156:159], v[144:147], v[104:107]
    v_mfma_f32_16x16x32_bf16 v[44:47], v[160:163], v[128:131], v[44:47]
    ds_read_b64_tr_b16 v[194:195], v222 offset:49920
    v_mfma_f32_16x16x32_bf16 v[60:63], v[160:163], v[132:135], v[60:63]
    ds_read_b64_tr_b16 v[196:197], v223 offset:46080
    v_mfma_f32_16x16x32_bf16 v[76:79], v[160:163], v[136:139], v[76:79]
    s_add_u32 s47, s47, 128
    ds_read_b64_tr_b16 v[198:199], v223 offset:49920
    v_mfma_f32_16x16x32_bf16 v[92:95], v[160:163], v[140:143], v[92:95]
    v_mfma_f32_16x16x32_bf16 v[108:111], v[160:163], v[144:147], v[108:111]
    v_mfma_f32_16x16x32_bf16 v[232:235], v[148:151], v[228:231], v[232:235]
    v_mfma_f32_16x16x32_bf16 v[236:239], v[152:155], v[228:231], v[236:239]
    v_mfma_f32_16x16x32_bf16 v[112:115], v[228:231], v[128:131], v[112:115]
    v_mfma_f32_16x16x32_bf16 v[116:119], v[128:131], v[128:131], v[116:119]
    s_waitcnt vmcnt(4) lgkmcnt(0)
    s_barrier
    s_mul_i32 s44, s33, 10
    s_add_u32 s44, s44, 320
    v_min_u32 v20, 9, v0
    v_add_u32 v20, s44, v20
    v_mul_u32_u24 v20, 3840, v20
    v_add_u32 v20, s45, v20
    s_mul_i32 s44, s32, 1280
    s_cmp_lt_u32 s32, 3
    s_cbranch_scc0 L_tlb_a0_a0_1
    buffer_load_dword v244, v20, s[16:19], s44 offen
L_tlb_a0_a0_1:
    s_sub_u32 s44, s32, 3
    s_cmp_lt_u32 s44, 3
    s_cbranch_scc0 L_tlb_a1_a0_1
    s_mul_i32 s44, s44, 1280
    buffer_load_dword v244, v20, s[16:19], s44 offen offset:128
L_tlb_a1_a0_1:
    v_mfma_f32_16x16x32_bf16 v[32:35], v[184:187], v[164:167], v[32:35]
    s_add_u32 m0, s40, 46080
    s_nop 0
    buffer_load_dwordx4 v12, s[16:19], s48 offen lds
    v_mfma_f32_16x16x32_bf16 v[48:51], v[184:187], v[168:171], v[48:51]
    ds_read_b128 v[128:131], v208 offset:36864
    v_mfma_f32_16x16x32_bf16 v[64:67], v[184:187], v[172:175], v[64:67]
    ds_read_b128 v[132:135], v209 offset:36864
    v_mfma_f32_16x16x32_bf16 v[80:83], v[184:187], v[176:179], v[80:83]
    v_mfma_f32_16x16x32_bf16 v[96:99], v[184:187], v[180:183], v[96:99]
    ds_read_b128 v[136:139], v210 offset:36864
    v_mfma_f32_16x16x32_bf16 v[36:39], v[188:191], v[164:167], v[36:39]
    ds_read_b128 v[140:143], v211 offset:36864
    v_mfma_f32_16x16x32_bf16 v[52:55], v[188:191], v[168:171], v[52:55]
    ds_read_b128 v[144:147], v212 offset:36864
    v_mfma_f32_16x16x32_bf16 v[68:71], v[188:191], v[172:175], v[68:71]
    v_mfma_f32_16x16x32_bf16 v[84:87], v[188:191], v[176:179], v[84:87]
    ds_read_b64_tr_b16 v[148:149], v220 offset:0
    v_mfma_f32_16x16x32_bf16 v[100:103], v[188:191], v[180:183], v[100:103]
    ds_read_b64_tr_b16 v[150:151], v220 offset:3840
    v_mfma_f32_16x16x32_bf16 v[40:43], v[192:195], v[164:167], v[40:43]
    v_mfma_f32_16x16x32_bf16 v[56:59], v[192:195], v[168:171], v[56:59]
    s_cmp_eq_u32 s32, 7
    s_cbranch_scc1 L_a_s1_a0_7
    s_add_u32 m0, s41, 46080
    s_nop 0
    buffer_load_dwordx4 v13, s[16:19], s48 offen lds
L_a_s1_a0_7:
    s_add_u32 s48, s48, 122880
    ds_read_b64_tr_b16 v[152:153], v221 offset:0
    v_mfma_f32_16x16x32_bf16 v[72:75], v[192:195], v[172:175], v[72:75]
    ds_read_b64_tr_b16 v[154:155], v221 offset:3840
    v_mfma_f32_16x16x32_bf16 v[88:91], v[192:195], v[176:179], v[88:91]
    ds_read_b64_tr_b16 v[156:157], v222 offset:0
    v_mfma_f32_16x16x32_bf16 v[104:107], v[192:195], v[180:183], v[104:107]
    v_mfma_f32_16x16x32_bf16 v[44:47], v[196:199], v[164:167], v[44:47]
    ds_read_b64_tr_b16 v[158:159], v222 offset:3840
    v_mfma_f32_16x16x32_bf16 v[60:63], v[196:199], v[168:171], v[60:63]
    ds_read_b64_tr_b16 v[160:161], v223 offset:0
    v_mfma_f32_16x16x32_bf16 v[76:79], v[196:199], v[172:175], v[76:79]
    ds_read_b64_tr_b16 v[162:163], v223 offset:3840
    v_mfma_f32_16x16x32_bf16 v[92:95], v[196:199], v[176:179], v[92:95]
    v_mfma_f32_16x16x32_bf16 v[108:111], v[196:199], v[180:183], v[108:111]
    v_mfma_f32_16x16x32_bf16 v[232:235], v[184:187], v[228:231], v[232:235]
    v_mfma_f32_16x16x32_bf16 v[236:239], v[188:191], v[228:231], v[236:239]
    v_mfma_f32_16x16x32_bf16 v[112:115], v[228:231], v[164:167], v[112:115]
    v_mfma_f32_16x16x32_bf16 v[116:119], v[164:167], v[164:167], v[116:119]
    s_waitcnt vmcnt(4) lgkmcnt(0)
    s_barrier
    v_mfma_f32_16x16x32_bf16 v[32:35], v[148:151], v[128:131], v[32:35]
    s_add_u32 m0, s40, 0
    s_nop 0
    buffer_load_dwordx4 v12, s[16:19], s48 offen lds
    v_mfma_f32_16x16x32_bf16 v[48:51], v[148:151], v[132:135], v[48:51]
    ds_read_b128 v[164:167], v213 offset:36864
    v_mfma_f32_16x16x32_bf16 v[64:67], v[148:151], v[136:139], v[64:67]
    ds_read_b128 v[168:171], v214 offset:36864
    v_mfma_f32_16x16x32_bf16 v[80:83], v[148:151], v[140:143], v[80:83]
    v_mfma_f32_16x16x32_bf16 v[96:99], v[148:151], v[144:147], v[96:99]
    ds_read_b128 v[172:175], v215 offset:36864
    v_mfma_f32_16x16x32_bf16 v[36:39], v[152:155], v[128:131], v[36:39]
    ds_read_b128 v[176:179], v216 offset:36864
    v_mfma_f32_16x16x32_bf16 v[52:55], v[152:155], v[132:135], v[52:55]
    s_cmp_eq_u32 s32, 7
    s_cbranch_scc1 L_a_s1_a0_8
    s_add_u32 m0, s41, 0
    s_nop 0
    buffer_load_dwordx4 v13, s[16:19], s48 offen lds
L_a_s1_a0_8:
    s_add_u32 s48, s48, 122880
    s_cmp_ge_u32 s32, 6
    s_cbranch_scc1 L_a_s4_a0_8_o
L_a_s4_a0_8:
    s_add_u32 m0, s42, 18432
    s_nop 0
    buffer_load_dwordx4 v10, s[28:31], s47 offen lds
    ds_read_b128 v[180:183], v217 offset:36864
    v_mfma_f32_16x16x32_bf16 v[68:71], v[152:155], v[136:139], v[68:71]
    v_mfma_f32_16x16x32_bf16 v[84:87], v[152:155], v[140:143], v[84:87]
    ds_read_b64_tr_b16 v[184:185], v220 offset:15360
    v_mfma_f32_16x16x32_bf16 v[100:103], v[152:155], v[144:147], v[100:103]
    ds_read_b64_tr_b16 v[186:187], v220 offset:19200
    v_mfma_f32_16x16x32_bf16 v[40:43], v[156:159], v[128:131], v[40:43]
    v_mfma_f32_16x16x32_bf16 v[56:59], v[156:159], v[132:135], v[56:59]
    s_add_u32 m0, s42, 26624
    s_nop 0
    buffer_load_dwordx4 v11, s[28:31], s47 offen lds
    ds_read_b64_tr_b16 v[188:189], v221 offset:15360
    v_mfma_f32_16x16x32_bf16 v[72:75], v[156:159], v[136:139], v[72:75]
    ds_read_b64_tr_b16 v[190:191], v221 offset:19200
    v_mfma_f32_16x16x32_bf16 v[88:91], v[156:159], v[140:143], v[88:91]
    ds_read_b64_tr_b16 v[192:193], v222 offset:15360
    v_mfma_f32_16x16x32_bf16 v[104:107], v[156:159], v[144:147], v[104:107]
    v_mfma_f32_16x16x32_bf16 v[44:47], v[160:163], v[128:131], v[44:47]
    ds_read_b64_tr_b16 v[194:195], v222 offset:19200
    v_mfma_f32_16x16x32_bf16 v[60:63], v[160:163], v[132:135], v[60:63]
    ds_read_b64_tr_b16 v[196:197], v223 offset:15360
    v_mfma_f32_16x16x32_bf16 v[76:79], v[160:163], v[136:139], v[76:79]
    s_add_u32 s47, s47, 128
    ds_read_b64_tr_b16 v[198:199], v223 offset:19200
    v_mfma_f32_16x16x32_bf16 v[92:95], v[160:163], v[140:143], v[92:95]
    v_mfma_f32_16x16x32_bf16 v[108:111], v[160:163], v[144:147], v[108:111]
    v_mfma_f32_16x16x32_bf16 v[232:235], v[148:151], v[228:231], v[232:235]
    v_mfma_f32_16x16x32_bf16 v[236:239], v[152:155], v[228:231], v[236:239]
    v_mfma_f32_16x16x32_bf16 v[112:115], v[228:231], v[128:131], v[112:115]
    v_mfma_f32_16x16x32_bf16 v[116:119], v[128:131], v[128:131], v[116:119]
    s_waitcnt vmcnt(4) lgkmcnt(0)
    s_barrier
    v_mfma_f32_16x16x32_bf16 v[32:35], v[184:187], v[164:167], v[32:35]
    s_add_u32 m0, s40, 15360
    s_nop 0
    buffer_load_dwordx4 v12, s[16:19], s48 offen lds
    v_mfma_f32_16x16x32_bf16 v[48:51], v[184:187], v[168:171], v[48:51]
    ds_read_b128 v[128:131], v208 offset:0
    v_mfma_f32_16x16x32_bf16 v[64:67], v[184:187], v[172:175], v[64:67]
    ds_read_b128 v[132:135], v209 offset:0
    v_mfma_f32_16x16x32_bf16 v[80:83], v[184:187], v[176:179], v[80:83]
    v_mfma_f32_16x16x32_bf16 v[96:99], v[184:187], v[180:183], v[96:99]
    ds_read_b128 v[136:139], v210 offset:0
    v_mfma_f32_16x16x32_bf16 v[36:39], v[188:191], v[164:167], v[36:39]
    ds_read_b128 v[140:143], v211 offset:0
    v_mfma_f32_16x16x32_bf16 v[52:55], v[188:191], v[168:171], v[52:55]
    ds_read_b128 v[144:147], v212 offset:0
    v_mfma_f32_16x16x32_bf16 v[68:71], v[188:191], v[172:175], v[68:71]
    v_mfma_f32_16x16x32_bf16 v[84:87], v[188:191], v[176:179], v[84:87]
    ds_read_b64_tr_b16 v[148:149], v220 offset:30720
    v_mfma_f32_16x16x32_bf16 v[100:103], v[188:191], v[180:183], v[100:103]
    ds_read_b64_tr_b16 v[150:151], v220 offset:34560
    v_mfma_f32_16x16x32_bf16 v[40:43], v[192:195], v[164:167], v[40:43]
    v_mfma_f32_16x16x32_bf16 v[56:59], v[192:195], v[168:171], v[56:59]
    s_cmp_eq_u32 s32, 7
    s_cbranch_scc1 L_a_s1_a0_9
    s_add_u32 m0, s41, 15360
    s_nop 0
    buffer_load_dwordx4 v13, s[16:19], s48 offen lds
L_a_s1_a0_9:
    s_add_u32 s48, s48, 122880
    ds_read_b64_tr_b16 v[152:153], v221 offset:30720
    v_mfma_f32_16x16x32_bf16 v[72:75], v[192:195], v[172:175], v[72:75]
    ds_read_b64_tr_b16 v[154:155], v221 offset:34560
    v_mfma_f32_16x16x32_bf16 v[88:91], v[192:195], v[176:179], v[88:91]
    ds_read_b64_tr_b16 v[156:157], v222 offset:30720
    v_mfma_f32_16x16x32_bf16 v[104:107], v[192:195], v[180:183], v[104:107]
    v_mfma_f32_16x16x32_bf16 v[44:47], v[196:199], v[164:167], v[44:47]
    ds_read_b64_tr_b16 v[158:159], v222 offset:34560
    v_mfma_f32_16x16x32_bf16 v[60:63], v[196:199], v[168:171], v[60:63]
    ds_read_b64_tr_b16 v[160:161], v223 offset:30720
    v_mfma_f32_16x16x32_bf16 v[76:79], v[196:199], v[172:175], v[76:79]
    ds_read_b64_tr_b16 v[162:163], v223 offset:34560
    v_mfma_f32_16x16x32_bf16 v[92:95], v[196:199], v[176:179], v[92:95]
    v_mfma_f32_16x16x32_bf16 v[108:111], v[196:199], v[180:183], v[108:111]
    v_mfma_f32_16x16x32_bf16 v[232:235], v[184:187], v[228:231], v[232:235]
    v_mfma_f32_16x16x32_bf16 v[236:239], v[188:191], v[228:231], v[236:239]
    v_mfma_f32_16x16x32_bf16 v[112:115], v[228:231], v[164:167], v[112:115]
    v_mfma_f32_16x16x32_bf16 v[116:119], v[164:167], v[164:167], v[116:119]
    s_waitcnt vmcnt(4) lgkmcnt(0)
    s_barrier
    s_mul_i32 s44, s33, 10
    s_add_u32 s44, s44, 480
    v_min_u32 v20, 9, v0
    v_add_u32 v20, s44, v20
    v_mul_u32_u24 v20, 3840, v20
    v_add_u32 v20, s45, v20
    s_mul_i32 s44, s32, 1280
    s_cmp_lt_u32 s32, 3
    s_cbranch_scc0 L_tlb_a0_a0_2
    buffer_load_dword v244, v20, s[16:19], s44 offen
L_tlb_a0_a0_2:
    s_sub_u32 s44, s32, 3
    s_cmp_lt_u32 s44, 3
    s_cbranch_scc0 L_tlb_a1_a0_2
    s_mul_i32 s44, s44, 1280
    buffer_load_dword v244, v20, s[16:19], s44 offen offset:128
L_tlb_a1_a0_2:
    v_mfma_f32_16x16x32_bf16 v[32:35], v[148:151], v[128:131], v[32:35]
    s_add_u32 m0, s40, 30720
    s_nop 0
    buffer_load_dwordx4 v12, s[16:19], s48 offen lds
    v_mfma_f32_16x16x32_bf16 v[48:51], v[148:151], v[132:135], v[48:51]
    ds_read_b128 v[164:167], v213 offset:0
    v_mfma_f32_16x16x32_bf16 v[64:67], v[148:151], v[136:139], v[64:67]
    ds_read_b128 v[168:171], v214 offset:0
    v_mfma_f32_16x16x32_bf16 v[80:83], v[148:151], v[140:143], v[80:83]
    v_mfma_f32_16x16x32_bf16 v[96:99], v[148:151], v[144:147], v[96:99]
    ds_read_b128 v[172:175], v215 offset:0
    v_mfma_f32_16x16x32_bf16 v[36:39], v[152:155], v[128:131], v[36:39]
    ds_read_b128 v[176:179], v216 offset:0
    v_mfma_f32_16x16x32_bf16 v[52:55], v[152:155], v[132:135], v[52:55]
    s_cmp_eq_u32 s32, 7
    s_cbranch_scc1 L_a_s1_a0_10
    s_add_u32 m0, s41, 30720
    s_nop 0
    buffer_load_dwordx4 v13, s[16:19], s48 offen lds
L_a_s1_a0_10:
    s_add_u32 s48, s48, 122880
    s_cmp_ge_u32 s32, 6
    s_cbranch_scc1 L_a_s4_a0_10_o
L_a_s4_a0_10:
    s_add_u32 m0, s42, 36864
    s_nop 0
    buffer_load_dwordx4 v10, s[28:31], s47 offen lds
    ds_read_b128 v[180:183], v217 offset:0
    v_mfma_f32_16x16x32_bf16 v[68:71], v[152:155], v[136:139], v[68:71]
    v_mfma_f32_16x16x32_bf16 v[84:87], v[152:155], v[140:143], v[84:87]
    ds_read_b64_tr_b16 v[184:185], v220 offset:46080
    v_mfma_f32_16x16x32_bf16 v[100:103], v[152:155], v[144:147], v[100:103]
    ds_read_b64_tr_b16 v[186:187], v220 offset:49920
    v_mfma_f32_16x16x32_bf16 v[40:43], v[156:159], v[128:131], v[40:43]
    v_mfma_f32_16x16x32_bf16 v[56:59], v[156:159], v[132:135], v[56:59]
    s_add_u32 m0, s42, 45056
    s_nop 0
    buffer_load_dwordx4 v11, s[28:31], s47 offen lds
    ds_read_b64_tr_b16 v[188:189], v221 offset:46080
    v_mfma_f32_16x16x32_bf16 v[72:75], v[156:159], v[136:139], v[72:75]
    ds_read_b64_tr_b16 v[190:191], v221 offset:49920
    v_mfma_f32_16x16x32_bf16 v[88:91], v[156:159], v[140:143], v[88:91]
    ds_read_b64_tr_b16 v[192:193], v222 offset:46080
    v_mfma_f32_16x16x32_bf16 v[104:107], v[156:159], v[144:147], v[104:107]
    v_mfma_f32_16x16x32_bf16 v[44:47], v[160:163], v[128:131], v[44:47]
    ds_read_b64_tr_b16 v[194:195], v222 offset:49920
    v_mfma_f32_16x16x32_bf16 v[60:63], v[160:163], v[132:135], v[60:63]
    ds_read_b64_tr_b16 v[196:197], v223 offset:46080
    v_mfma_f32_16x16x32_bf16 v[76:79], v[160:163], v[136:139], v[76:79]
    s_add_u32 s47, s47, 128
    ds_read_b64_tr_b16 v[198:199], v223 offset:49920
    v_mfma_f32_16x16x32_bf16 v[92:95], v[160:163], v[140:143], v[92:95]
    v_mfma_f32_16x16x32_bf16 v[108:111], v[160:163], v[144:147], v[108:111]
    v_mfma_f32_16x16x32_bf16 v[232:235], v[148:151], v[228:231], v[232:235]
    v_mfma_f32_16x16x32_bf16 v[236:239], v[152:155], v[228:231], v[236:239]
    v_mfma_f32_16x16x32_bf16 v[112:115], v[228:231], v[128:131], v[112:115]
    v_mfma_f32_16x16x32_bf16 v[116:119], v[128:131], v[128:131], v[116:119]
    s_waitcnt vmcnt(4) lgkmcnt(0)
    s_barrier
    v_mfma_f32_16x16x32_bf16 v[32:35], v[184:187], v[164:167], v[32:35]
    s_add_u32 m0, s40, 46080
    s_nop 0
    buffer_load_dwordx4 v12, s[16:19], s48 offen lds
    v_mfma_f32_16x16x32_bf16 v[48:51], v[184:187], v[168:171], v[48:51]
    ds_read_b128 v[128:131], v208 offset:18432
    v_mfma_f32_16x16x32_bf16 v[64:67], v[184:187], v[172:175], v[64:67]
    ds_read_b128 v[132:135], v209 offset:18432
    v_mfma_f32_16x16x32_bf16 v[80:83], v[184:187], v[176:179], v[80:83]
    v_mfma_f32_16x16x32_bf16 v[96:99], v[184:187], v[180:183], v[96:99]
    ds_read_b128 v[136:139], v210 offset:18432
    v_mfma_f32_16x16x32_bf16 v[36:39], v[188:191], v[164:167], v[36:39]
    ds_read_b128 v[140:143], v211 offset:18432
    v_mfma_f32_16x16x32_bf16 v[52:55], v[188:191], v[168:171], v[52:55]
    ds_read_b128 v[144:147], v212 offset:18432
    v_mfma_f32_16x16x32_bf16 v[68:71], v[188:191], v[172:175], v[68:71]
    v_mfma_f32_16x16x32_bf16 v[84:87], v[188:191], v[176:179], v[84:87]
    ds_read_b64_tr_b16 v[148:149], v220 offset:0
    v_mfma_f32_16x16x32_bf16 v[100:103], v[188:191], v[180:183], v[100:103]
    ds_read_b64_tr_b16 v[150:151], v220 offset:3840
    v_mfma_f32_16x16x32_bf16 v[40:43], v[192:195], v[164:167], v[40:43]
    v_mfma_f32_16x16x32_bf16 v[56:59], v[192:195], v[168:171], v[56:59]
    s_cmp_eq_u32 s32, 7
    s_cbranch_scc1 L_a_s1_a0_11
    s_add_u32 m0, s41, 46080
    s_nop 0
    buffer_load_dwordx4 v13, s[16:19], s48 offen lds
L_a_s1_a0_11:
    s_add_u32 s48, s48, 122880
    ds_read_b64_tr_b16 v[152:153], v221 offset:0
    v_mfma_f32_16x16x32_bf16 v[72:75], v[192:195], v[172:175], v[72:75]
    ds_read_b64_tr_b16 v[154:155], v221 offset:3840
    v_mfma_f32_16x16x32_bf16 v[88:91], v[192:195], v[176:179], v[88:91]
    ds_read_b64_tr_b16 v[156:157], v222 offset:0
    v_mfma_f32_16x16x32_bf16 v[104:107], v[192:195], v[180:183], v[104:107]
    v_mfma_f32_16x16x32_bf16 v[44:47], v[196:199], v[164:167], v[44:47]
    ds_read_b64_tr_b16 v[158:159], v222 offset:3840
    v_mfma_f32_16x16x32_bf16 v[60:63], v[196:199], v[168:171], v[60:63]
    ds_read_b64_tr_b16 v[160:161], v223 offset:0
    v_mfma_f32_16x16x32_bf16 v[76:79], v[196:199], v[172:175], v[76:79]
    ds_read_b64_tr_b16 v[162:163], v223 offset:3840
    v_mfma_f32_16x16x32_bf16 v[92:95], v[196:199], v[176:179], v[92:95]
    v_mfma_f32_16x16x32_bf16 v[108:111], v[196:199], v[180:183], v[108:111]
    v_mfma_f32_16x16x32_bf16 v[232:235], v[184:187], v[228:231], v[232:235]
    v_mfma_f32_16x16x32_bf16 v[236:239], v[188:191], v[228:231], v[236:239]
    v_mfma_f32_16x16x32_bf16 v[112:115], v[228:231], v[164:167], v[112:115]
    v_mfma_f32_16x16x32_bf16 v[116:119], v[164:167], v[164:167], v[116:119]
    s_waitcnt vmcnt(4) lgkmcnt(0)
    s_barrier
    v_mfma_f32_16x16x32_bf16 v[32:35], v[148:151], v[128:131], v[32:35]
    s_add_u32 m0, s40, 0
    s_nop 0
    buffer_load_dwordx4 v12, s[16:19], s48 offen lds
    v_mfma_f32_16x16x32_bf16 v[48:51], v[148:151], v[132:135], v[48:51]
    ds_read_b128 v[164:167], v213 offset:18432
    v_mfma_f32_16x16x32_bf16 v[64:67], v[148:151], v[136:139], v[64:67]
    ds_read_b128 v[168:171], v214 offset:18432
    v_mfma_f32_16x16x32_bf16 v[80:83], v[148:151], v[140:143], v[80:83]
    v_mfma_f32_16x16x32_bf16 v[96:99], v[148:151], v[144:147], v[96:99]
    ds_read_b128 v[172:175], v215 offset:18432
    v_mfma_f32_16x16x32_bf16 v[36:39], v[152:155], v[128:131], v[36:39]
    ds_read_b128 v[176:179], v216 offset:18432
    v_mfma_f32_16x16x32_bf16 v[52:55], v[152:155], v[132:135], v[52:55]
    s_cmp_eq_u32 s32, 7
    s_cbranch_scc1 L_a_s1_a0_12
    s_add_u32 m0, s41, 0
    s_nop 0
    buffer_load_dwordx4 v13, s[16:19], s48 offen lds
L_a_s1_a0_12:
    s_add_u32 s48, s48, 122880
    s_cmp_ge_u32 s32, 6
    s_cbranch_scc1 L_a_s4_a0_12_o
L_a_s4_a0_12:
    s_add_u32 m0, s42, 0
    s_nop 0
    buffer_load_dwordx4 v10, s[28:31], s47 offen lds
    ds_read_b128 v[180:183], v217 offset:18432
    v_mfma_f32_16x16x32_bf16 v[68:71], v[152:155], v[136:139], v[68:71]
    v_mfma_f32_16x16x32_bf16 v[84:87], v[152:155], v[140:143], v[84:87]
    ds_read_b64_tr_b16 v[184:185], v220 offset:15360
    v_mfma_f32_16x16x32_bf16 v[100:103], v[152:155], v[144:147], v[100:103]
    ds_read_b64_tr_b16 v[186:187], v220 offset:19200
    v_mfma_f32_16x16x32_bf16 v[40:43], v[156:159], v[128:131], v[40:43]
    v_mfma_f32_16x16x32_bf16 v[56:59], v[156:159], v[132:135], v[56:59]
    s_add_u32 m0, s42, 8192
    s_nop 0
    buffer_load_dwordx4 v11, s[28:31], s47 offen lds
    ds_read_b64_tr_b16 v[188:189], v221 offset:15360
    v_mfma_f32_16x16x32_bf16 v[72:75], v[156:159], v[136:139], v[72:75]
    ds_read_b64_tr_b16 v[190:191], v221 offset:19200
    v_mfma_f32_16x16x32_bf16 v[88:91], v[156:159], v[140:143], v[88:91]
    ds_read_b64_tr_b16 v[192:193], v222 offset:15360
    v_mfma_f32_16x16x32_bf16 v[104:107], v[156:159], v[144:147], v[104:107]
    v_mfma_f32_16x16x32_bf16 v[44:47], v[160:163], v[128:131], v[44:47]
    ds_read_b64_tr_b16 v[194:195], v222 offset:19200
    v_mfma_f32_16x16x32_bf16 v[60:63], v[160:163], v[132:135], v[60:63]
    ds_read_b64_tr_b16 v[196:197], v223 offset:15360
    v_mfma_f32_16x16x32_bf16 v[76:79], v[160:163], v[136:139], v[76:79]
    s_add_u32 s47, s47, 128
    ds_read_b64_tr_b16 v[198:199], v223 offset:19200
    v_mfma_f32_16x16x32_bf16 v[92:95], v[160:163], v[140:143], v[92:95]
    v_mfma_f32_16x16x32_bf16 v[108:111], v[160:163], v[144:147], v[108:111]
    v_mfma_f32_16x16x32_bf16 v[232:235], v[148:151], v[228:231], v[232:235]
    v_mfma_f32_16x16x32_bf16 v[236:239], v[152:155], v[228:231], v[236:239]
    v_mfma_f32_16x16x32_bf16 v[112:115], v[228:231], v[128:131], v[112:115]
    v_mfma_f32_16x16x32_bf16 v[116:119], v[128:131], v[128:131], v[116:119]
    s_waitcnt vmcnt(4) lgkmcnt(0)
    s_barrier
    s_mul_i32 s58, s2, 3
    s_add_u32 s58, s58, s32
    s_cmp_lt_u32 s32, 3
    s_cselect_b32 s58, s58, 4095
    s_cmp_lt_u32 s58, 680
    s_cbranch_scc0 L_b2_skip1_a0
    s_mul_i32 s59, s58, 6554
    s_lshr_b32 s59, s59, 16
    s_mul_i32 s60, s59, 10
    s_sub_u32 s60, s58, s60
    s_cmp_lt_u32 s59, 20
    s_cselect_b32 s64, s52, s54
    s_cselect_b32 s65, s53, s55
    s_mov_b32 s66, 1966080
    s_cselect_b32 s66, 819200, s66
    s_mov_b32 s67, 0x00020000
    s_sub_u32 s61, s59, 20
    s_cmp_lt_u32 s59, 20
    s_cselect_b32 s61, s59, s61
    s_mul_i32 s61, s61, 40960
    s_lshl_b32 s62, s60, 7
    s_add_u32 s61, s61, s62
    s_lshl_b32 s62, s32, 12
    s_add_u32 s62, s62, 147456
    v_lshrrev_b32 v20, 3, v0
    v_and_b32 v21, 7, v0
    v_add_u32 v22, 0, v20
    v_lshrrev_b32 v246, 1, v22
    v_and_b32 v246, 4, v246
    v_lshlrev_b32 v247, 1, v22
    v_and_b32 v247, 8, v247
    v_and_b32 v23, 0x13, v22
    v_or3_b32 v23, v23, v246, v247
    v_mul_u32_u24 v23, 1280, v23
    v_lshl_add_u32 v23, v21, 4, v23
    s_add_u32 m0, s62, 0
    s_nop 0
    buffer_load_dwordx4 v23, s[64:67], s61 offen lds
    v_add_u32 v22, 8, v20
    v_lshrrev_b32 v246, 1, v22
    v_and_b32 v246, 4, v246
    v_lshlrev_b32 v247, 1, v22
    v_and_b32 v247, 8, v247
    v_and_b32 v23, 0x13, v22
    v_or3_b32 v23, v23, v246, v247
    v_mul_u32_u24 v23, 1280, v23
    v_lshl_add_u32 v23, v21, 4, v23
    s_add_u32 m0, s62, 1024
    s_nop 0
    buffer_load_dwordx4 v23, s[64:67], s61 offen lds
    v_add_u32 v22, 16, v20
    v_lshrrev_b32 v246, 1, v22
    v_and_b32 v246, 4, v246
    v_lshlrev_b32 v247, 1, v22
    v_and_b32 v247, 8, v247
    v_and_b32 v23, 0x13, v22
    v_or3_b32 v23, v23, v246, v247
    v_mul_u32_u24 v23, 1280, v23
    v_lshl_add_u32 v23, v21, 4, v23
    s_add_u32 m0, s62, 2048
    s_nop 0
    buffer_load_dwordx4 v23, s[64:67], s61 offen lds
    v_add_u32 v22, 24, v20
    v_lshrrev_b32 v246, 1, v22
    v_and_b32 v246, 4, v246
    v_lshlrev_b32 v247, 1, v22
    v_and_b32 v247, 8, v247
    v_and_b32 v23, 0x13, v22
    v_or3_b32 v23, v23, v246, v247
    v_mul_u32_u24 v23, 1280, v23
    v_lshl_add_u32 v23, v21, 4, v23
    s_add_u32 m0, s62, 3072
    s_nop 0
    buffer_load_dwordx4 v23, s[64:67], s61 offen lds
L_b2_skip1_a0:
    v_mfma_f32_16x16x32_bf16 v[32:35], v[184:187], v[164:167], v[32:35]
    s_add_u32 m0, s40, 15360
    s_nop 0
    buffer_load_dwordx4 v12, s[16:19], s48 offen lds
    v_mfma_f32_16x16x32_bf16 v[48:51], v[184:187], v[168:171], v[48:51]
    ds_read_b128 v[128:131], v208 offset:36864
    v_mfma_f32_16x16x32_bf16 v[64:67], v[184:187], v[172:175], v[64:67]
    ds_read_b128 v[132:135], v209 offset:36864
    v_mfma_f32_16x16x32_bf16 v[80:83], v[184:187], v[176:179], v[80:83]
    v_mfma_f32_16x16x32_bf16 v[96:99], v[184:187], v[180:183], v[96:99]
    ds_read_b128 v[136:139], v210 offset:36864
    v_mfma_f32_16x16x32_bf16 v[36:39], v[188:191], v[164:167], v[36:39]
    ds_read_b128 v[140:143], v211 offset:36864
    v_mfma_f32_16x16x32_bf16 v[52:55], v[188:191], v[168:171], v[52:55]
    ds_read_b128 v[144:147], v212 offset:36864
    v_mfma_f32_16x16x32_bf16 v[68:71], v[188:191], v[172:175], v[68:71]
    v_mfma_f32_16x16x32_bf16 v[84:87], v[188:191], v[176:179], v[84:87]
    ds_read_b64_tr_b16 v[148:149], v220 offset:30720
    v_mfma_f32_16x16x32_bf16 v[100:103], v[188:191], v[180:183], v[100:103]
    ds_read_b64_tr_b16 v[150:151], v220 offset:34560
    v_mfma_f32_16x16x32_bf16 v[40:43], v[192:195], v[164:167], v[40:43]
    v_mfma_f32_16x16x32_bf16 v[56:59], v[192:195], v[168:171], v[56:59]
    s_cmp_eq_u32 s32, 7
    s_cbranch_scc1 L_a_s1_a0_13
    s_add_u32 m0, s41, 15360
    s_nop 0
    buffer_load_dwordx4 v13, s[16:19], s48 offen lds
L_a_s1_a0_13:
    s_add_u32 s48, s48, 122880
    ds_read_b64_tr_b16 v[152:153], v221 offset:30720
    v_mfma_f32_16x16x32_bf16 v[72:75], v[192:195], v[172:175], v[72:75]
    ds_read_b64_tr_b16 v[154:155], v221 offset:34560
    v_mfma_f32_16x16x32_bf16 v[88:91], v[192:195], v[176:179], v[88:91]
    ds_read_b64_tr_b16 v[156:157], v222 offset:30720
    v_mfma_f32_16x16x32_bf16 v[104:107], v[192:195], v[180:183], v[104:107]
    v_mfma_f32_16x16x32_bf16 v[44:47], v[196:199], v[164:167], v[44:47]
    ds_read_b64_tr_b16 v[158:159], v222 offset:34560
    v_mfma_f32_16x16x32_bf16 v[60:63], v[196:199], v[168:171], v[60:63]
    ds_read_b64_tr_b16 v[160:161], v223 offset:30720
    v_mfma_f32_16x16x32_bf16 v[76:79], v[196:199], v[172:175], v[76:79]
    ds_read_b64_tr_b16 v[162:163], v223 offset:34560
    v_mfma_f32_16x16x32_bf16 v[92:95], v[196:199], v[176:179], v[92:95]
    v_mfma_f32_16x16x32_bf16 v[108:111], v[196:199], v[180:183], v[108:111]
    v_mfma_f32_16x16x32_bf16 v[232:235], v[184:187], v[228:231], v[232:235]
    v_mfma_f32_16x16x32_bf16 v[236:239], v[188:191], v[228:231], v[236:239]
    v_mfma_f32_16x16x32_bf16 v[112:115], v[228:231], v[164:167], v[112:115]
    v_mfma_f32_16x16x32_bf16 v[116:119], v[164:167], v[164:167], v[116:119]
    s_waitcnt vmcnt(4) lgkmcnt(0)
    s_barrier
    v_mfma_f32_16x16x32_bf16 v[32:35], v[148:151], v[128:131], v[32:35]
    s_add_u32 m0, s40, 30720
    s_nop 0
    buffer_load_dwordx4 v12, s[16:19], s48 offen lds
    v_mfma_f32_16x16x32_bf16 v[48:51], v[148:151], v[132:135], v[48:51]
    ds_read_b128 v[164:167], v213 offset:36864
    v_mfma_f32_16x16x32_bf16 v[64:67], v[148:151], v[136:139], v[64:67]
    ds_read_b128 v[168:171], v214 offset:36864
    v_mfma_f32_16x16x32_bf16 v[80:83], v[148:151], v[140:143], v[80:83]
    v_mfma_f32_16x16x32_bf16 v[96:99], v[148:151], v[144:147], v[96:99]
    ds_read_b128 v[172:175], v215 offset:36864
    v_mfma_f32_16x16x32_bf16 v[36:39], v[152:155], v[128:131], v[36:39]
    ds_read_b128 v[176:179], v216 offset:36864
    v_mfma_f32_16x16x32_bf16 v[52:55], v[152:155], v[132:135], v[52:55]
    s_cmp_eq_u32 s32, 7
    s_cbranch_scc1 L_a_s1_a0_14
    s_add_u32 m0, s41, 30720
    s_nop 0
    buffer_load_dwordx4 v13, s[16:19], s48 offen lds
L_a_s1_a0_14:
    s_add_u32 s48, s48, 122880
    s_cmp_ge_u32 s32, 6
    s_cbranch_scc1 L_a_s4_a0_14_o
L_a_s4_a0_14:
    s_add_u32 m0, s42, 18432
    s_nop 0
    buffer_load_dwordx4 v10, s[28:31], s47 offen lds
    ds_read_b128 v[180:183], v217 offset:36864
    v_mfma_f32_16x16x32_bf16 v[68:71], v[152:155], v[136:139], v[68:71]
    v_mfma_f32_16x16x32_bf16 v[84:87], v[152:155], v[140:143], v[84:87]
    ds_read_b64_tr_b16 v[184:185], v220 offset:46080
    v_mfma_f32_16x16x32_bf16 v[100:103], v[152:155], v[144:147], v[100:103]
    ds_read_b64_tr_b16 v[186:187], v220 offset:49920
    v_mfma_f32_16x16x32_bf16 v[40:43], v[156:159], v[128:131], v[40:43]
    v_mfma_f32_16x16x32_bf16 v[56:59], v[156:159], v[132:135], v[56:59]
    s_add_u32 m0, s42, 26624
    s_nop 0
    buffer_load_dwordx4 v11, s[28:31], s47 offen lds
    ds_read_b64_tr_b16 v[188:189], v221 offset:46080
    v_mfma_f32_16x16x32_bf16 v[72:75], v[156:159], v[136:139], v[72:75]
    ds_read_b64_tr_b16 v[190:191], v221 offset:49920
    v_mfma_f32_16x16x32_bf16 v[88:91], v[156:159], v[140:143], v[88:91]
    ds_read_b64_tr_b16 v[192:193], v222 offset:46080
    v_mfma_f32_16x16x32_bf16 v[104:107], v[156:159], v[144:147], v[104:107]
    v_mfma_f32_16x16x32_bf16 v[44:47], v[160:163], v[128:131], v[44:47]
    ds_read_b64_tr_b16 v[194:195], v222 offset:49920
    v_mfma_f32_16x16x32_bf16 v[60:63], v[160:163], v[132:135], v[60:63]
    ds_read_b64_tr_b16 v[196:197], v223 offset:46080
    v_mfma_f32_16x16x32_bf16 v[76:79], v[160:163], v[136:139], v[76:79]
    s_add_u32 s47, s47, 128
    ds_read_b64_tr_b16 v[198:199], v223 offset:49920
    v_mfma_f32_16x16x32_bf16 v[92:95], v[160:163], v[140:143], v[92:95]
    v_mfma_f32_16x16x32_bf16 v[108:111], v[160:163], v[144:147], v[108:111]
    v_mfma_f32_16x16x32_bf16 v[232:235], v[148:151], v[228:231], v[232:235]
    v_mfma_f32_16x16x32_bf16 v[236:239], v[152:155], v[228:231], v[236:239]
    v_mfma_f32_16x16x32_bf16 v[112:115], v[228:231], v[128:131], v[112:115]
    v_mfma_f32_16x16x32_bf16 v[116:119], v[128:131], v[128:131], v[116:119]
    s_waitcnt vmcnt(4) lgkmcnt(0)
    s_barrier
    v_mfma_f32_16x16x32_bf16 v[32:35], v[184:187], v[164:167], v[32:35]
    s_add_u32 m0, s40, 46080
    s_nop 0
    buffer_load_dwordx4 v12, s[16:19], s48 offen lds
    v_mfma_f32_16x16x32_bf16 v[48:51], v[184:187], v[168:171], v[48:51]
    ds_read_b128 v[128:131], v208 offset:0
    v_mfma_f32_16x16x32_bf16 v[64:67], v[184:187], v[172:175], v[64:67]
    ds_read_b128 v[132:135], v209 offset:0
    v_mfma_f32_16x16x32_bf16 v[80:83], v[184:187], v[176:179], v[80:83]
    v_mfma_f32_16x16x32_bf16 v[96:99], v[184:187], v[180:183], v[96:99]
    ds_read_b128 v[136:139], v210 offset:0
    v_mfma_f32_16x16x32_bf16 v[36:39], v[188:191], v[164:167], v[36:39]
    ds_read_b128 v[140:143], v211 offset:0
    v_mfma_f32_16x16x32_bf16 v[52:55], v[188:191], v[168:171], v[52:55]
    ds_read_b128 v[144:147], v212 offset:0
    v_mfma_f32_16x16x32_bf16 v[68:71], v[188:191], v[172:175], v[68:71]
    v_mfma_f32_16x16x32_bf16 v[84:87], v[188:191], v[176:179], v[84:87]
    ds_read_b64_tr_b16 v[148:149], v220 offset:0
    v_mfma_f32_16x16x32_bf16 v[100:103], v[188:191], v[180:183], v[100:103]
    ds_read_b64_tr_b16 v[150:151], v220 offset:3840
    v_mfma_f32_16x16x32_bf16 v[40:43], v[192:195], v[164:167], v[40:43]
    v_mfma_f32_16x16x32_bf16 v[56:59], v[192:195], v[168:171], v[56:59]
    s_cmp_eq_u32 s32, 7
    s_cbranch_scc1 L_a_s1_a0_15
    s_add_u32 m0, s41, 46080
    s_nop 0
    buffer_load_dwordx4 v13, s[16:19], s48 offen lds
L_a_s1_a0_15:
    s_add_u32 s48, s48, 122880
    ds_read_b64_tr_b16 v[152:153], v221 offset:0
    v_mfma_f32_16x16x32_bf16 v[72:75], v[192:195], v[172:175], v[72:75]
    ds_read_b64_tr_b16 v[154:155], v221 offset:3840
    v_mfma_f32_16x16x32_bf16 v[88:91], v[192:195], v[176:179], v[88:91]
    ds_read_b64_tr_b16 v[156:157], v222 offset:0
    v_mfma_f32_16x16x32_bf16 v[104:107], v[192:195], v[180:183], v[104:107]
    v_mfma_f32_16x16x32_bf16 v[44:47], v[196:199], v[164:167], v[44:47]
    ds_read_b64_tr_b16 v[158:159], v222 offset:3840
    v_mfma_f32_16x16x32_bf16 v[60:63], v[196:199], v[168:171], v[60:63]
    ds_read_b64_tr_b16 v[160:161], v223 offset:0
    v_mfma_f32_16x16x32_bf16 v[76:79], v[196:199], v[172:175], v[76:79]
    ds_read_b64_tr_b16 v[162:163], v223 offset:3840
    v_mfma_f32_16x16x32_bf16 v[92:95], v[196:199], v[176:179], v[92:95]
    v_mfma_f32_16x16x32_bf16 v[108:111], v[196:199], v[180:183], v[108:111]
    v_mfma_f32_16x16x32_bf16 v[232:235], v[184:187], v[228:231], v[232:235]
    v_mfma_f32_16x16x32_bf16 v[236:239], v[188:191], v[228:231], v[236:239]
    v_mfma_f32_16x16x32_bf16 v[112:115], v[228:231], v[164:167], v[112:115]
    v_mfma_f32_16x16x32_bf16 v[116:119], v[164:167], v[164:167], v[116:119]
    s_waitcnt vmcnt(4) lgkmcnt(0)
    s_barrier
    v_mfma_f32_16x16x32_bf16 v[32:35], v[148:151], v[128:131], v[32:35]
    s_add_u32 m0, s40, 0
    s_nop 0
    buffer_load_dwordx4 v12, s[16:19], s48 offen lds
    v_mfma_f32_16x16x32_bf16 v[48:51], v[148:151], v[132:135], v[48:51]
    ds_read_b128 v[164:167], v213 offset:0
    v_mfma_f32_16x16x32_bf16 v[64:67], v[148:151], v[136:139], v[64:67]
    ds_read_b128 v[168:171], v214 offset:0
    v_mfma_f32_16x16x32_bf16 v[80:83], v[148:151], v[140:143], v[80:83]
    v_mfma_f32_16x16x32_bf16 v[96:99], v[148:151], v[144:147], v[96:99]
    ds_read_b128 v[172:175], v215 offset:0
    v_mfma_f32_16x16x32_bf16 v[36:39], v[152:155], v[128:131], v[36:39]
    ds_read_b128 v[176:179], v216 offset:0
    v_mfma_f32_16x16x32_bf16 v[52:55], v[152:155], v[132:135], v[52:55]
    s_cmp_eq_u32 s32, 7
    s_cbranch_scc1 L_a_s1_a0_16
    s_add_u32 m0, s41, 0
    s_nop 0
    buffer_load_dwordx4 v13, s[16:19], s48 offen lds
L_a_s1_a0_16:
    s_add_u32 s48, s48, 122880
    s_cmp_ge_u32 s32, 6
    s_cbranch_scc1 L_a_s4_a0_16_o
L_a_s4_a0_16:
    s_add_u32 m0, s42, 36864
    s_nop 0
    buffer_load_dwordx4 v10, s[28:31], s47 offen lds
    ds_read_b128 v[180:183], v217 offset:0
    v_mfma_f32_16x16x32_bf16 v[68:71], v[152:155], v[136:139], v[68:71]
    v_mfma_f32_16x16x32_bf16 v[84:87], v[152:155], v[140:143], v[84:87]
    ds_read_b64_tr_b16 v[184:185], v220 offset:15360
    v_mfma_f32_16x16x32_bf16 v[100:103], v[152:155], v[144:147], v[100:103]
    ds_read_b64_tr_b16 v[186:187], v220 offset:19200
    v_mfma_f32_16x16x32_bf16 v[40:43], v[156:159], v[128:131], v[40:43]
    v_mfma_f32_16x16x32_bf16 v[56:59], v[156:159], v[132:135], v[56:59]
    s_add_u32 m0, s42, 45056
    s_nop 0
    buffer_load_dwordx4 v11, s[28:31], s47 offen lds
    ds_read_b64_tr_b16 v[188:189], v221 offset:15360
    v_mfma_f32_16x16x32_bf16 v[72:75], v[156:159], v[136:139], v[72:75]
    ds_read_b64_tr_b16 v[190:191], v221 offset:19200
    v_mfma_f32_16x16x32_bf16 v[88:91], v[156:159], v[140:143], v[88:91]
    ds_read_b64_tr_b16 v[192:193], v222 offset:15360
    v_mfma_f32_16x16x32_bf16 v[104:107], v[156:159], v[144:147], v[104:107]
    v_mfma_f32_16x16x32_bf16 v[44:47], v[160:163], v[128:131], v[44:47]
    ds_read_b64_tr_b16 v[194:195], v222 offset:19200
    v_mfma_f32_16x16x32_bf16 v[60:63], v[160:163], v[132:135], v[60:63]
    ds_read_b64_tr_b16 v[196:197], v223 offset:15360
    v_mfma_f32_16x16x32_bf16 v[76:79], v[160:163], v[136:139], v[76:79]
    s_add_u32 s47, s47, 128
    ds_read_b64_tr_b16 v[198:199], v223 offset:19200
    v_mfma_f32_16x16x32_bf16 v[92:95], v[160:163], v[140:143], v[92:95]
    v_mfma_f32_16x16x32_bf16 v[108:111], v[160:163], v[144:147], v[108:111]
    v_mfma_f32_16x16x32_bf16 v[232:235], v[148:151], v[228:231], v[232:235]
    v_mfma_f32_16x16x32_bf16 v[236:239], v[152:155], v[228:231], v[236:239]
    v_mfma_f32_16x16x32_bf16 v[112:115], v[228:231], v[128:131], v[112:115]
    v_mfma_f32_16x16x32_bf16 v[116:119], v[128:131], v[128:131], v[116:119]
    s_waitcnt vmcnt(4) lgkmcnt(0)
    s_barrier
    v_mfma_f32_16x16x32_bf16 v[32:35], v[184:187], v[164:167], v[32:35]
    s_add_u32 m0, s40, 15360
    s_nop 0
    buffer_load_dwordx4 v12, s[16:19], s48 offen lds
    v_mfma_f32_16x16x32_bf16 v[48:51], v[184:187], v[168:171], v[48:51]
    ds_read_b128 v[128:131], v208 offset:18432
    v_mfma_f32_16x16x32_bf16 v[64:67], v[184:187], v[172:175], v[64:67]
    ds_read_b128 v[132:135], v209 offset:18432
    v_mfma_f32_16x16x32_bf16 v[80:83], v[184:187], v[176:179], v[80:83]
    v_mfma_f32_16x16x32_bf16 v[96:99], v[184:187], v[180:183], v[96:99]
    ds_read_b128 v[136:139], v210 offset:18432
    v_mfma_f32_16x16x32_bf16 v[36:39], v[188:191], v[164:167], v[36:39]
    ds_read_b128 v[140:143], v211 offset:18432
    v_mfma_f32_16x16x32_bf16 v[52:55], v[188:191], v[168:171], v[52:55]
    ds_read_b128 v[144:147], v212 offset:18432
    v_mfma_f32_16x16x32_bf16 v[68:71], v[188:191], v[172:175], v[68:71]
    v_mfma_f32_16x16x32_bf16 v[84:87], v[188:191], v[176:179], v[84:87]
    ds_read_b64_tr_b16 v[148:149], v220 offset:30720
    v_mfma_f32_16x16x32_bf16 v[100:103], v[188:191], v[180:183], v[100:103]
    ds_read_b64_tr_b16 v[150:151], v220 offset:34560
    v_mfma_f32_16x16x32_bf16 v[40:43], v[192:195], v[164:167], v[40:43]
    v_mfma_f32_16x16x32_bf16 v[56:59], v[192:195], v[168:171], v[56:59]
    s_cmp_eq_u32 s32, 7
    s_cbranch_scc1 L_a_s1_a0_17
    s_add_u32 m0, s41, 15360
    s_nop 0
    buffer_load_dwordx4 v13, s[16:19], s48 offen lds
L_a_s1_a0_17:
    s_add_u32 s48, s48, 122880
    ds_read_b64_tr_b16 v[152:153], v221 offset:30720
    v_mfma_f32_16x16x32_bf16 v[72:75], v[192:195], v[172:175], v[72:75]
    ds_read_b64_tr_b16 v[154:155], v221 offset:34560
    v_mfma_f32_16x16x32_bf16 v[88:91], v[192:195], v[176:179], v[88:91]
    ds_read_b64_tr_b16 v[156:157], v222 offset:30720
    v_mfma_f32_16x16x32_bf16 v[104:107], v[192:195], v[180:183], v[104:107]
    v_mfma_f32_16x16x32_bf16 v[44:47], v[196:199], v[164:167], v[44:47]
    ds_read_b64_tr_b16 v[158:159], v222 offset:34560
    v_mfma_f32_16x16x32_bf16 v[60:63], v[196:199], v[168:171], v[60:63]
    ds_read_b64_tr_b16 v[160:161], v223 offset:30720
    v_mfma_f32_16x16x32_bf16 v[76:79], v[196:199], v[172:175], v[76:79]
    ds_read_b64_tr_b16 v[162:163], v223 offset:34560
    v_mfma_f32_16x16x32_bf16 v[92:95], v[196:199], v[176:179], v[92:95]
    v_mfma_f32_16x16x32_bf16 v[108:111], v[196:199], v[180:183], v[108:111]
    v_mfma_f32_16x16x32_bf16 v[232:235], v[184:187], v[228:231], v[232:235]
    v_mfma_f32_16x16x32_bf16 v[236:239], v[188:191], v[228:231], v[236:239]
    v_mfma_f32_16x16x32_bf16 v[112:115], v[228:231], v[164:167], v[112:115]
    v_mfma_f32_16x16x32_bf16 v[116:119], v[164:167], v[164:167], v[116:119]
    s_waitcnt vmcnt(4) lgkmcnt(0)
    s_barrier
    v_mfma_f32_16x16x32_bf16 v[32:35], v[148:151], v[128:131], v[32:35]
    s_add_u32 m0, s40, 30720
    s_nop 0
    buffer_load_dwordx4 v12, s[16:19], s48 offen lds
    v_mfma_f32_16x16x32_bf16 v[48:51], v[148:151], v[132:135], v[48:51]
    ds_read_b128 v[164:167], v213 offset:18432
    v_mfma_f32_16x16x32_bf16 v[64:67], v[148:151], v[136:139], v[64:67]
    ds_read_b128 v[168:171], v214 offset:18432
    v_mfma_f32_16x16x32_bf16 v[80:83], v[148:151], v[140:143], v[80:83]
    v_mfma_f32_16x16x32_bf16 v[96:99], v[148:151], v[144:147], v[96:99]
    ds_read_b128 v[172:175], v215 offset:18432
    v_mfma_f32_16x16x32_bf16 v[36:39], v[152:155], v[128:131], v[36:39]
    ds_read_b128 v[176:179], v216 offset:18432
    v_mfma_f32_16x16x32_bf16 v[52:55], v[152:155], v[132:135], v[52:55]
    s_cmp_eq_u32 s32, 7
    s_cbranch_scc1 L_a_s1_a0_18
    s_add_u32 m0, s41, 30720
    s_nop 0
    buffer_load_dwordx4 v13, s[16:19], s48 offen lds
L_a_s1_a0_18:
    s_add_u32 s48, s48, 122880
    s_cmp_ge_u32 s32, 6
    s_cbranch_scc1 L_a_s4_a0_18_o
L_a_s4_a0_18:
    s_add_u32 m0, s42, 0
    s_nop 0
    buffer_load_dwordx4 v10, s[28:31], s47 offen lds
    ds_read_b128 v[180:183], v217 offset:18432
    v_mfma_f32_16x16x32_bf16 v[68:71], v[152:155], v[136:139], v[68:71]
    v_mfma_f32_16x16x32_bf16 v[84:87], v[152:155], v[140:143], v[84:87]
    ds_read_b64_tr_b16 v[184:185], v220 offset:46080
    v_mfma_f32_16x16x32_bf16 v[100:103], v[152:155], v[144:147], v[100:103]
    ds_read_b64_tr_b16 v[186:187], v220 offset:49920
    v_mfma_f32_16x16x32_bf16 v[40:43], v[156:159], v[128:131], v[40:43]
    v_mfma_f32_16x16x32_bf16 v[56:59], v[156:159], v[132:135], v[56:59]
    s_add_u32 m0, s42, 8192
    s_nop 0
    buffer_load_dwordx4 v11, s[28:31], s47 offen lds
    ds_read_b64_tr_b16 v[188:189], v221 offset:46080
    v_mfma_f32_16x16x32_bf16 v[72:75], v[156:159], v[136:139], v[72:75]
    ds_read_b64_tr_b16 v[190:191], v221 offset:49920
    v_mfma_f32_16x16x32_bf16 v[88:91], v[156:159], v[140:143], v[88:91]
    ds_read_b64_tr_b16 v[192:193], v222 offset:46080
    v_mfma_f32_16x16x32_bf16 v[104:107], v[156:159], v[144:147], v[104:107]
    v_mfma_f32_16x16x32_bf16 v[44:47], v[160:163], v[128:131], v[44:47]
    ds_read_b64_tr_b16 v[194:195], v222 offset:49920
    v_mfma_f32_16x16x32_bf16 v[60:63], v[160:163], v[132:135], v[60:63]
    ds_read_b64_tr_b16 v[196:197], v223 offset:46080
    v_mfma_f32_16x16x32_bf16 v[76:79], v[160:163], v[136:139], v[76:79]
    s_add_u32 s47, s47, 128
    ds_read_b64_tr_b16 v[198:199], v223 offset:49920
    v_mfma_f32_16x16x32_bf16 v[92:95], v[160:163], v[140:143], v[92:95]
    v_mfma_f32_16x16x32_bf16 v[108:111], v[160:163], v[144:147], v[108:111]
    v_mfma_f32_16x16x32_bf16 v[232:235], v[148:151], v[228:231], v[232:235]
    v_mfma_f32_16x16x32_bf16 v[236:239], v[152:155], v[228:231], v[236:239]
    v_mfma_f32_16x16x32_bf16 v[112:115], v[228:231], v[128:131], v[112:115]
    v_mfma_f32_16x16x32_bf16 v[116:119], v[128:131], v[128:131], v[116:119]
    s_waitcnt vmcnt(4) lgkmcnt(0)
    s_barrier
    s_cmp_lt_u32 s58, 680
    s_cbranch_scc0 L_b2_skip2_a0
    v_lshlrev_b32 v1, 7, v9
    v_lshl_add_u32 v1, v4, 3, v1
    v_add_u32 v1, s62, v1
    ds_read_b64_tr_b16 v[244:245], v1 offset:0
    ds_read_b64_tr_b16 v[246:247], v1 offset:1024
    ds_read_b64_tr_b16 v[248:249], v1 offset:32
    ds_read_b64_tr_b16 v[250:251], v1 offset:1056
    ds_read_b64_tr_b16 v[252:253], v1 offset:64
    ds_read_b64_tr_b16 v[254:255], v1 offset:1088
    ds_read_b64_tr_b16 v[20:21], v1 offset:96
    ds_read_b64_tr_b16 v[22:23], v1 offset:1120
    s_waitcnt lgkmcnt(0)
    s_lshl_b32 s61, s60, 2
    s_add_u32 s61, s61, 0
    s_mul_i32 s62, s61, 13108
    s_lshr_b32 s62, s62, 16
    s_mul_i32 s63, s62, 5
    s_sub_u32 s63, s61, s63
    s_mul_i32 s62, s62, 68
    s_add_u32 s62, s62, s59
    s_mul_i32 s62, s62, 5
    s_add_u32 s62, s62, s63
    s_lshl_b32 s62, s62, 10
    s_add_u32 s62, s62, 9437184
    buffer_store_dwordx4 v[244:247], v5, s[12:15], s62 offen sc0 sc1
    s_lshl_b32 s61, s60, 2
    s_add_u32 s61, s61, 1
    s_mul_i32 s62, s61, 13108
    s_lshr_b32 s62, s62, 16
    s_mul_i32 s63, s62, 5
    s_sub_u32 s63, s61, s63
    s_mul_i32 s62, s62, 68
    s_add_u32 s62, s62, s59
    s_mul_i32 s62, s62, 5
    s_add_u32 s62, s62, s63
    s_lshl_b32 s62, s62, 10
    s_add_u32 s62, s62, 9437184
    buffer_store_dwordx4 v[248:251], v5, s[12:15], s62 offen sc0 sc1
    s_lshl_b32 s61, s60, 2
    s_add_u32 s61, s61, 2
    s_mul_i32 s62, s61, 13108
    s_lshr_b32 s62, s62, 16
    s_mul_i32 s63, s62, 5
    s_sub_u32 s63, s61, s63
    s_mul_i32 s62, s62, 68
    s_add_u32 s62, s62, s59
    s_mul_i32 s62, s62, 5
    s_add_u32 s62, s62, s63
    s_lshl_b32 s62, s62, 10
    s_add_u32 s62, s62, 9437184
    buffer_store_dwordx4 v[252:255], v5, s[12:15], s62 offen sc0 sc1
    s_lshl_b32 s61, s60, 2
    s_add_u32 s61, s61, 3
    s_mul_i32 s62, s61, 13108
    s_lshr_b32 s62, s62, 16
    s_mul_i32 s63, s62, 5
    s_sub_u32 s63, s61, s63
    s_mul_i32 s62, s62, 68
    s_add_u32 s62, s62, s59
    s_mul_i32 s62, s62, 5
    s_add_u32 s62, s62, s63
    s_lshl_b32 s62, s62, 10
    s_add_u32 s62, s62, 9437184
    buffer_store_dwordx4 v[20:23], v5, s[12:15], s62 offen sc0 sc1
    s_nop 4
L_b2_skip2_a0:
    v_mfma_f32_16x16x32_bf16 v[32:35], v[184:187], v[164:167], v[32:35]
    s_add_u32 m0, s40, 46080
    s_nop 0
    buffer_load_dwordx4 v12, s[16:19], s48 offen lds
    v_mfma_f32_16x16x32_bf16 v[48:51], v[184:187], v[168:171], v[48:51]
    ds_read_b128 v[128:131], v208 offset:36864
    v_mfma_f32_16x16x32_bf16 v[64:67], v[184:187], v[172:175], v[64:67]
    ds_read_b128 v[132:135], v209 offset:36864
    v_mfma_f32_16x16x32_bf16 v[80:83], v[184:187], v[176:179], v[80:83]
    v_mfma_f32_16x16x32_bf16 v[96:99], v[184:187], v[180:183], v[96:99]
    ds_read_b128 v[136:139], v210 offset:36864
    v_mfma_f32_16x16x32_bf16 v[36:39], v[188:191], v[164:167], v[36:39]
    ds_read_b128 v[140:143], v211 offset:36864
    v_mfma_f32_16x16x32_bf16 v[52:55], v[188:191], v[168:171], v[52:55]
    ds_read_b128 v[144:147], v212 offset:36864
    v_mfma_f32_16x16x32_bf16 v[68:71], v[188:191], v[172:175], v[68:71]
    v_mfma_f32_16x16x32_bf16 v[84:87], v[188:191], v[176:179], v[84:87]
    ds_read_b64_tr_b16 v[148:149], v220 offset:0
    v_mfma_f32_16x16x32_bf16 v[100:103], v[188:191], v[180:183], v[100:103]
    ds_read_b64_tr_b16 v[150:151], v220 offset:3840
    v_mfma_f32_16x16x32_bf16 v[40:43], v[192:195], v[164:167], v[40:43]
    v_mfma_f32_16x16x32_bf16 v[56:59], v[192:195], v[168:171], v[56:59]
    s_cmp_eq_u32 s32, 7
    s_cbranch_scc1 L_a_s1_a0_19
    s_add_u32 m0, s41, 46080
    s_nop 0
    buffer_load_dwordx4 v13, s[16:19], s48 offen lds
L_a_s1_a0_19:
    s_add_u32 s48, s48, 122880
    ds_read_b64_tr_b16 v[152:153], v221 offset:0
    v_mfma_f32_16x16x32_bf16 v[72:75], v[192:195], v[172:175], v[72:75]
    ds_read_b64_tr_b16 v[154:155], v221 offset:3840
    v_mfma_f32_16x16x32_bf16 v[88:91], v[192:195], v[176:179], v[88:91]
    ds_read_b64_tr_b16 v[156:157], v222 offset:0
    v_mfma_f32_16x16x32_bf16 v[104:107], v[192:195], v[180:183], v[104:107]
    v_mfma_f32_16x16x32_bf16 v[44:47], v[196:199], v[164:167], v[44:47]
    ds_read_b64_tr_b16 v[158:159], v222 offset:3840
    v_mfma_f32_16x16x32_bf16 v[60:63], v[196:199], v[168:171], v[60:63]
    ds_read_b64_tr_b16 v[160:161], v223 offset:0
    v_mfma_f32_16x16x32_bf16 v[76:79], v[196:199], v[172:175], v[76:79]
    ds_read_b64_tr_b16 v[162:163], v223 offset:3840
    v_mfma_f32_16x16x32_bf16 v[92:95], v[196:199], v[176:179], v[92:95]
    v_mfma_f32_16x16x32_bf16 v[108:111], v[196:199], v[180:183], v[108:111]
    v_mfma_f32_16x16x32_bf16 v[232:235], v[184:187], v[228:231], v[232:235]
    v_mfma_f32_16x16x32_bf16 v[236:239], v[188:191], v[228:231], v[236:239]
    v_mfma_f32_16x16x32_bf16 v[112:115], v[228:231], v[164:167], v[112:115]
    v_mfma_f32_16x16x32_bf16 v[116:119], v[164:167], v[164:167], v[116:119]
    s_waitcnt vmcnt(4) lgkmcnt(0)
    s_barrier
    v_mfma_f32_16x16x32_bf16 v[32:35], v[148:151], v[128:131], v[32:35]
    v_mfma_f32_16x16x32_bf16 v[48:51], v[148:151], v[132:135], v[48:51]
    ds_read_b128 v[164:167], v213 offset:36864
    v_mfma_f32_16x16x32_bf16 v[64:67], v[148:151], v[136:139], v[64:67]
    ds_read_b128 v[168:171], v214 offset:36864
    v_mfma_f32_16x16x32_bf16 v[80:83], v[148:151], v[140:143], v[80:83]
    v_mfma_f32_16x16x32_bf16 v[96:99], v[148:151], v[144:147], v[96:99]
    ds_read_b128 v[172:175], v215 offset:36864
    v_mfma_f32_16x16x32_bf16 v[36:39], v[152:155], v[128:131], v[36:39]
    ds_read_b128 v[176:179], v216 offset:36864
    v_mfma_f32_16x16x32_bf16 v[52:55], v[152:155], v[132:135], v[52:55]
    ds_read_b128 v[180:183], v217 offset:36864
    v_mfma_f32_16x16x32_bf16 v[68:71], v[152:155], v[136:139], v[68:71]
    v_mfma_f32_16x16x32_bf16 v[84:87], v[152:155], v[140:143], v[84:87]
    ds_read_b64_tr_b16 v[184:185], v220 offset:15360
    v_mfma_f32_16x16x32_bf16 v[100:103], v[152:155], v[144:147], v[100:103]
    ds_read_b64_tr_b16 v[186:187], v220 offset:19200
    v_mfma_f32_16x16x32_bf16 v[40:43], v[156:159], v[128:131], v[40:43]
    v_mfma_f32_16x16x32_bf16 v[56:59], v[156:159], v[132:135], v[56:59]
    ds_read_b64_tr_b16 v[188:189], v221 offset:15360
    v_mfma_f32_16x16x32_bf16 v[72:75], v[156:159], v[136:139], v[72:75]
    ds_read_b64_tr_b16 v[190:191], v221 offset:19200
    v_mfma_f32_16x16x32_bf16 v[88:91], v[156:159], v[140:143], v[88:91]
    ds_read_b64_tr_b16 v[192:193], v222 offset:15360
    v_mfma_f32_16x16x32_bf16 v[104:107], v[156:159], v[144:147], v[104:107]
    v_mfma_f32_16x16x32_bf16 v[44:47], v[160:163], v[128:131], v[44:47]
    ds_read_b64_tr_b16 v[194:195], v222 offset:19200
    v_mfma_f32_16x16x32_bf16 v[60:63], v[160:163], v[132:135], v[60:63]
    ds_read_b64_tr_b16 v[196:197], v223 offset:15360
    v_mfma_f32_16x16x32_bf16 v[76:79], v[160:163], v[136:139], v[76:79]
    ds_read_b64_tr_b16 v[198:199], v223 offset:19200
    v_mfma_f32_16x16x32_bf16 v[92:95], v[160:163], v[140:143], v[92:95]
    v_mfma_f32_16x16x32_bf16 v[108:111], v[160:163], v[144:147], v[108:111]
    v_mfma_f32_16x16x32_bf16 v[232:235], v[148:151], v[228:231], v[232:235]
    v_mfma_f32_16x16x32_bf16 v[236:239], v[152:155], v[228:231], v[236:239]
    v_mfma_f32_16x16x32_bf16 v[112:115], v[228:231], v[128:131], v[112:115]
    v_mfma_f32_16x16x32_bf16 v[116:119], v[128:131], v[128:131], v[116:119]
    s_waitcnt vmcnt(1) lgkmcnt(0)
    s_barrier
    v_mfma_f32_16x16x32_bf16 v[32:35], v[184:187], v[164:167], v[32:35]
    v_mfma_f32_16x16x32_bf16 v[48:51], v[184:187], v[168:171], v[48:51]
    ds_read_b128 v[128:131], v208 offset:0
    v_mfma_f32_16x16x32_bf16 v[64:67], v[184:187], v[172:175], v[64:67]
    ds_read_b128 v[132:135], v209 offset:0
    v_mfma_f32_16x16x32_bf16 v[80:83], v[184:187], v[176:179], v[80:83]
    v_mfma_f32_16x16x32_bf16 v[96:99], v[184:187], v[180:183], v[96:99]
    ds_read_b128 v[136:139], v210 offset:0
    v_mfma_f32_16x16x32_bf16 v[36:39], v[188:191], v[164:167], v[36:39]
    ds_read_b128 v[140:143], v211 offset:0
    v_mfma_f32_16x16x32_bf16 v[52:55], v[188:191], v[168:171], v[52:55]
    ds_read_b128 v[144:147], v212 offset:0
    v_mfma_f32_16x16x32_bf16 v[68:71], v[188:191], v[172:175], v[68:71]
    v_mfma_f32_16x16x32_bf16 v[84:87], v[188:191], v[176:179], v[84:87]
    ds_read_b64_tr_b16 v[148:149], v220 offset:30720
    v_mfma_f32_16x16x32_bf16 v[100:103], v[188:191], v[180:183], v[100:103]
    ds_read_b64_tr_b16 v[150:151], v220 offset:34560
    v_mfma_f32_16x16x32_bf16 v[40:43], v[192:195], v[164:167], v[40:43]
    v_mfma_f32_16x16x32_bf16 v[56:59], v[192:195], v[168:171], v[56:59]
    ds_read_b64_tr_b16 v[152:153], v221 offset:30720
    v_mfma_f32_16x16x32_bf16 v[72:75], v[192:195], v[172:175], v[72:75]
    ds_read_b64_tr_b16 v[154:155], v221 offset:34560
    v_mfma_f32_16x16x32_bf16 v[88:91], v[192:195], v[176:179], v[88:91]
    ds_read_b64_tr_b16 v[156:157], v222 offset:30720
    v_mfma_f32_16x16x32_bf16 v[104:107], v[192:195], v[180:183], v[104:107]
    v_mfma_f32_16x16x32_bf16 v[44:47], v[196:199], v[164:167], v[44:47]
    ds_read_b64_tr_b16 v[158:159], v222 offset:34560
    v_mfma_f32_16x16x32_bf16 v[60:63], v[196:199], v[168:171], v[60:63]
    ds_read_b64_tr_b16 v[160:161], v223 offset:30720
    v_mfma_f32_16x16x32_bf16 v[76:79], v[196:199], v[172:175], v[76:79]
    ds_read_b64_tr_b16 v[162:163], v223 offset:34560
    v_mfma_f32_16x16x32_bf16 v[92:95], v[196:199], v[176:179], v[92:95]
    v_mfma_f32_16x16x32_bf16 v[108:111], v[196:199], v[180:183], v[108:111]
    v_mfma_f32_16x16x32_bf16 v[232:235], v[184:187], v[228:231], v[232:235]
    v_mfma_f32_16x16x32_bf16 v[236:239], v[188:191], v[228:231], v[236:239]
    v_mfma_f32_16x16x32_bf16 v[112:115], v[228:231], v[164:167], v[112:115]
    v_mfma_f32_16x16x32_bf16 v[116:119], v[164:167], v[164:167], v[116:119]
    s_waitcnt vmcnt(0) lgkmcnt(0)
    s_barrier
    v_mfma_f32_16x16x32_bf16 v[32:35], v[148:151], v[128:131], v[32:35]
    v_mfma_f32_16x16x32_bf16 v[48:51], v[148:151], v[132:135], v[48:51]
    ds_read_b128 v[164:167], v213 offset:0
    v_mfma_f32_16x16x32_bf16 v[64:67], v[148:151], v[136:139], v[64:67]
    ds_read_b128 v[168:171], v214 offset:0
    v_mfma_f32_16x16x32_bf16 v[80:83], v[148:151], v[140:143], v[80:83]
    v_mfma_f32_16x16x32_bf16 v[96:99], v[148:151], v[144:147], v[96:99]
    ds_read_b128 v[172:175], v215 offset:0
    v_mfma_f32_16x16x32_bf16 v[36:39], v[152:155], v[128:131], v[36:39]
    ds_read_b128 v[176:179], v216 offset:0
    v_mfma_f32_16x16x32_bf16 v[52:55], v[152:155], v[132:135], v[52:55]
    ds_read_b128 v[180:183], v217 offset:0
    v_mfma_f32_16x16x32_bf16 v[68:71], v[152:155], v[136:139], v[68:71]
    v_mfma_f32_16x16x32_bf16 v[84:87], v[152:155], v[140:143], v[84:87]
    ds_read_b64_tr_b16 v[184:185], v220 offset:46080
    v_mfma_f32_16x16x32_bf16 v[100:103], v[152:155], v[144:147], v[100:103]
    ds_read_b64_tr_b16 v[186:187], v220 offset:49920
    v_mfma_f32_16x16x32_bf16 v[40:43], v[156:159], v[128:131], v[40:43]
    v_mfma_f32_16x16x32_bf16 v[56:59], v[156:159], v[132:135], v[56:59]
    ds_read_b64_tr_b16 v[188:189], v221 offset:46080
    v_mfma_f32_16x16x32_bf16 v[72:75], v[156:159], v[136:139], v[72:75]
    ds_read_b64_tr_b16 v[190:191], v221 offset:49920
    v_mfma_f32_16x16x32_bf16 v[88:91], v[156:159], v[140:143], v[88:91]
    ds_read_b64_tr_b16 v[192:193], v222 offset:46080
    v_mfma_f32_16x16x32_bf16 v[104:107], v[156:159], v[144:147], v[104:107]
    v_mfma_f32_16x16x32_bf16 v[44:47], v[160:163], v[128:131], v[44:47]
    ds_read_b64_tr_b16 v[194:195], v222 offset:49920
    v_mfma_f32_16x16x32_bf16 v[60:63], v[160:163], v[132:135], v[60:63]
    ds_read_b64_tr_b16 v[196:197], v223 offset:46080
    v_mfma_f32_16x16x32_bf16 v[76:79], v[160:163], v[136:139], v[76:79]
    ds_read_b64_tr_b16 v[198:199], v223 offset:49920
    v_mfma_f32_16x16x32_bf16 v[92:95], v[160:163], v[140:143], v[92:95]
    v_mfma_f32_16x16x32_bf16 v[108:111], v[160:163], v[144:147], v[108:111]
    v_mfma_f32_16x16x32_bf16 v[232:235], v[148:151], v[228:231], v[232:235]
    v_mfma_f32_16x16x32_bf16 v[236:239], v[152:155], v[228:231], v[236:239]
    v_mfma_f32_16x16x32_bf16 v[112:115], v[228:231], v[128:131], v[112:115]
    v_mfma_f32_16x16x32_bf16 v[116:119], v[128:131], v[128:131], v[116:119]
    s_waitcnt lgkmcnt(0)
    v_mfma_f32_16x16x32_bf16 v[32:35], v[184:187], v[164:167], v[32:35]
    v_mfma_f32_16x16x32_bf16 v[48:51], v[184:187], v[168:171], v[48:51]
    v_mfma_f32_16x16x32_bf16 v[64:67], v[184:187], v[172:175], v[64:67]
    v_mfma_f32_16x16x32_bf16 v[80:83], v[184:187], v[176:179], v[80:83]
    v_mfma_f32_16x16x32_bf16 v[96:99], v[184:187], v[180:183], v[96:99]
    v_mfma_f32_16x16x32_bf16 v[36:39], v[188:191], v[164:167], v[36:39]
    v_mfma_f32_16x16x32_bf16 v[52:55], v[188:191], v[168:171], v[52:55]
    v_mfma_f32_16x16x32_bf16 v[68:71], v[188:191], v[172:175], v[68:71]
    v_mfma_f32_16x16x32_bf16 v[84:87], v[188:191], v[176:179], v[84:87]
    v_mfma_f32_16x16x32_bf16 v[100:103], v[188:191], v[180:183], v[100:103]
    v_mfma_f32_16x16x32_bf16 v[40:43], v[192:195], v[164:167], v[40:43]
    v_mfma_f32_16x16x32_bf16 v[56:59], v[192:195], v[168:171], v[56:59]
    v_mfma_f32_16x16x32_bf16 v[72:75], v[192:195], v[172:175], v[72:75]
    v_mfma_f32_16x16x32_bf16 v[88:91], v[192:195], v[176:179], v[88:91]
    v_mfma_f32_16x16x32_bf16 v[104:107], v[192:195], v[180:183], v[104:107]
    v_mfma_f32_16x16x32_bf16 v[44:47], v[196:199], v[164:167], v[44:47]
    v_mfma_f32_16x16x32_bf16 v[60:63], v[196:199], v[168:171], v[60:63]
    v_mfma_f32_16x16x32_bf16 v[76:79], v[196:199], v[172:175], v[76:79]
    v_mfma_f32_16x16x32_bf16 v[92:95], v[196:199], v[176:179], v[92:95]
    v_mfma_f32_16x16x32_bf16 v[108:111], v[196:199], v[180:183], v[108:111]
    v_mfma_f32_16x16x32_bf16 v[232:235], v[184:187], v[228:231], v[232:235]
    v_mfma_f32_16x16x32_bf16 v[236:239], v[188:191], v[228:231], v[236:239]
    v_mfma_f32_16x16x32_bf16 v[112:115], v[228:231], v[164:167], v[112:115]
    v_mfma_f32_16x16x32_bf16 v[116:119], v[164:167], v[164:167], v[116:119]
    s_branch L_a_loopend
L_a_loop1:
    s_waitcnt vmcnt(5)
    s_barrier
    ds_read_b128 v[128:131], v208 offset:0
    ds_read_b128 v[132:135], v209 offset:0
    ds_read_b128 v[136:139], v210 offset:0
    ds_read_b128 v[140:143], v211 offset:0
    ds_read_b128 v[144:147], v212 offset:0
    ds_read_b64_tr_b16 v[148:149], v220 offset:0
    ds_read_b64_tr_b16 v[150:151], v220 offset:3840
    ds_read_b64_tr_b16 v[152:153], v221 offset:0
    ds_read_b64_tr_b16 v[154:155], v221 offset:3840
    ds_read_b64_tr_b16 v[156:157], v222 offset:0
    ds_read_b64_tr_b16 v[158:159], v222 offset:3840
    ds_read_b64_tr_b16 v[160:161], v223 offset:0
    ds_read_b64_tr_b16 v[162:163], v223 offset:3840
    s_waitcnt vmcnt(4) lgkmcnt(0)
    s_barrier
    s_mul_i32 s44, s33, 12
    s_add_u32 s44, s44, 128
    v_min_u32 v20, 11, v0
    v_add_u32 v20, s44, v20
    v_mul_u32_u24 v20, 3840, v20
    v_add_u32 v20, s45, v20
    s_mul_i32 s44, s32, 1280
    s_cmp_lt_u32 s32, 3
    s_cbranch_scc0 L_tlb_a0_a1_0
    buffer_load_dword v244, v20, s[16:19], s44 offen
L_tlb_a0_a1_0:
    s_sub_u32 s44, s32, 3
    s_cmp_lt_u32 s44, 3
    s_cbranch_scc0 L_tlb_a1_a1_0
    s_mul_i32 s44, s44, 1280
    buffer_load_dword v244, v20, s[16:19], s44 offen offset:128
L_tlb_a1_a1_0:
    v_mfma_f32_16x16x32_bf16 v[32:35], v[148:151], v[128:131], 0
    s_add_u32 m0, s40, 0
    s_nop 0
    buffer_load_dwordx4 v12, s[16:19], s48 offen lds
    v_mfma_f32_16x16x32_bf16 v[48:51], v[148:151], v[132:135], 0
    ds_read_b128 v[164:167], v213 offset:0
    v_mfma_f32_16x16x32_bf16 v[64:67], v[148:151], v[136:139], 0
    ds_read_b128 v[168:171], v214 offset:0
    v_mfma_f32_16x16x32_bf16 v[80:83], v[148:151], v[140:143], 0
    ds_read_b128 v[172:175], v215 offset:0
    v_mfma_f32_16x16x32_bf16 v[36:39], v[152:155], v[128:131], 0
    ds_read_b128 v[176:179], v216 offset:0
    v_mfma_f32_16x16x32_bf16 v[52:55], v[152:155], v[132:135], 0
    s_cmp_eq_u32 s32, 7
    s_cbranch_scc1 L_a_s1_a1_4
    s_add_u32 m0, s41, 0
    s_nop 0
    buffer_load_dwordx4 v13, s[16:19], s48 offen lds
L_a_s1_a1_4:
    s_add_u32 s48, s48, 122880
    s_cmp_ge_u32 s32, 6
    s_cbranch_scc1 L_a_s4_a1_4_o
L_a_s4_a1_4:
    s_add_u32 m0, s42, 36864
    s_nop 0
    buffer_load_dwordx4 v10, s[28:31], s47 offen lds
    v_mfma_f32_16x16x32_bf16 v[68:71], v[152:155], v[136:139], 0
    ds_read_b128 v[180:183], v217 offset:0
    v_mfma_f32_16x16x32_bf16 v[84:87], v[152:155], v[140:143], 0
    ds_read_b64_tr_b16 v[184:185], v220 offset:15360
    v_mfma_f32_16x16x32_bf16 v[40:43], v[156:159], v[128:131], 0
    ds_read_b64_tr_b16 v[186:187], v220 offset:19200
    v_mfma_f32_16x16x32_bf16 v[56:59], v[156:159], v[132:135], 0
    ds_read_b64_tr_b16 v[188:189], v221 offset:15360
    v_mfma_f32_16x16x32_bf16 v[72:75], v[156:159], v[136:139], 0
    s_add_u32 m0, s42, 45056
    s_nop 0
    buffer_load_dwordx4 v11, s[28:31], s47 offen lds
    v_mfma_f32_16x16x32_bf16 v[88:91], v[156:159], v[140:143], 0
    ds_read_b64_tr_b16 v[190:191], v221 offset:19200
    v_mfma_f32_16x16x32_bf16 v[44:47], v[160:163], v[128:131], 0
    ds_read_b64_tr_b16 v[192:193], v222 offset:15360
    v_mfma_f32_16x16x32_bf16 v[60:63], v[160:163], v[132:135], 0
    ds_read_b64_tr_b16 v[194:195], v222 offset:19200
    v_mfma_f32_16x16x32_bf16 v[76:79], v[160:163], v[136:139], 0
    ds_read_b64_tr_b16 v[196:197], v223 offset:15360
    v_mfma_f32_16x16x32_bf16 v[92:95], v[160:163], v[140:143], 0
    s_add_u32 s47, s47, 128
    ds_read_b64_tr_b16 v[198:199], v223 offset:19200
    v_mfma_f32_16x16x32_bf16 v[232:235], v[148:151], v[228:231], 0
    v_mfma_f32_16x16x32_bf16 v[236:239], v[152:155], v[228:231], 0
    v_mfma_f32_16x16x32_bf16 v[112:115], v[228:231], v[128:131], 0
    v_mfma_f32_16x16x32_bf16 v[116:119], v[128:131], v[128:131], 0
    v_mfma_f32_16x16x32_bf16 v[120:123], v[228:231], v[144:147], 0
    v_mfma_f32_16x16x32_bf16 v[124:127], v[144:147], v[144:147], 0
    s_waitcnt vmcnt(4) lgkmcnt(0)
    s_barrier
    v_mfma_f32_16x16x32_bf16 v[32:35], v[184:187], v[164:167], v[32:35]
    s_add_u32 m0, s40, 15360
    s_nop 0
    buffer_load_dwordx4 v12, s[16:19], s48 offen lds
    v_mfma_f32_16x16x32_bf16 v[48:51], v[184:187], v[168:171], v[48:51]
    ds_read_b128 v[128:131], v208 offset:18432
    v_mfma_f32_16x16x32_bf16 v[64:67], v[184:187], v[172:175], v[64:67]
    ds_read_b128 v[132:135], v209 offset:18432
    v_mfma_f32_16x16x32_bf16 v[80:83], v[184:187], v[176:179], v[80:83]
    ds_read_b128 v[136:139], v210 offset:18432
    v_mfma_f32_16x16x32_bf16 v[36:39], v[188:191], v[164:167], v[36:39]
    ds_read_b128 v[140:143], v211 offset:18432
    v_mfma_f32_16x16x32_bf16 v[52:55], v[188:191], v[168:171], v[52:55]
    v_mfma_f32_16x16x32_bf16 v[68:71], v[188:191], v[172:175], v[68:71]
    ds_read_b128 v[144:147], v212 offset:18432
    v_mfma_f32_16x16x32_bf16 v[84:87], v[188:191], v[176:179], v[84:87]
    ds_read_b64_tr_b16 v[148:149], v220 offset:30720
    v_mfma_f32_16x16x32_bf16 v[40:43], v[192:195], v[164:167], v[40:43]
    ds_read_b64_tr_b16 v[150:151], v220 offset:34560
    v_mfma_f32_16x16x32_bf16 v[56:59], v[192:195], v[168:171], v[56:59]
    ds_read_b64_tr_b16 v[152:153], v221 offset:30720
    v_mfma_f32_16x16x32_bf16 v[72:75], v[192:195], v[172:175], v[72:75]
    s_cmp_eq_u32 s32, 7
    s_cbranch_scc1 L_a_s1_a1_5
    s_add_u32 m0, s41, 15360
    s_nop 0
    buffer_load_dwordx4 v13, s[16:19], s48 offen lds
L_a_s1_a1_5:
    s_add_u32 s48, s48, 122880
    v_mfma_f32_16x16x32_bf16 v[88:91], v[192:195], v[176:179], v[88:91]
    ds_read_b64_tr_b16 v[154:155], v221 offset:34560
    v_mfma_f32_16x16x32_bf16 v[44:47], v[196:199], v[164:167], v[44:47]
    ds_read_b64_tr_b16 v[156:157], v222 offset:30720
    v_mfma_f32_16x16x32_bf16 v[60:63], v[196:199], v[168:171], v[60:63]
    ds_read_b64_tr_b16 v[158:159], v222 offset:34560
    v_mfma_f32_16x16x32_bf16 v[76:79], v[196:199], v[172:175], v[76:79]
    ds_read_b64_tr_b16 v[160:161], v223 offset:30720
    v_mfma_f32_16x16x32_bf16 v[92:95], v[196:199], v[176:179], v[92:95]
    ds_read_b64_tr_b16 v[162:163], v223 offset:34560
    v_mfma_f32_16x16x32_bf16 v[232:235], v[184:187], v[228:231], v[232:235]
    v_mfma_f32_16x16x32_bf16 v[236:239], v[188:191], v[228:231], v[236:239]
    v_mfma_f32_16x16x32_bf16 v[112:115], v[228:231], v[164:167], v[112:115]
    v_mfma_f32_16x16x32_bf16 v[116:119], v[164:167], v[164:167], v[116:119]
    v_mfma_f32_16x16x32_bf16 v[120:123], v[228:231], v[180:183], v[120:123]
    v_mfma_f32_16x16x32_bf16 v[124:127], v[180:183], v[180:183], v[124:127]
    s_waitcnt vmcnt(4) lgkmcnt(0)
    s_barrier
    v_mfma_f32_16x16x32_bf16 v[32:35], v[148:151], v[128:131], v[32:35]
    s_add_u32 m0, s40, 30720
    s_nop 0
    buffer_load_dwordx4 v12, s[16:19], s48 offen lds
    v_mfma_f32_16x16x32_bf16 v[48:51], v[148:151], v[132:135], v[48:51]
    ds_read_b128 v[164:167], v213 offset:18432
    v_mfma_f32_16x16x32_bf16 v[64:67], v[148:151], v[136:139], v[64:67]
    ds_read_b128 v[168:171], v214 offset:18432
    v_mfma_f32_16x16x32_bf16 v[80:83], v[148:151], v[140:143], v[80:83]
    ds_read_b128 v[172:175], v215 offset:18432
    v_mfma_f32_16x16x32_bf16 v[36:39], v[152:155], v[128:131], v[36:39]
    ds_read_b128 v[176:179], v216 offset:18432
    v_mfma_f32_16x16x32_bf16 v[52:55], v[152:155], v[132:135], v[52:55]
    s_cmp_eq_u32 s32, 7
    s_cbranch_scc1 L_a_s1_a1_6
    s_add_u32 m0, s41, 30720
    s_nop 0
    buffer_load_dwordx4 v13, s[16:19], s48 offen lds
L_a_s1_a1_6:
    s_add_u32 s48, s48, 122880
    s_cmp_ge_u32 s32, 6
    s_cbranch_scc1 L_a_s4_a1_6_o
L_a_s4_a1_6:
    s_add_u32 m0, s42, 0
    s_nop 0
    buffer_load_dwordx4 v10, s[28:31], s47 offen lds
    v_mfma_f32_16x16x32_bf16 v[68:71], v[152:155], v[136:139], v[68:71]
    ds_read_b128 v[180:183], v217 offset:18432
    v_mfma_f32_16x16x32_bf16 v[84:87], v[152:155], v[140:143], v[84:87]
    ds_read_b64_tr_b16 v[184:185], v220 offset:46080
    v_mfma_f32_16x16x32_bf16 v[40:43], v[156:159], v[128:131], v[40:43]
    ds_read_b64_tr_b16 v[186:187], v220 offset:49920
    v_mfma_f32_16x16x32_bf16 v[56:59], v[156:159], v[132:135], v[56:59]
    ds_read_b64_tr_b16 v[188:189], v221 offset:46080
    v_mfma_f32_16x16x32_bf16 v[72:75], v[156:159], v[136:139], v[72:75]
    s_add_u32 m0, s42, 8192
    s_nop 0
    buffer_load_dwordx4 v11, s[28:31], s47 offen lds
    v_mfma_f32_16x16x32_bf16 v[88:91], v[156:159], v[140:143], v[88:91]
    ds_read_b64_tr_b16 v[190:191], v221 offset:49920
    v_mfma_f32_16x16x32_bf16 v[44:47], v[160:163], v[128:131], v[44:47]
    ds_read_b64_tr_b16 v[192:193], v222 offset:46080
    v_mfma_f32_16x16x32_bf16 v[60:63], v[160:163], v[132:135], v[60:63]
    ds_read_b64_tr_b16 v[194:195], v222 offset:49920
    v_mfma_f32_16x16x32_bf16 v[76:79], v[160:163], v[136:139], v[76:79]
    ds_read_b64_tr_b16 v[196:197], v223 offset:46080
    v_mfma_f32_16x16x32_bf16 v[92:95], v[160:163], v[140:143], v[92:95]
    s_add_u32 s47, s47, 128
    ds_read_b64_tr_b16 v[198:199], v223 offset:49920
    v_mfma_f32_16x16x32_bf16 v[232:235], v[148:151], v[228:231], v[232:235]
    v_mfma_f32_16x16x32_bf16 v[236:239], v[152:155], v[228:231], v[236:239]
    v_mfma_f32_16x16x32_bf16 v[112:115], v[228:231], v[128:131], v[112:115]
    v_mfma_f32_16x16x32_bf16 v[116:119], v[128:131], v[128:131], v[116:119]
    v_mfma_f32_16x16x32_bf16 v[120:123], v[228:231], v[144:147], v[120:123]
    v_mfma_f32_16x16x32_bf16 v[124:127], v[144:147], v[144:147], v[124:127]
    s_waitcnt vmcnt(4) lgkmcnt(0)
    s_barrier
    s_mul_i32 s44, s33, 10
    s_add_u32 s44, s44, 320
    v_min_u32 v20, 9, v0
    v_add_u32 v20, s44, v20
    v_mul_u32_u24 v20, 3840, v20
    v_add_u32 v20, s45, v20
    s_mul_i32 s44, s32, 1280
    s_cmp_lt_u32 s32, 3
    s_cbranch_scc0 L_tlb_a0_a1_1
    buffer_load_dword v244, v20, s[16:19], s44 offen
L_tlb_a0_a1_1:
    s_sub_u32 s44, s32, 3
    s_cmp_lt_u32 s44, 3
    s_cbranch_scc0 L_tlb_a1_a1_1
    s_mul_i32 s44, s44, 1280
    buffer_load_dword v244, v20, s[16:19], s44 offen offset:128
L_tlb_a1_a1_1:
    v_mfma_f32_16x16x32_bf16 v[32:35], v[184:187], v[164:167], v[32:35]
    s_add_u32 m0, s40, 46080
    s_nop 0
    buffer_load_dwordx4 v12, s[16:19], s48 offen lds
    v_mfma_f32_16x16x32_bf16 v[48:51], v[184:187], v[168:171], v[48:51]
    ds_read_b128 v[128:131], v208 offset:36864
    v_mfma_f32_16x16x32_bf16 v[64:67], v[184:187], v[172:175], v[64:67]
    ds_read_b128 v[132:135], v209 offset:36864
    v_mfma_f32_16x16x32_bf16 v[80:83], v[184:187], v[176:179], v[80:83]
    ds_read_b128 v[136:139], v210 offset:36864
    v_mfma_f32_16x16x32_bf16 v[36:39], v[188:191], v[164:167], v[36:39]
    ds_read_b128 v[140:143], v211 offset:36864
    v_mfma_f32_16x16x32_bf16 v[52:55], v[188:191], v[168:171], v[52:55]
    v_mfma_f32_16x16x32_bf16 v[68:71], v[188:191], v[172:175], v[68:71]
    ds_read_b128 v[144:147], v212 offset:36864
    v_mfma_f32_16x16x32_bf16 v[84:87], v[188:191], v[176:179], v[84:87]
    ds_read_b64_tr_b16 v[148:149], v220 offset:0
    v_mfma_f32_16x16x32_bf16 v[40:43], v[192:195], v[164:167], v[40:43]
    ds_read_b64_tr_b16 v[150:151], v220 offset:3840
    v_mfma_f32_16x16x32_bf16 v[56:59], v[192:195], v[168:171], v[56:59]
    ds_read_b64_tr_b16 v[152:153], v221 offset:0
    v_mfma_f32_16x16x32_bf16 v[72:75], v[192:195], v[172:175], v[72:75]
    s_cmp_eq_u32 s32, 7
    s_cbranch_scc1 L_a_s1_a1_7
    s_add_u32 m0, s41, 46080
    s_nop 0
    buffer_load_dwordx4 v13, s[16:19], s48 offen lds
L_a_s1_a1_7:
    s_add_u32 s48, s48, 122880
    v_mfma_f32_16x16x32_bf16 v[88:91], v[192:195], v[176:179], v[88:91]
    ds_read_b64_tr_b16 v[154:155], v221 offset:3840
    v_mfma_f32_16x16x32_bf16 v[44:47], v[196:199], v[164:167], v[44:47]
    ds_read_b64_tr_b16 v[156:157], v222 offset:0
    v_mfma_f32_16x16x32_bf16 v[60:63], v[196:199], v[168:171], v[60:63]
    ds_read_b64_tr_b16 v[158:159], v222 offset:3840
    v_mfma_f32_16x16x32_bf16 v[76:79], v[196:199], v[172:175], v[76:79]
    ds_read_b64_tr_b16 v[160:161], v223 offset:0
    v_mfma_f32_16x16x32_bf16 v[92:95], v[196:199], v[176:179], v[92:95]
    ds_read_b64_tr_b16 v[162:163], v223 offset:3840
    v_mfma_f32_16x16x32_bf16 v[232:235], v[184:187], v[228:231], v[232:235]
    v_mfma_f32_16x16x32_bf16 v[236:239], v[188:191], v[228:231], v[236:239]
    v_mfma_f32_16x16x32_bf16 v[112:115], v[228:231], v[164:167], v[112:115]
    v_mfma_f32_16x16x32_bf16 v[116:119], v[164:167], v[164:167], v[116:119]
    v_mfma_f32_16x16x32_bf16 v[120:123], v[228:231], v[180:183], v[120:123]
    v_mfma_f32_16x16x32_bf16 v[124:127], v[180:183], v[180:183], v[124:127]
    s_waitcnt vmcnt(4) lgkmcnt(0)
    s_barrier
    v_mfma_f32_16x16x32_bf16 v[32:35], v[148:151], v[128:131], v[32:35]
    s_add_u32 m0, s40, 0
    s_nop 0
    buffer_load_dwordx4 v12, s[16:19], s48 offen lds
    v_mfma_f32_16x16x32_bf16 v[48:51], v[148:151], v[132:135], v[48:51]
    ds_read_b128 v[164:167], v213 offset:36864
    v_mfma_f32_16x16x32_bf16 v[64:67], v[148:151], v[136:139], v[64:67]
    ds_read_b128 v[168:171], v214 offset:36864
    v_mfma_f32_16x16x32_bf16 v[80:83], v[148:151], v[140:143], v[80:83]
    ds_read_b128 v[172:175], v215 offset:36864
    v_mfma_f32_16x16x32_bf16 v[36:39], v[152:155], v[128:131], v[36:39]
    ds_read_b128 v[176:179], v216 offset:36864
    v_mfma_f32_16x16x32_bf16 v[52:55], v[152:155], v[132:135], v[52:55]
    s_cmp_eq_u32 s32, 7
    s_cbranch_scc1 L_a_s1_a1_8
    s_add_u32 m0, s41, 0
    s_nop 0
    buffer_load_dwordx4 v13, s[16:19], s48 offen lds
L_a_s1_a1_8:
    s_add_u32 s48, s48, 122880
    s_cmp_ge_u32 s32, 6
    s_cbranch_scc1 L_a_s4_a1_8_o
L_a_s4_a1_8:
    s_add_u32 m0, s42, 18432
    s_nop 0
    buffer_load_dwordx4 v10, s[28:31], s47 offen lds
    v_mfma_f32_16x16x32_bf16 v[68:71], v[152:155], v[136:139], v[68:71]
    ds_read_b128 v[180:183], v217 offset:36864
    v_mfma_f32_16x16x32_bf16 v[84:87], v[152:155], v[140:143], v[84:87]
    ds_read_b64_tr_b16 v[184:185], v220 offset:15360
    v_mfma_f32_16x16x32_bf16 v[40:43], v[156:159], v[128:131], v[40:43]
    ds_read_b64_tr_b16 v[186:187], v220 offset:19200
    v_mfma_f32_16x16x32_bf16 v[56:59], v[156:159], v[132:135], v[56:59]
    ds_read_b64_tr_b16 v[188:189], v221 offset:15360
    v_mfma_f32_16x16x32_bf16 v[72:75], v[156:159], v[136:139], v[72:75]
    s_add_u32 m0, s42, 26624
    s_nop 0
    buffer_load_dwordx4 v11, s[28:31], s47 offen lds
    v_mfma_f32_16x16x32_bf16 v[88:91], v[156:159], v[140:143], v[88:91]
    ds_read_b64_tr_b16 v[190:191], v221 offset:19200
    v_mfma_f32_16x16x32_bf16 v[44:47], v[160:163], v[128:131], v[44:47]
    ds_read_b64_tr_b16 v[192:193], v222 offset:15360
    v_mfma_f32_16x16x32_bf16 v[60:63], v[160:163], v[132:135], v[60:63]
    ds_read_b64_tr_b16 v[194:195], v222 offset:19200
    v_mfma_f32_16x16x32_bf16 v[76:79], v[160:163], v[136:139], v[76:79]
    ds_read_b64_tr_b16 v[196:197], v223 offset:15360
    v_mfma_f32_16x16x32_bf16 v[92:95], v[160:163], v[140:143], v[92:95]
    s_add_u32 s47, s47, 128
    ds_read_b64_tr_b16 v[198:199], v223 offset:19200
    v_mfma_f32_16x16x32_bf16 v[232:235], v[148:151], v[228:231], v[232:235]
    v_mfma_f32_16x16x32_bf16 v[236:239], v[152:155], v[228:231], v[236:239]
    v_mfma_f32_16x16x32_bf16 v[112:115], v[228:231], v[128:131], v[112:115]
    v_mfma_f32_16x16x32_bf16 v[116:119], v[128:131], v[128:131], v[116:119]
    v_mfma_f32_16x16x32_bf16 v[120:123], v[228:231], v[144:147], v[120:123]
    v_mfma_f32_16x16x32_bf16 v[124:127], v[144:147], v[144:147], v[124:127]
    s_waitcnt vmcnt(4) lgkmcnt(0)
    s_barrier
    v_mfma_f32_16x16x32_bf16 v[32:35], v[184:187], v[164:167], v[32:35]
    s_add_u32 m0, s40, 15360
    s_nop 0
    buffer_load_dwordx4 v12, s[16:19], s48 offen lds
    v_mfma_f32_16x16x32_bf16 v[48:51], v[184:187], v[168:171], v[48:51]
    ds_read_b128 v[128:131], v208 offset:0
    v_mfma_f32_16x16x32_bf16 v[64:67], v[184:187], v[172:175], v[64:67]
    ds_read_b128 v[132:135], v209 offset:0
    v_mfma_f32_16x16x32_bf16 v[80:83], v[184:187], v[176:179], v[80:83]
    ds_read_b128 v[136:139], v210 offset:0
    v_mfma_f32_16x16x32_bf16 v[36:39], v[188:191], v[164:167], v[36:39]
    ds_read_b128 v[140:143], v211 offset:0
    v_mfma_f32_16x16x32_bf16 v[52:55], v[188:191], v[168:171], v[52:55]
    v_mfma_f32_16x16x32_bf16 v[68:71], v[188:191], v[172:175], v[68:71]
    ds_read_b128 v[144:147], v212 offset:0
    v_mfma_f32_16x16x32_bf16 v[84:87], v[188:191], v[176:179], v[84:87]
    ds_read_b64_tr_b16 v[148:149], v220 offset:30720
    v_mfma_f32_16x16x32_bf16 v[40:43], v[192:195], v[164:167], v[40:43]
    ds_read_b64_tr_b16 v[150:151], v220 offset:34560
    v_mfma_f32_16x16x32_bf16 v[56:59], v[192:195], v[168:171], v[56:59]
    ds_read_b64_tr_b16 v[152:153], v221 offset:30720
    v_mfma_f32_16x16x32_bf16 v[72:75], v[192:195], v[172:175], v[72:75]
    s_cmp_eq_u32 s32, 7
    s_cbranch_scc1 L_a_s1_a1_9
    s_add_u32 m0, s41, 15360
    s_nop 0
    buffer_load_dwordx4 v13, s[16:19], s48 offen lds
L_a_s1_a1_9:
    s_add_u32 s48, s48, 122880
    v_mfma_f32_16x16x32_bf16 v[88:91], v[192:195], v[176:179], v[88:91]
    ds_read_b64_tr_b16 v[154:155], v221 offset:34560
    v_mfma_f32_16x16x32_bf16 v[44:47], v[196:199], v[164:167], v[44:47]
    ds_read_b64_tr_b16 v[156:157], v222 offset:30720
    v_mfma_f32_16x16x32_bf16 v[60:63], v[196:199], v[168:171], v[60:63]
    ds_read_b64_tr_b16 v[158:159], v222 offset:34560
    v_mfma_f32_16x16x32_bf16 v[76:79], v[196:199], v[172:175], v[76:79]
    ds_read_b64_tr_b16 v[160:161], v223 offset:30720
    v_mfma_f32_16x16x32_bf16 v[92:95], v[196:199], v[176:179], v[92:95]
    ds_read_b64_tr_b16 v[162:163], v223 offset:34560
    v_mfma_f32_16x16x32_bf16 v[232:235], v[184:187], v[228:231], v[232:235]
    v_mfma_f32_16x16x32_bf16 v[236:239], v[188:191], v[228:231], v[236:239]
    v_mfma_f32_16x16x32_bf16 v[112:115], v[228:231], v[164:167], v[112:115]
    v_mfma_f32_16x16x32_bf16 v[116:119], v[164:167], v[164:167], v[116:119]
    v_mfma_f32_16x16x32_bf16 v[120:123], v[228:231], v[180:183], v[120:123]
    v_mfma_f32_16x16x32_bf16 v[124:127], v[180:183], v[180:183], v[124:127]
    s_waitcnt vmcnt(4) lgkmcnt(0)
    s_barrier
    s_mul_i32 s44, s33, 10
    s_add_u32 s44, s44, 480
    v_min_u32 v20, 9, v0
    v_add_u32 v20, s44, v20
    v_mul_u32_u24 v20, 3840, v20
    v_add_u32 v20, s45, v20
    s_mul_i32 s44, s32, 1280
    s_cmp_lt_u32 s32, 3
    s_cbranch_scc0 L_tlb_a0_a1_2
    buffer_load_dword v244, v20, s[16:19], s44 offen
L_tlb_a0_a1_2:
    s_sub_u32 s44, s32, 3
    s_cmp_lt_u32 s44, 3
    s_cbranch_scc0 L_tlb_a1_a1_2
    s_mul_i32 s44, s44, 1280
    buffer_load_dword v244, v20, s[16:19], s44 offen offset:128
L_tlb_a1_a1_2:
    v_mfma_f32_16x16x32_bf16 v[32:35], v[148:151], v[128:131], v[32:35]
    s_add_u32 m0, s40, 30720
    s_nop 0
    buffer_load_dwordx4 v12, s[16:19], s48 offen lds
    v_mfma_f32_16x16x32_bf16 v[48:51], v[148:151], v[132:135], v[48:51]
    ds_read_b128 v[164:167], v213 offset:0
    v_mfma_f32_16x16x32_bf16 v[64:67], v[148:151], v[136:139], v[64:67]
    ds_read_b128 v[168:171], v214 offset:0
    v_mfma_f32_16x16x32_bf16 v[80:83], v[148:151], v[140:143], v[80:83]
    ds_read_b128 v[172:175], v215 offset:0
    v_mfma_f32_16x16x32_bf16 v[36:39], v[152:155], v[128:131], v[36:39]
    ds_read_b128 v[176:179], v216 offset:0
    v_mfma_f32_16x16x32_bf16 v[52:55], v[152:155], v[132:135], v[52:55]
    s_cmp_eq_u32 s32, 7
    s_cbranch_scc1 L_a_s1_a1_10
    s_add_u32 m0, s41, 30720
    s_nop 0
    buffer_load_dwordx4 v13, s[16:19], s48 offen lds
L_a_s1_a1_10:
    s_add_u32 s48, s48, 122880
    s_cmp_ge_u32 s32, 6
    s_cbranch_scc1 L_a_s4_a1_10_o
L_a_s4_a1_10:
    s_add_u32 m0, s42, 36864
    s_nop 0
    buffer_load_dwordx4 v10, s[28:31], s47 offen lds
    v_mfma_f32_16x16x32_bf16 v[68:71], v[152:155], v[136:139], v[68:71]
    ds_read_b128 v[180:183], v217 offset:0
    v_mfma_f32_16x16x32_bf16 v[84:87], v[152:155], v[140:143], v[84:87]
    ds_read_b64_tr_b16 v[184:185], v220 offset:46080
    v_mfma_f32_16x16x32_bf16 v[40:43], v[156:159], v[128:131], v[40:43]
    ds_read_b64_tr_b16 v[186:187], v220 offset:49920
    v_mfma_f32_16x16x32_bf16 v[56:59], v[156:159], v[132:135], v[56:59]
    ds_read_b64_tr_b16 v[188:189], v221 offset:46080
    v_mfma_f32_16x16x32_bf16 v[72:75], v[156:159], v[136:139], v[72:75]
    s_add_u32 m0, s42, 45056
    s_nop 0
    buffer_load_dwordx4 v11, s[28:31], s47 offen lds
    v_mfma_f32_16x16x32_bf16 v[88:91], v[156:159], v[140:143], v[88:91]
    ds_read_b64_tr_b16 v[190:191], v221 offset:49920
    v_mfma_f32_16x16x32_bf16 v[44:47], v[160:163], v[128:131], v[44:47]
    ds_read_b64_tr_b16 v[192:193], v222 offset:46080
    v_mfma_f32_16x16x32_bf16 v[60:63], v[160:163], v[132:135], v[60:63]
    ds_read_b64_tr_b16 v[194:195], v222 offset:49920
    v_mfma_f32_16x16x32_bf16 v[76:79], v[160:163], v[136:139], v[76:79]
    ds_read_b64_tr_b16 v[196:197], v223 offset:46080
    v_mfma_f32_16x16x32_bf16 v[92:95], v[160:163], v[140:143], v[92:95]
    s_add_u32 s47, s47, 128
    ds_read_b64_tr_b16 v[198:199], v223 offset:49920
    v_mfma_f32_16x16x32_bf16 v[232:235], v[148:151], v[228:231], v[232:235]
    v_mfma_f32_16x16x32_bf16 v[236:239], v[152:155], v[228:231], v[236:239]
    v_mfma_f32_16x16x32_bf16 v[112:115], v[228:231], v[128:131], v[112:115]
    v_mfma_f32_16x16x32_bf16 v[116:119], v[128:131], v[128:131], v[116:119]
    v_mfma_f32_16x16x32_bf16 v[120:123], v[228:231], v[144:147], v[120:123]
    v_mfma_f32_16x16x32_bf16 v[124:127], v[144:147], v[144:147], v[124:127]
    s_waitcnt vmcnt(4) lgkmcnt(0)
    s_barrier
    v_mfma_f32_16x16x32_bf16 v[32:35], v[184:187], v[164:167], v[32:35]
    s_add_u32 m0, s40, 46080
    s_nop 0
    buffer_load_dwordx4 v12, s[16:19], s48 offen lds
    v_mfma_f32_16x16x32_bf16 v[48:51], v[184:187], v[168:171], v[48:51]
    ds_read_b128 v[128:131], v208 offset:18432
    v_mfma_f32_16x16x32_bf16 v[64:67], v[184:187], v[172:175], v[64:67]
    ds_read_b128 v[132:135], v209 offset:18432
    v_mfma_f32_16x16x32_bf16 v[80:83], v[184:187], v[176:179], v[80:83]
    ds_read_b128 v[136:139], v210 offset:18432
    v_mfma_f32_16x16x32_bf16 v[36:39], v[188:191], v[164:167], v[36:39]
    ds_read_b128 v[140:143], v211 offset:18432
    v_mfma_f32_16x16x32_bf16 v[52:55], v[188:191], v[168:171], v[52:55]
    v_mfma_f32_16x16x32_bf16 v[68:71], v[188:191], v[172:175], v[68:71]
    ds_read_b128 v[144:147], v212 offset:18432
    v_mfma_f32_16x16x32_bf16 v[84:87], v[188:191], v[176:179], v[84:87]
    ds_read_b64_tr_b16 v[148:149], v220 offset:0
    v_mfma_f32_16x16x32_bf16 v[40:43], v[192:195], v[164:167], v[40:43]
    ds_read_b64_tr_b16 v[150:151], v220 offset:3840
    v_mfma_f32_16x16x32_bf16 v[56:59], v[192:195], v[168:171], v[56:59]
    ds_read_b64_tr_b16 v[152:153], v221 offset:0
    v_mfma_f32_16x16x32_bf16 v[72:75], v[192:195], v[172:175], v[72:75]
    s_cmp_eq_u32 s32, 7
    s_cbranch_scc1 L_a_s1_a1_11
    s_add_u32 m0, s41, 46080
    s_nop 0
    buffer_load_dwordx4 v13, s[16:19], s48 offen lds
L_a_s1_a1_11:
    s_add_u32 s48, s48, 122880
    v_mfma_f32_16x16x32_bf16 v[88:91], v[192:195], v[176:179], v[88:91]
    ds_read_b64_tr_b16 v[154:155], v221 offset:3840
    v_mfma_f32_16x16x32_bf16 v[44:47], v[196:199], v[164:167], v[44:47]
    ds_read_b64_tr_b16 v[156:157], v222 offset:0
    v_mfma_f32_16x16x32_bf16 v[60:63], v[196:199], v[168:171], v[60:63]
    ds_read_b64_tr_b16 v[158:159], v222 offset:3840
    v_mfma_f32_16x16x32_bf16 v[76:79], v[196:199], v[172:175], v[76:79]
    ds_read_b64_tr_b16 v[160:161], v223 offset:0
    v_mfma_f32_16x16x32_bf16 v[92:95], v[196:199], v[176:179], v[92:95]
    ds_read_b64_tr_b16 v[162:163], v223 offset:3840
    v_mfma_f32_16x16x32_bf16 v[232:235], v[184:187], v[228:231], v[232:235]
    v_mfma_f32_16x16x32_bf16 v[236:239], v[188:191], v[228:231], v[236:239]
    v_mfma_f32_16x16x32_bf16 v[112:115], v[228:231], v[164:167], v[112:115]
    v_mfma_f32_16x16x32_bf16 v[116:119], v[164:167], v[164:167], v[116:119]
    v_mfma_f32_16x16x32_bf16 v[120:123], v[228:231], v[180:183], v[120:123]
    v_mfma_f32_16x16x32_bf16 v[124:127], v[180:183], v[180:183], v[124:127]
    s_waitcnt vmcnt(4) lgkmcnt(0)
    s_barrier
    v_mfma_f32_16x16x32_bf16 v[32:35], v[148:151], v[128:131], v[32:35]
    s_add_u32 m0, s40, 0
    s_nop 0
    buffer_load_dwordx4 v12, s[16:19], s48 offen lds
    v_mfma_f32_16x16x32_bf16 v[48:51], v[148:151], v[132:135], v[48:51]
    ds_read_b128 v[164:167], v213 offset:18432
    v_mfma_f32_16x16x32_bf16 v[64:67], v[148:151], v[136:139], v[64:67]
    ds_read_b128 v[168:171], v214 offset:18432
    v_mfma_f32_16x16x32_bf16 v[80:83], v[148:151], v[140:143], v[80:83]
    ds_read_b128 v[172:175], v215 offset:18432
    v_mfma_f32_16x16x32_bf16 v[36:39], v[152:155], v[128:131], v[36:39]
    ds_read_b128 v[176:179], v216 offset:18432
    v_mfma_f32_16x16x32_bf16 v[52:55], v[152:155], v[132:135], v[52:55]
    s_cmp_eq_u32 s32, 7
    s_cbranch_scc1 L_a_s1_a1_12
    s_add_u32 m0, s41, 0
    s_nop 0
    buffer_load_dwordx4 v13, s[16:19], s48 offen lds
L_a_s1_a1_12:
    s_add_u32 s48, s48, 122880
    s_cmp_ge_u32 s32, 6
    s_cbranch_scc1 L_a_s4_a1_12_o
L_a_s4_a1_12:
    s_add_u32 m0, s42, 0
    s_nop 0
    buffer_load_dwordx4 v10, s[28:31], s47 offen lds
    v_mfma_f32_16x16x32_bf16 v[68:71], v[152:155], v[136:139], v[68:71]
    ds_read_b128 v[180:183], v217 offset:18432
    v_mfma_f32_16x16x32_bf16 v[84:87], v[152:155], v[140:143], v[84:87]
    ds_read_b64_tr_b16 v[184:185], v220 offset:15360
    v_mfma_f32_16x16x32_bf16 v[40:43], v[156:159], v[128:131], v[40:43]
    ds_read_b64_tr_b16 v[186:187], v220 offset:19200
    v_mfma_f32_16x16x32_bf16 v[56:59], v[156:159], v[132:135], v[56:59]
    ds_read_b64_tr_b16 v[188:189], v221 offset:15360
    v_mfma_f32_16x16x32_bf16 v[72:75], v[156:159], v[136:139], v[72:75]
    s_add_u32 m0, s42, 8192
    s_nop 0
    buffer_load_dwordx4 v11, s[28:31], s47 offen lds
    v_mfma_f32_16x16x32_bf16 v[88:91], v[156:159], v[140:143], v[88:91]
    ds_read_b64_tr_b16 v[190:191], v221 offset:19200
    v_mfma_f32_16x16x32_bf16 v[44:47], v[160:163], v[128:131], v[44:47]
    ds_read_b64_tr_b16 v[192:193], v222 offset:15360
    v_mfma_f32_16x16x32_bf16 v[60:63], v[160:163], v[132:135], v[60:63]
    ds_read_b64_tr_b16 v[194:195], v222 offset:19200
    v_mfma_f32_16x16x32_bf16 v[76:79], v[160:163], v[136:139], v[76:79]
    ds_read_b64_tr_b16 v[196:197], v223 offset:15360
    v_mfma_f32_16x16x32_bf16 v[92:95], v[160:163], v[140:143], v[92:95]
    s_add_u32 s47, s47, 128
    ds_read_b64_tr_b16 v[198:199], v223 offset:19200
    v_mfma_f32_16x16x32_bf16 v[232:235], v[148:151], v[228:231], v[232:235]
    v_mfma_f32_16x16x32_bf16 v[236:239], v[152:155], v[228:231], v[236:239]
    v_mfma_f32_16x16x32_bf16 v[112:115], v[228:231], v[128:131], v[112:115]
    v_mfma_f32_16x16x32_bf16 v[116:119], v[128:131], v[128:131], v[116:119]
    v_mfma_f32_16x16x32_bf16 v[120:123], v[228:231], v[144:147], v[120:123]
    v_mfma_f32_16x16x32_bf16 v[124:127], v[144:147], v[144:147], v[124:127]
    s_waitcnt vmcnt(4) lgkmcnt(0)
    s_barrier
    s_mul_i32 s58, s2, 3
    s_add_u32 s58, s58, s32
    s_cmp_lt_u32 s32, 3
    s_cselect_b32 s58, s58, 4095
    s_cmp_lt_u32 s58, 680
    s_cbranch_scc0 L_b2_skip1_a1
    s_mul_i32 s59, s58, 6554
    s_lshr_b32 s59, s59, 16
    s_mul_i32 s60, s59, 10
    s_sub_u32 s60, s58, s60
    s_cmp_lt_u32 s59, 20
    s_cselect_b32 s64, s52, s54
    s_cselect_b32 s65, s53, s55
    s_mov_b32 s66, 1966080
    s_cselect_b32 s66, 819200, s66
    s_mov_b32 s67, 0x00020000
    s_sub_u32 s61, s59, 20
    s_cmp_lt_u32 s59, 20
    s_cselect_b32 s61, s59, s61
    s_mul_i32 s61, s61, 40960
    s_lshl_b32 s62, s60, 7
    s_add_u32 s61, s61, s62
    s_lshl_b32 s62, s32, 12
    s_add_u32 s62, s62, 147456
    v_lshrrev_b32 v20, 3, v0
    v_and_b32 v21, 7, v0
    v_add_u32 v22, 0, v20
    v_lshrrev_b32 v246, 1, v22
    v_and_b32 v246, 4, v246
    v_lshlrev_b32 v247, 1, v22
    v_and_b32 v247, 8, v247
    v_and_b32 v23, 0x13, v22
    v_or3_b32 v23, v23, v246, v247
    v_mul_u32_u24 v23, 1280, v23
    v_lshl_add_u32 v23, v21, 4, v23
    s_add_u32 m0, s62, 0
    s_nop 0
    buffer_load_dwordx4 v23, s[64:67], s61 offen lds
    v_add_u32 v22, 8, v20
    v_lshrrev_b32 v246, 1, v22
    v_and_b32 v246, 4, v246
    v_lshlrev_b32 v247, 1, v22
    v_and_b32 v247, 8, v247
    v_and_b32 v23, 0x13, v22
    v_or3_b32 v23, v23, v246, v247
    v_mul_u32_u24 v23, 1280, v23
    v_lshl_add_u32 v23, v21, 4, v23
    s_add_u32 m0, s62, 1024
    s_nop 0
    buffer_load_dwordx4 v23, s[64:67], s61 offen lds
    v_add_u32 v22, 16, v20
    v_lshrrev_b32 v246, 1, v22
    v_and_b32 v246, 4, v246
    v_lshlrev_b32 v247, 1, v22
    v_and_b32 v247, 8, v247
    v_and_b32 v23, 0x13, v22
    v_or3_b32 v23, v23, v246, v247
    v_mul_u32_u24 v23, 1280, v23
    v_lshl_add_u32 v23, v21, 4, v23
    s_add_u32 m0, s62, 2048
    s_nop 0
    buffer_load_dwordx4 v23, s[64:67], s61 offen lds
    v_add_u32 v22, 24, v20
    v_lshrrev_b32 v246, 1, v22
    v_and_b32 v246, 4, v246
    v_lshlrev_b32 v247, 1, v22
    v_and_b32 v247, 8, v247
    v_and_b32 v23, 0x13, v22
    v_or3_b32 v23, v23, v246, v247
    v_mul_u32_u24 v23, 1280, v23
    v_lshl_add_u32 v23, v21, 4, v23
    s_add_u32 m0, s62, 3072
    s_nop 0
    buffer_load_dwordx4 v23, s[64:67], s61 offen lds
L_b2_skip1_a1:
    v_mfma_f32_16x16x32_bf16 v[32:35], v[184:187], v[164:167], v[32:35]
    s_add_u32 m0, s40, 15360
    s_nop 0
    buffer_load_dwordx4 v12, s[16:19], s48 offen lds
    v_mfma_f32_16x16x32_bf16 v[48:51], v[184:187], v[168:171], v[48:51]
    ds_read_b128 v[128:131], v208 offset:36864
    v_mfma_f32_16x16x32_bf16 v[64:67], v[184:187], v[172:175], v[64:67]
    ds_read_b128 v[132:135], v209 offset:36864
    v_mfma_f32_16x16x32_bf16 v[80:83], v[184:187], v[176:179], v[80:83]
    ds_read_b128 v[136:139], v210 offset:36864
    v_mfma_f32_16x16x32_bf16 v[36:39], v[188:191], v[164:167], v[36:39]
    ds_read_b128 v[140:143], v211 offset:36864
    v_mfma_f32_16x16x32_bf16 v[52:55], v[188:191], v[168:171], v[52:55]
    v_mfma_f32_16x16x32_bf16 v[68:71], v[188:191], v[172:175], v[68:71]
    ds_read_b128 v[144:147], v212 offset:36864
    v_mfma_f32_16x16x32_bf16 v[84:87], v[188:191], v[176:179], v[84:87]
    ds_read_b64_tr_b16 v[148:149], v220 offset:30720
    v_mfma_f32_16x16x32_bf16 v[40:43], v[192:195], v[164:167], v[40:43]
    ds_read_b64_tr_b16 v[150:151], v220 offset:34560
    v_mfma_f32_16x16x32_bf16 v[56:59], v[192:195], v[168:171], v[56:59]
    ds_read_b64_tr_b16 v[152:153], v221 offset:30720
    v_mfma_f32_16x16x32_bf16 v[72:75], v[192:195], v[172:175], v[72:75]
    s_cmp_eq_u32 s32, 7
    s_cbranch_scc1 L_a_s1_a1_13
    s_add_u32 m0, s41, 15360
    s_nop 0
    buffer_load_dwordx4 v13, s[16:19], s48 offen lds
L_a_s1_a1_13:
    s_add_u32 s48, s48, 122880
    v_mfma_f32_16x16x32_bf16 v[88:91], v[192:195], v[176:179], v[88:91]
    ds_read_b64_tr_b16 v[154:155], v221 offset:34560
    v_mfma_f32_16x16x32_bf16 v[44:47], v[196:199], v[164:167], v[44:47]
    ds_read_b64_tr_b16 v[156:157], v222 offset:30720
    v_mfma_f32_16x16x32_bf16 v[60:63], v[196:199], v[168:171], v[60:63]
    ds_read_b64_tr_b16 v[158:159], v222 offset:34560
    v_mfma_f32_16x16x32_bf16 v[76:79], v[196:199], v[172:175], v[76:79]
    ds_read_b64_tr_b16 v[160:161], v223 offset:30720
    v_mfma_f32_16x16x32_bf16 v[92:95], v[196:199], v[176:179], v[92:95]
    ds_read_b64_tr_b16 v[162:163], v223 offset:34560
    v_mfma_f32_16x16x32_bf16 v[232:235], v[184:187], v[228:231], v[232:235]
    v_mfma_f32_16x16x32_bf16 v[236:239], v[188:191], v[228:231], v[236:239]
    v_mfma_f32_16x16x32_bf16 v[112:115], v[228:231], v[164:167], v[112:115]
    v_mfma_f32_16x16x32_bf16 v[116:119], v[164:167], v[164:167], v[116:119]
    v_mfma_f32_16x16x32_bf16 v[120:123], v[228:231], v[180:183], v[120:123]
    v_mfma_f32_16x16x32_bf16 v[124:127], v[180:183], v[180:183], v[124:127]
    s_waitcnt vmcnt(4) lgkmcnt(0)
    s_barrier
    v_mfma_f32_16x16x32_bf16 v[32:35], v[148:151], v[128:131], v[32:35]
    s_add_u32 m0, s40, 30720
    s_nop 0
    buffer_load_dwordx4 v12, s[16:19], s48 offen lds
    v_mfma_f32_16x16x32_bf16 v[48:51], v[148:151], v[132:135], v[48:51]
    ds_read_b128 v[164:167], v213 offset:36864
    v_mfma_f32_16x16x32_bf16 v[64:67], v[148:151], v[136:139], v[64:67]
    ds_read_b128 v[168:171], v214 offset:36864
    v_mfma_f32_16x16x32_bf16 v[80:83], v[148:151], v[140:143], v[80:83]
    ds_read_b128 v[172:175], v215 offset:36864
    v_mfma_f32_16x16x32_bf16 v[36:39], v[152:155], v[128:131], v[36:39]
    ds_read_b128 v[176:179], v216 offset:36864
    v_mfma_f32_16x16x32_bf16 v[52:55], v[152:155], v[132:135], v[52:55]
    s_cmp_eq_u32 s32, 7
    s_cbranch_scc1 L_a_s1_a1_14
    s_add_u32 m0, s41, 30720
    s_nop 0
    buffer_load_dwordx4 v13, s[16:19], s48 offen lds
L_a_s1_a1_14:
    s_add_u32 s48, s48, 122880
    s_cmp_ge_u32 s32, 6
    s_cbranch_scc1 L_a_s4_a1_14_o
L_a_s4_a1_14:
    s_add_u32 m0, s42, 18432
    s_nop 0
    buffer_load_dwordx4 v10, s[28:31], s47 offen lds
    v_mfma_f32_16x16x32_bf16 v[68:71], v[152:155], v[136:139], v[68:71]
    ds_read_b128 v[180:183], v217 offset:36864
    v_mfma_f32_16x16x32_bf16 v[84:87], v[152:155], v[140:143], v[84:87]
    ds_read_b64_tr_b16 v[184:185], v220 offset:46080
    v_mfma_f32_16x16x32_bf16 v[40:43], v[156:159], v[128:131], v[40:43]
    ds_read_b64_tr_b16 v[186:187], v220 offset:49920
    v_mfma_f32_16x16x32_bf16 v[56:59], v[156:159], v[132:135], v[56:59]
    ds_read_b64_tr_b16 v[188:189], v221 offset:46080
    v_mfma_f32_16x16x32_bf16 v[72:75], v[156:159], v[136:139], v[72:75]
    s_add_u32 m0, s42, 26624
    s_nop 0
    buffer_load_dwordx4 v11, s[28:31], s47 offen lds
    v_mfma_f32_16x16x32_bf16 v[88:91], v[156:159], v[140:143], v[88:91]
    ds_read_b64_tr_b16 v[190:191], v221 offset:49920
    v_mfma_f32_16x16x32_bf16 v[44:47], v[160:163], v[128:131], v[44:47]
    ds_read_b64_tr_b16 v[192:193], v222 offset:46080
    v_mfma_f32_16x16x32_bf16 v[60:63], v[160:163], v[132:135], v[60:63]
    ds_read_b64_tr_b16 v[194:195], v222 offset:49920
    v_mfma_f32_16x16x32_bf16 v[76:79], v[160:163], v[136:139], v[76:79]
    ds_read_b64_tr_b16 v[196:197], v223 offset:46080
    v_mfma_f32_16x16x32_bf16 v[92:95], v[160:163], v[140:143], v[92:95]
    s_add_u32 s47, s47, 128
    ds_read_b64_tr_b16 v[198:199], v223 offset:49920
    v_mfma_f32_16x16x32_bf16 v[232:235], v[148:151], v[228:231], v[232:235]
    v_mfma_f32_16x16x32_bf16 v[236:239], v[152:155], v[228:231], v[236:239]
    v_mfma_f32_16x16x32_bf16 v[112:115], v[228:231], v[128:131], v[112:115]
    v_mfma_f32_16x16x32_bf16 v[116:119], v[128:131], v[128:131], v[116:119]
    v_mfma_f32_16x16x32_bf16 v[120:123], v[228:231], v[144:147], v[120:123]
    v_mfma_f32_16x16x32_bf16 v[124:127], v[144:147], v[144:147], v[124:127]
    s_waitcnt vmcnt(4) lgkmcnt(0)
    s_barrier
    v_mfma_f32_16x16x32_bf16 v[32:35], v[184:187], v[164:167], v[32:35]
    s_add_u32 m0, s40, 46080
    s_nop 0
    buffer_load_dwordx4 v12, s[16:19], s48 offen lds
    v_mfma_f32_16x16x32_bf16 v[48:51], v[184:187], v[168:171], v[48:51]
    ds_read_b128 v[128:131], v208 offset:0
    v_mfma_f32_16x16x32_bf16 v[64:67], v[184:187], v[172:175], v[64:67]
    ds_read_b128 v[132:135], v209 offset:0
    v_mfma_f32_16x16x32_bf16 v[80:83], v[184:187], v[176:179], v[80:83]
    ds_read_b128 v[136:139], v210 offset:0
    v_mfma_f32_16x16x32_bf16 v[36:39], v[188:191], v[164:167], v[36:39]
    ds_read_b128 v[140:143], v211 offset:0
    v_mfma_f32_16x16x32_bf16 v[52:55], v[188:191], v[168:171], v[52:55]
    v_mfma_f32_16x16x32_bf16 v[68:71], v[188:191], v[172:175], v[68:71]
    ds_read_b128 v[144:147], v212 offset:0
    v_mfma_f32_16x16x32_bf16 v[84:87], v[188:191], v[176:179], v[84:87]
    ds_read_b64_tr_b16 v[148:149], v220 offset:0
    v_mfma_f32_16x16x32_bf16 v[40:43], v[192:195], v[164:167], v[40:43]
    ds_read_b64_tr_b16 v[150:151], v220 offset:3840
    v_mfma_f32_16x16x32_bf16 v[56:59], v[192:195], v[168:171], v[56:59]
    ds_read_b64_tr_b16 v[152:153], v221 offset:0
    v_mfma_f32_16x16x32_bf16 v[72:75], v[192:195], v[172:175], v[72:75]
    s_cmp_eq_u32 s32, 7
    s_cbranch_scc1 L_a_s1_a1_15
    s_add_u32 m0, s41, 46080
    s_nop 0
    buffer_load_dwordx4 v13, s[16:19], s48 offen lds
L_a_s1_a1_15:
    s_add_u32 s48, s48, 122880
    v_mfma_f32_16x16x32_bf16 v[88:91], v[192:195], v[176:179], v[88:91]
    ds_read_b64_tr_b16 v[154:155], v221 offset:3840
    v_mfma_f32_16x16x32_bf16 v[44:47], v[196:199], v[164:167], v[44:47]
    ds_read_b64_tr_b16 v[156:157], v222 offset:0
    v_mfma_f32_16x16x32_bf16 v[60:63], v[196:199], v[168:171], v[60:63]
    ds_read_b64_tr_b16 v[158:159], v222 offset:3840
    v_mfma_f32_16x16x32_bf16 v[76:79], v[196:199], v[172:175], v[76:79]
    ds_read_b64_tr_b16 v[160:161], v223 offset:0
    v_mfma_f32_16x16x32_bf16 v[92:95], v[196:199], v[176:179], v[92:95]
    ds_read_b64_tr_b16 v[162:163], v223 offset:3840
    v_mfma_f32_16x16x32_bf16 v[232:235], v[184:187], v[228:231], v[232:235]
    v_mfma_f32_16x16x32_bf16 v[236:239], v[188:191], v[228:231], v[236:239]
    v_mfma_f32_16x16x32_bf16 v[112:115], v[228:231], v[164:167], v[112:115]
    v_mfma_f32_16x16x32_bf16 v[116:119], v[164:167], v[164:167], v[116:119]
    v_mfma_f32_16x16x32_bf16 v[120:123], v[228:231], v[180:183], v[120:123]
    v_mfma_f32_16x16x32_bf16 v[124:127], v[180:183], v[180:183], v[124:127]
    s_waitcnt vmcnt(4) lgkmcnt(0)
    s_barrier
    v_mfma_f32_16x16x32_bf16 v[32:35], v[148:151], v[128:131], v[32:35]
    s_add_u32 m0, s40, 0
    s_nop 0
    buffer_load_dwordx4 v12, s[16:19], s48 offen lds
    v_mfma_f32_16x16x32_bf16 v[48:51], v[148:151], v[132:135], v[48:51]
    ds_read_b128 v[164:167], v213 offset:0
    v_mfma_f32_16x16x32_bf16 v[64:67], v[148:151], v[136:139], v[64:67]
    ds_read_b128 v[168:171], v214 offset:0
    v_mfma_f32_16x16x32_bf16 v[80:83], v[148:151], v[140:143], v[80:83]
    ds_read_b128 v[172:175], v215 offset:0
    v_mfma_f32_16x16x32_bf16 v[36:39], v[152:155], v[128:131], v[36:39]
    ds_read_b128 v[176:179], v216 offset:0
    v_mfma_f32_16x16x32_bf16 v[52:55], v[152:155], v[132:135], v[52:55]
    s_cmp_eq_u32 s32, 7
    s_cbranch_scc1 L_a_s1_a1_16
    s_add_u32 m0, s41, 0
    s_nop 0
    buffer_load_dwordx4 v13, s[16:19], s48 offen lds
L_a_s1_a1_16:
    s_add_u32 s48, s48, 122880
    s_cmp_ge_u32 s32, 6
    s_cbranch_scc1 L_a_s4_a1_16_o
L_a_s4_a1_16:
    s_add_u32 m0, s42, 36864
    s_nop 0
    buffer_load_dwordx4 v10, s[28:31], s47 offen lds
    v_mfma_f32_16x16x32_bf16 v[68:71], v[152:155], v[136:139], v[68:71]
    ds_read_b128 v[180:183], v217 offset:0
    v_mfma_f32_16x16x32_bf16 v[84:87], v[152:155], v[140:143], v[84:87]
    ds_read_b64_tr_b16 v[184:185], v220 offset:15360
    v_mfma_f32_16x16x32_bf16 v[40:43], v[156:159], v[128:131], v[40:43]
    ds_read_b64_tr_b16 v[186:187], v220 offset:19200
    v_mfma_f32_16x16x32_bf16 v[56:59], v[156:159], v[132:135], v[56:59]
    ds_read_b64_tr_b16 v[188:189], v221 offset:15360
    v_mfma_f32_16x16x32_bf16 v[72:75], v[156:159], v[136:139], v[72:75]
    s_add_u32 m0, s42, 45056
    s_nop 0
    buffer_load_dwordx4 v11, s[28:31], s47 offen lds
    v_mfma_f32_16x16x32_bf16 v[88:91], v[156:159], v[140:143], v[88:91]
    ds_read_b64_tr_b16 v[190:191], v221 offset:19200
    v_mfma_f32_16x16x32_bf16 v[44:47], v[160:163], v[128:131], v[44:47]
    ds_read_b64_tr_b16 v[192:193], v222 offset:15360
    v_mfma_f32_16x16x32_bf16 v[60:63], v[160:163], v[132:135], v[60:63]
    ds_read_b64_tr_b16 v[194:195], v222 offset:19200
    v_mfma_f32_16x16x32_bf16 v[76:79], v[160:163], v[136:139], v[76:79]
    ds_read_b64_tr_b16 v[196:197], v223 offset:15360
    v_mfma_f32_16x16x32_bf16 v[92:95], v[160:163], v[140:143], v[92:95]
    s_add_u32 s47, s47, 128
    ds_read_b64_tr_b16 v[198:199], v223 offset:19200
    v_mfma_f32_16x16x32_bf16 v[232:235], v[148:151], v[228:231], v[232:235]
    v_mfma_f32_16x16x32_bf16 v[236:239], v[152:155], v[228:231], v[236:239]
    v_mfma_f32_16x16x32_bf16 v[112:115], v[228:231], v[128:131], v[112:115]
    v_mfma_f32_16x16x32_bf16 v[116:119], v[128:131], v[128:131], v[116:119]
    v_mfma_f32_16x16x32_bf16 v[120:123], v[228:231], v[144:147], v[120:123]
    v_mfma_f32_16x16x32_bf16 v[124:127], v[144:147], v[144:147], v[124:127]
    s_waitcnt vmcnt(4) lgkmcnt(0)
    s_barrier
    v_mfma_f32_16x16x32_bf16 v[32:35], v[184:187], v[164:167], v[32:35]
    s_add_u32 m0, s40, 15360
    s_nop 0
    buffer_load_dwordx4 v12, s[16:19], s48 offen lds
    v_mfma_f32_16x16x32_bf16 v[48:51], v[184:187], v[168:171], v[48:51]
    ds_read_b128 v[128:131], v208 offset:18432
    v_mfma_f32_16x16x32_bf16 v[64:67], v[184:187], v[172:175], v[64:67]
    ds_read_b128 v[132:135], v209 offset:18432
    v_mfma_f32_16x16x32_bf16 v[80:83], v[184:187], v[176:179], v[80:83]
    ds_read_b128 v[136:139], v210 offset:18432
    v_mfma_f32_16x16x32_bf16 v[36:39], v[188:191], v[164:167], v[36:39]
    ds_read_b128 v[140:143], v211 offset:18432
    v_mfma_f32_16x16x32_bf16 v[52:55], v[188:191], v[168:171], v[52:55]
    v_mfma_f32_16x16x32_bf16 v[68:71], v[188:191], v[172:175], v[68:71]
    ds_read_b128 v[144:147], v212 offset:18432
    v_mfma_f32_16x16x32_bf16 v[84:87], v[188:191], v[176:179], v[84:87]
    ds_read_b64_tr_b16 v[148:149], v220 offset:30720
    v_mfma_f32_16x16x32_bf16 v[40:43], v[192:195], v[164:167], v[40:43]
    ds_read_b64_tr_b16 v[150:151], v220 offset:34560
    v_mfma_f32_16x16x32_bf16 v[56:59], v[192:195], v[168:171], v[56:59]
    ds_read_b64_tr_b16 v[152:153], v221 offset:30720
    v_mfma_f32_16x16x32_bf16 v[72:75], v[192:195], v[172:175], v[72:75]
    s_cmp_eq_u32 s32, 7
    s_cbranch_scc1 L_a_s1_a1_17
    s_add_u32 m0, s41, 15360
    s_nop 0
    buffer_load_dwordx4 v13, s[16:19], s48 offen lds
L_a_s1_a1_17:
    s_add_u32 s48, s48, 122880
    v_mfma_f32_16x16x32_bf16 v[88:91], v[192:195], v[176:179], v[88:91]
    ds_read_b64_tr_b16 v[154:155], v221 offset:34560
    v_mfma_f32_16x16x32_bf16 v[44:47], v[196:199], v[164:167], v[44:47]
    ds_read_b64_tr_b16 v[156:157], v222 offset:30720
    v_mfma_f32_16x16x32_bf16 v[60:63], v[196:199], v[168:171], v[60:63]
    ds_read_b64_tr_b16 v[158:159], v222 offset:34560
    v_mfma_f32_16x16x32_bf16 v[76:79], v[196:199], v[172:175], v[76:79]
    ds_read_b64_tr_b16 v[160:161], v223 offset:30720
    v_mfma_f32_16x16x32_bf16 v[92:95], v[196:199], v[176:179], v[92:95]
    ds_read_b64_tr_b16 v[162:163], v223 offset:34560
    v_mfma_f32_16x16x32_bf16 v[232:235], v[184:187], v[228:231], v[232:235]
    v_mfma_f32_16x16x32_bf16 v[236:239], v[188:191], v[228:231], v[236:239]
    v_mfma_f32_16x16x32_bf16 v[112:115], v[228:231], v[164:167], v[112:115]
    v_mfma_f32_16x16x32_bf16 v[116:119], v[164:167], v[164:167], v[116:119]
    v_mfma_f32_16x16x32_bf16 v[120:123], v[228:231], v[180:183], v[120:123]
    v_mfma_f32_16x16x32_bf16 v[124:127], v[180:183], v[180:183], v[124:127]
    s_waitcnt vmcnt(4) lgkmcnt(0)
    s_barrier
    v_mfma_f32_16x16x32_bf16 v[32:35], v[148:151], v[128:131], v[32:35]
    s_add_u32 m0, s40, 30720
    s_nop 0
    buffer_load_dwordx4 v12, s[16:19], s48 offen lds
    v_mfma_f32_16x16x32_bf16 v[48:51], v[148:151], v[132:135], v[48:51]
    ds_read_b128 v[164:167], v213 offset:18432
    v_mfma_f32_16x16x32_bf16 v[64:67], v[148:151], v[136:139], v[64:67]
    ds_read_b128 v[168:171], v214 offset:18432
    v_mfma_f32_16x16x32_bf16 v[80:83], v[148:151], v[140:143], v[80:83]
    ds_read_b128 v[172:175], v215 offset:18432
    v_mfma_f32_16x16x32_bf16 v[36:39], v[152:155], v[128:131], v[36:39]
    ds_read_b128 v[176:179], v216 offset:18432
    v_mfma_f32_16x16x32_bf16 v[52:55], v[152:155], v[132:135], v[52:55]
    s_cmp_eq_u32 s32, 7
    s_cbranch_scc1 L_a_s1_a1_18
    s_add_u32 m0, s41, 30720
    s_nop 0
    buffer_load_dwordx4 v13, s[16:19], s48 offen lds
L_a_s1_a1_18:
    s_add_u32 s48, s48, 122880
    s_cmp_ge_u32 s32, 6
    s_cbranch_scc1 L_a_s4_a1_18_o
L_a_s4_a1_18:
    s_add_u32 m0, s42, 0
    s_nop 0
    buffer_load_dwordx4 v10, s[28:31], s47 offen lds
    v_mfma_f32_16x16x32_bf16 v[68:71], v[152:155], v[136:139], v[68:71]
    ds_read_b128 v[180:183], v217 offset:18432
    v_mfma_f32_16x16x32_bf16 v[84:87], v[152:155], v[140:143], v[84:87]
    ds_read_b64_tr_b16 v[184:185], v220 offset:46080
    v_mfma_f32_16x16x32_bf16 v[40:43], v[156:159], v[128:131], v[40:43]
    ds_read_b64_tr_b16 v[186:187], v220 offset:49920
    v_mfma_f32_16x16x32_bf16 v[56:59], v[156:159], v[132:135], v[56:59]
    ds_read_b64_tr_b16 v[188:189], v221 offset:46080
    v_mfma_f32_16x16x32_bf16 v[72:75], v[156:159], v[136:139], v[72:75]
    s_add_u32 m0, s42, 8192
    s_nop 0
    buffer_load_dwordx4 v11, s[28:31], s47 offen lds
    v_mfma_f32_16x16x32_bf16 v[88:91], v[156:159], v[140:143], v[88:91]
    ds_read_b64_tr_b16 v[190:191], v221 offset:49920
    v_mfma_f32_16x16x32_bf16 v[44:47], v[160:163], v[128:131], v[44:47]
    ds_read_b64_tr_b16 v[192:193], v222 offset:46080
    v_mfma_f32_16x16x32_bf16 v[60:63], v[160:163], v[132:135], v[60:63]
    ds_read_b64_tr_b16 v[194:195], v222 offset:49920
    v_mfma_f32_16x16x32_bf16 v[76:79], v[160:163], v[136:139], v[76:79]
    ds_read_b64_tr_b16 v[196:197], v223 offset:46080
    v_mfma_f32_16x16x32_bf16 v[92:95], v[160:163], v[140:143], v[92:95]
    s_add_u32 s47, s47, 128
    ds_read_b64_tr_b16 v[198:199], v223 offset:49920
    v_mfma_f32_16x16x32_bf16 v[232:235], v[148:151], v[228:231], v[232:235]
    v_mfma_f32_16x16x32_bf16 v[236:239], v[152:155], v[228:231], v[236:239]
    v_mfma_f32_16x16x32_bf16 v[112:115], v[228:231], v[128:131], v[112:115]
    v_mfma_f32_16x16x32_bf16 v[116:119], v[128:131], v[128:131], v[116:119]
    v_mfma_f32_16x16x32_bf16 v[120:123], v[228:231], v[144:147], v[120:123]
    v_mfma_f32_16x16x32_bf16 v[124:127], v[144:147], v[144:147], v[124:127]
    s_waitcnt vmcnt(4) lgkmcnt(0)
    s_barrier
    s_cmp_lt_u32 s58, 680
    s_cbranch_scc0 L_b2_skip2_a1
    v_lshlrev_b32 v1, 7, v9
    v_lshl_add_u32 v1, v4, 3, v1
    v_add_u32 v1, s62, v1
    ds_read_b64_tr_b16 v[244:245], v1 offset:0
    ds_read_b64_tr_b16 v[246:247], v1 offset:1024
    ds_read_b64_tr_b16 v[248:249], v1 offset:32
    ds_read_b64_tr_b16 v[250:251], v1 offset:1056
    ds_read_b64_tr_b16 v[252:253], v1 offset:64
    ds_read_b64_tr_b16 v[254:255], v1 offset:1088
    ds_read_b64_tr_b16 v[20:21], v1 offset:96
    ds_read_b64_tr_b16 v[22:23], v1 offset:1120
    s_waitcnt lgkmcnt(0)
    s_lshl_b32 s61, s60, 2
    s_add_u32 s61, s61, 0
    s_mul_i32 s62, s61, 13108
    s_lshr_b32 s62, s62, 16
    s_mul_i32 s63, s62, 5
    s_sub_u32 s63, s61, s63
    s_mul_i32 s62, s62, 68
    s_add_u32 s62, s62, s59
    s_mul_i32 s62, s62, 5
    s_add_u32 s62, s62, s63
    s_lshl_b32 s62, s62, 10
    s_add_u32 s62, s62, 9437184
    buffer_store_dwordx4 v[244:247], v5, s[12:15], s62 offen sc0 sc1
    s_lshl_b32 s61, s60, 2
    s_add_u32 s61, s61, 1
    s_mul_i32 s62, s61, 13108
    s_lshr_b32 s62, s62, 16
    s_mul_i32 s63, s62, 5
    s_sub_u32 s63, s61, s63
    s_mul_i32 s62, s62, 68
    s_add_u32 s62, s62, s59
    s_mul_i32 s62, s62, 5
    s_add_u32 s62, s62, s63
    s_lshl_b32 s62, s62, 10
    s_add_u32 s62, s62, 9437184
    buffer_store_dwordx4 v[248:251], v5, s[12:15], s62 offen sc0 sc1
    s_lshl_b32 s61, s60, 2
    s_add_u32 s61, s61, 2
    s_mul_i32 s62, s61, 13108
    s_lshr_b32 s62, s62, 16
    s_mul_i32 s63, s62, 5
    s_sub_u32 s63, s61, s63
    s_mul_i32 s62, s62, 68
    s_add_u32 s62, s62, s59
    s_mul_i32 s62, s62, 5
    s_add_u32 s62, s62, s63
    s_lshl_b32 s62, s62, 10
    s_add_u32 s62, s62, 9437184
    buffer_store_dwordx4 v[252:255], v5, s[12:15], s62 offen sc0 sc1
    s_lshl_b32 s61, s60, 2
    s_add_u32 s61, s61, 3
    s_mul_i32 s62, s61, 13108
    s_lshr_b32 s62, s62, 16
    s_mul_i32 s63, s62, 5
    s_sub_u32 s63, s61, s63
    s_mul_i32 s62, s62, 68
    s_add_u32 s62, s62, s59
    s_mul_i32 s62, s62, 5
    s_add_u32 s62, s62, s63
    s_lshl_b32 s62, s62, 10
    s_add_u32 s62, s62, 9437184
    buffer_store_dwordx4 v[20:23], v5, s[12:15], s62 offen sc0 sc1
    s_nop 4
L_b2_skip2_a1:
    v_mfma_f32_16x16x32_bf16 v[32:35], v[184:187], v[164:167], v[32:35]
    s_add_u32 m0, s40, 46080
    s_nop 0
    buffer_load_dwordx4 v12, s[16:19], s48 offen lds
    v_mfma_f32_16x16x32_bf16 v[48:51], v[184:187], v[168:171], v[48:51]
    ds_read_b128 v[128:131], v208 offset:36864
    v_mfma_f32_16x16x32_bf16 v[64:67], v[184:187], v[172:175], v[64:67]
    ds_read_b128 v[132:135], v209 offset:36864
    v_mfma_f32_16x16x32_bf16 v[80:83], v[184:187], v[176:179], v[80:83]
    ds_read_b128 v[136:139], v210 offset:36864
    v_mfma_f32_16x16x32_bf16 v[36:39], v[188:191], v[164:167], v[36:39]
    ds_read_b128 v[140:143], v211 offset:36864
    v_mfma_f32_16x16x32_bf16 v[52:55], v[188:191], v[168:171], v[52:55]
    v_mfma_f32_16x16x32_bf16 v[68:71], v[188:191], v[172:175], v[68:71]
    ds_read_b128 v[144:147], v212 offset:36864
    v_mfma_f32_16x16x32_bf16 v[84:87], v[188:191], v[176:179], v[84:87]
    ds_read_b64_tr_b16 v[148:149], v220 offset:0
    v_mfma_f32_16x16x32_bf16 v[40:43], v[192:195], v[164:167], v[40:43]
    ds_read_b64_tr_b16 v[150:151], v220 offset:3840
    v_mfma_f32_16x16x32_bf16 v[56:59], v[192:195], v[168:171], v[56:59]
    ds_read_b64_tr_b16 v[152:153], v221 offset:0
    v_mfma_f32_16x16x32_bf16 v[72:75], v[192:195], v[172:175], v[72:75]
    s_cmp_eq_u32 s32, 7
    s_cbranch_scc1 L_a_s1_a1_19
    s_add_u32 m0, s41, 46080
    s_nop 0
    buffer_load_dwordx4 v13, s[16:19], s48 offen lds
L_a_s1_a1_19:
    s_add_u32 s48, s48, 122880
    v_mfma_f32_16x16x32_bf16 v[88:91], v[192:195], v[176:179], v[88:91]
    ds_read_b64_tr_b16 v[154:155], v221 offset:3840
    v_mfma_f32_16x16x32_bf16 v[44:47], v[196:199], v[164:167], v[44:47]
    ds_read_b64_tr_b16 v[156:157], v222 offset:0
    v_mfma_f32_16x16x32_bf16 v[60:63], v[196:199], v[168:171], v[60:63]
    ds_read_b64_tr_b16 v[158:159], v222 offset:3840
    v_mfma_f32_16x16x32_bf16 v[76:79], v[196:199], v[172:175], v[76:79]
    ds_read_b64_tr_b16 v[160:161], v223 offset:0
    v_mfma_f32_16x16x32_bf16 v[92:95], v[196:199], v[176:179], v[92:95]
    ds_read_b64_tr_b16 v[162:163], v223 offset:3840
    v_mfma_f32_16x16x32_bf16 v[232:235], v[184:187], v[228:231], v[232:235]
    v_mfma_f32_16x16x32_bf16 v[236:239], v[188:191], v[228:231], v[236:239]
    v_mfma_f32_16x16x32_bf16 v[112:115], v[228:231], v[164:167], v[112:115]
    v_mfma_f32_16x16x32_bf16 v[116:119], v[164:167], v[164:167], v[116:119]
    v_mfma_f32_16x16x32_bf16 v[120:123], v[228:231], v[180:183], v[120:123]
    v_mfma_f32_16x16x32_bf16 v[124:127], v[180:183], v[180:183], v[124:127]
    s_waitcnt vmcnt(4) lgkmcnt(0)
    s_barrier
    v_mfma_f32_16x16x32_bf16 v[32:35], v[148:151], v[128:131], v[32:35]
    v_mfma_f32_16x16x32_bf16 v[48:51], v[148:151], v[132:135], v[48:51]
    ds_read_b128 v[164:167], v213 offset:36864
    v_mfma_f32_16x16x32_bf16 v[64:67], v[148:151], v[136:139], v[64:67]
    ds_read_b128 v[168:171], v214 offset:36864
    v_mfma_f32_16x16x32_bf16 v[80:83], v[148:151], v[140:143], v[80:83]
    ds_read_b128 v[172:175], v215 offset:36864
    v_mfma_f32_16x16x32_bf16 v[36:39], v[152:155], v[128:131], v[36:39]
    ds_read_b128 v[176:179], v216 offset:36864
    v_mfma_f32_16x16x32_bf16 v[52:55], v[152:155], v[132:135], v[52:55]
    v_mfma_f32_16x16x32_bf16 v[68:71], v[152:155], v[136:139], v[68:71]
    ds_read_b128 v[180:183], v217 offset:36864
    v_mfma_f32_16x16x32_bf16 v[84:87], v[152:155], v[140:143], v[84:87]
    ds_read_b64_tr_b16 v[184:185], v220 offset:15360
    v_mfma_f32_16x16x32_bf16 v[40:43], v[156:159], v[128:131], v[40:43]
    ds_read_b64_tr_b16 v[186:187], v220 offset:19200
    v_mfma_f32_16x16x32_bf16 v[56:59], v[156:159], v[132:135], v[56:59]
    ds_read_b64_tr_b16 v[188:189], v221 offset:15360
    v_mfma_f32_16x16x32_bf16 v[72:75], v[156:159], v[136:139], v[72:75]
    v_mfma_f32_16x16x32_bf16 v[88:91], v[156:159], v[140:143], v[88:91]
    ds_read_b64_tr_b16 v[190:191], v221 offset:19200
    v_mfma_f32_16x16x32_bf16 v[44:47], v[160:163], v[128:131], v[44:47]
    ds_read_b64_tr_b16 v[192:193], v222 offset:15360
    v_mfma_f32_16x16x32_bf16 v[60:63], v[160:163], v[132:135], v[60:63]
    ds_read_b64_tr_b16 v[194:195], v222 offset:19200
    v_mfma_f32_16x16x32_bf16 v[76:79], v[160:163], v[136:139], v[76:79]
    ds_read_b64_tr_b16 v[196:197], v223 offset:15360
    v_mfma_f32_16x16x32_bf16 v[92:95], v[160:163], v[140:143], v[92:95]
    ds_read_b64_tr_b16 v[198:199], v223 offset:19200
    v_mfma_f32_16x16x32_bf16 v[232:235], v[148:151], v[228:231], v[232:235]
    v_mfma_f32_16x16x32_bf16 v[236:239], v[152:155], v[228:231], v[236:239]
    v_mfma_f32_16x16x32_bf16 v[112:115], v[228:231], v[128:131], v[112:115]
    v_mfma_f32_16x16x32_bf16 v[116:119], v[128:131], v[128:131], v[116:119]
    v_mfma_f32_16x16x32_bf16 v[120:123], v[228:231], v[144:147], v[120:123]
    v_mfma_f32_16x16x32_bf16 v[124:127], v[144:147], v[144:147], v[124:127]
    s_waitcnt vmcnt(1) lgkmcnt(0)
    s_barrier
    v_mfma_f32_16x16x32_bf16 v[32:35], v[184:187], v[164:167], v[32:35]
    v_mfma_f32_16x16x32_bf16 v[48:51], v[184:187], v[168:171], v[48:51]
    ds_read_b128 v[128:131], v208 offset:0
    v_mfma_f32_16x16x32_bf16 v[64:67], v[184:187], v[172:175], v[64:67]
    ds_read_b128 v[132:135], v209 offset:0
    v_mfma_f32_16x16x32_bf16 v[80:83], v[184:187], v[176:179], v[80:83]
    ds_read_b128 v[136:139], v210 offset:0
    v_mfma_f32_16x16x32_bf16 v[36:39], v[188:191], v[164:167], v[36:39]
    ds_read_b128 v[140:143], v211 offset:0
    v_mfma_f32_16x16x32_bf16 v[52:55], v[188:191], v[168:171], v[52:55]
    v_mfma_f32_16x16x32_bf16 v[68:71], v[188:191], v[172:175], v[68:71]
    ds_read_b128 v[144:147], v212 offset:0
    v_mfma_f32_16x16x32_bf16 v[84:87], v[188:191], v[176:179], v[84:87]
    ds_read_b64_tr_b16 v[148:149], v220 offset:30720
    v_mfma_f32_16x16x32_bf16 v[40:43], v[192:195], v[164:167], v[40:43]
    ds_read_b64_tr_b16 v[150:151], v220 offset:34560
    v_mfma_f32_16x16x32_bf16 v[56:59], v[192:195], v[168:171], v[56:59]
    ds_read_b64_tr_b16 v[152:153], v221 offset:30720
    v_mfma_f32_16x16x32_bf16 v[72:75], v[192:195], v[172:175], v[72:75]
    v_mfma_f32_16x16x32_bf16 v[88:91], v[192:195], v[176:179], v[88:91]
    ds_read_b64_tr_b16 v[154:155], v221 offset:34560
    v_mfma_f32_16x16x32_bf16 v[44:47], v[196:199], v[164:167], v[44:47]
    ds_read_b64_tr_b16 v[156:157], v222 offset:30720
    v_mfma_f32_16x16x32_bf16 v[60:63], v[196:199], v[168:171], v[60:63]
    ds_read_b64_tr_b16 v[158:159], v222 offset:34560
    v_mfma_f32_16x16x32_bf16 v[76:79], v[196:199], v[172:175], v[76:79]
    ds_read_b64_tr_b16 v[160:161], v223 offset:30720
    v_mfma_f32_16x16x32_bf16 v[92:95], v[196:199], v[176:179], v[92:95]
    ds_read_b64_tr_b16 v[162:163], v223 offset:34560
    v_mfma_f32_16x16x32_bf16 v[232:235], v[184:187], v[228:231], v[232:235]
    v_mfma_f32_16x16x32_bf16 v[236:239], v[188:191], v[228:231], v[236:239]
    v_mfma_f32_16x16x32_bf16 v[112:115], v[228:231], v[164:167], v[112:115]
    v_mfma_f32_16x16x32_bf16 v[116:119], v[164:167], v[164:167], v[116:119]
    v_mfma_f32_16x16x32_bf16 v[120:123], v[228:231], v[180:183], v[120:123]
    v_mfma_f32_16x16x32_bf16 v[124:127], v[180:183], v[180:183], v[124:127]
    s_waitcnt vmcnt(0) lgkmcnt(0)
    s_barrier
    v_mfma_f32_16x16x32_bf16 v[32:35], v[148:151], v[128:131], v[32:35]
    v_mfma_f32_16x16x32_bf16 v[48:51], v[148:151], v[132:135], v[48:51]
    ds_read_b128 v[164:167], v213 offset:0
    v_mfma_f32_16x16x32_bf16 v[64:67], v[148:151], v[136:139], v[64:67]
    ds_read_b128 v[168:171], v214 offset:0
    v_mfma_f32_16x16x32_bf16 v[80:83], v[148:151], v[140:143], v[80:83]
    ds_read_b128 v[172:175], v215 offset:0
    v_mfma_f32_16x16x32_bf16 v[36:39], v[152:155], v[128:131], v[36:39]
    ds_read_b128 v[176:179], v216 offset:0
    v_mfma_f32_16x16x32_bf16 v[52:55], v[152:155], v[132:135], v[52:55]
    v_mfma_f32_16x16x32_bf16 v[68:71], v[152:155], v[136:139], v[68:71]
    ds_read_b128 v[180:183], v217 offset:0
    v_mfma_f32_16x16x32_bf16 v[84:87], v[152:155], v[140:143], v[84:87]
    ds_read_b64_tr_b16 v[184:185], v220 offset:46080
    v_mfma_f32_16x16x32_bf16 v[40:43], v[156:159], v[128:131], v[40:43]
    ds_read_b64_tr_b16 v[186:187], v220 offset:49920
    v_mfma_f32_16x16x32_bf16 v[56:59], v[156:159], v[132:135], v[56:59]
    ds_read_b64_tr_b16 v[188:189], v221 offset:46080
    v_mfma_f32_16x16x32_bf16 v[72:75], v[156:159], v[136:139], v[72:75]
    v_mfma_f32_16x16x32_bf16 v[88:91], v[156:159], v[140:143], v[88:91]
    ds_read_b64_tr_b16 v[190:191], v221 offset:49920
    v_mfma_f32_16x16x32_bf16 v[44:47], v[160:163], v[128:131], v[44:47]
    ds_read_b64_tr_b16 v[192:193], v222 offset:46080
    v_mfma_f32_16x16x32_bf16 v[60:63], v[160:163], v[132:135], v[60:63]
    ds_read_b64_tr_b16 v[194:195], v222 offset:49920
    v_mfma_f32_16x16x32_bf16 v[76:79], v[160:163], v[136:139], v[76:79]
    ds_read_b64_tr_b16 v[196:197], v223 offset:46080
    v_mfma_f32_16x16x32_bf16 v[92:95], v[160:163], v[140:143], v[92:95]
    ds_read_b64_tr_b16 v[198:199], v223 offset:49920
    v_mfma_f32_16x16x32_bf16 v[232:235], v[148:151], v[228:231], v[232:235]
    v_mfma_f32_16x16x32_bf16 v[236:239], v[152:155], v[228:231], v[236:239]
    v_mfma_f32_16x16x32_bf16 v[112:115], v[228:231], v[128:131], v[112:115]
    v_mfma_f32_16x16x32_bf16 v[116:119], v[128:131], v[128:131], v[116:119]
    v_mfma_f32_16x16x32_bf16 v[120:123], v[228:231], v[144:147], v[120:123]
    v_mfma_f32_16x16x32_bf16 v[124:127], v[144:147], v[144:147], v[124:127]
    s_waitcnt lgkmcnt(0)
    v_mfma_f32_16x16x32_bf16 v[32:35], v[184:187], v[164:167], v[32:35]
    v_mfma_f32_16x16x32_bf16 v[48:51], v[184:187], v[168:171], v[48:51]
    v_mfma_f32_16x16x32_bf16 v[64:67], v[184:187], v[172:175], v[64:67]
    v_mfma_f32_16x16x32_bf16 v[80:83], v[184:187], v[176:179], v[80:83]
    v_mfma_f32_16x16x32_bf16 v[36:39], v[188:191], v[164:167], v[36:39]
    v_mfma_f32_16x16x32_bf16 v[52:55], v[188:191], v[168:171], v[52:55]
    v_mfma_f32_16x16x32_bf16 v[68:71], v[188:191], v[172:175], v[68:71]
    v_mfma_f32_16x16x32_bf16 v[84:87], v[188:191], v[176:179], v[84:87]
    v_mfma_f32_16x16x32_bf16 v[40:43], v[192:195], v[164:167], v[40:43]
    v_mfma_f32_16x16x32_bf16 v[56:59], v[192:195], v[168:171], v[56:59]
    v_mfma_f32_16x16x32_bf16 v[72:75], v[192:195], v[172:175], v[72:75]
    v_mfma_f32_16x16x32_bf16 v[88:91], v[192:195], v[176:179], v[88:91]
    v_mfma_f32_16x16x32_bf16 v[44:47], v[196:199], v[164:167], v[44:47]
    v_mfma_f32_16x16x32_bf16 v[60:63], v[196:199], v[168:171], v[60:63]
    v_mfma_f32_16x16x32_bf16 v[76:79], v[196:199], v[172:175], v[76:79]
    v_mfma_f32_16x16x32_bf16 v[92:95], v[196:199], v[176:179], v[92:95]
    v_mfma_f32_16x16x32_bf16 v[232:235], v[184:187], v[228:231], v[232:235]
    v_mfma_f32_16x16x32_bf16 v[236:239], v[188:191], v[228:231], v[236:239]
    v_mfma_f32_16x16x32_bf16 v[112:115], v[228:231], v[164:167], v[112:115]
    v_mfma_f32_16x16x32_bf16 v[116:119], v[164:167], v[164:167], v[116:119]
    v_mfma_f32_16x16x32_bf16 v[120:123], v[228:231], v[180:183], v[120:123]
    v_mfma_f32_16x16x32_bf16 v[124:127], v[180:183], v[180:183], v[124:127]
L_a_loopend:
    s_mov_b32 s16, 0xffff0000
    s_mov_b32 s17, 0x3acccccd
    s_nop 7
    v_lshrrev_b32 v21, 2, v6
    v_cmp_eq_u32 s[40:41], v21, v2
    v_and_b32 v21, 3, v6
    v_cmp_eq_u32 s[42:43], 1, v21
    v_cmp_eq_u32 s[44:45], 2, v21
    v_cmp_eq_u32 s[46:47], 3, v21
    s_nop 1
    v_mov_b32 v12, v112
    v_cndmask_b32 v13, v116, v117, s[42:43]
    v_cndmask_b32 v13, v13, v118, s[44:45]
    v_cndmask_b32 v13, v13, v119, s[46:47]
    v_cndmask_b32 v13, 0, v13, s[40:41]
    v_mov_b32 v20, v13
    s_nop 1
    v_permlane32_swap_b32 v13, v20
    s_nop 1
    v_add_f32 v13, v13, v20
    v_mov_b32 v20, v13
    s_nop 1
    v_permlane16_swap_b32 v13, v20
    s_nop 1
    v_add_f32 v13, v13, v20
    v_mov_b32 v16, v120
    v_cndmask_b32 v17, v124, v125, s[42:43]
    v_cndmask_b32 v17, v17, v126, s[44:45]
    v_cndmask_b32 v17, v17, v127, s[46:47]
    v_cndmask_b32 v17, 0, v17, s[40:41]
    v_mov_b32 v20, v17
    s_nop 1
    v_permlane32_swap_b32 v17, v20
    s_nop 1
    v_add_f32 v17, v17, v20
    v_mov_b32 v20, v17
    s_nop 1
    v_permlane16_swap_b32 v17, v20
    s_nop 1
    v_add_f32 v17, v17, v20
    v_mul_f32 v12, s17, v12
    v_mul_f32 v13, s17, v13
    v_fma_f32 v13, -v12, v12, v13
    v_max_f32 v13, 0, v13
    v_cvt_pk_bf16_f32 v20, v12, v13
    v_lshlrev_b32 v12, 16, v20
    v_and_b32 v13, s16, v20
    v_add_f32 v13, 0x3727c5ac, v13
    v_cvt_pk_bf16_f32 v20, v13, v13
    v_and_b32 v13, s16, v20
    v_sqrt_f32 v13, v13
    s_nop 0
    v_cvt_pk_bf16_f32 v20, v13, v13
    v_and_b32 v15, s16, v20
    v_rcp_f32 v20, v15
    s_nop 0
    v_fma_f32 v13, -v15, v20, 1.0
    v_fma_f32 v13, v13, v20, v20
    v_mul_f32 v14, 0xbfb8aa3b, v13
    v_mul_f32 v16, s17, v16
    v_mul_f32 v17, s17, v17
    v_fma_f32 v17, -v16, v16, v17
    v_max_f32 v17, 0, v17
    v_cvt_pk_bf16_f32 v20, v16, v17
    v_lshlrev_b32 v16, 16, v20
    v_and_b32 v17, s16, v20
    v_add_f32 v17, 0x3727c5ac, v17
    v_cvt_pk_bf16_f32 v20, v17, v17
    v_and_b32 v17, s16, v20
    v_sqrt_f32 v17, v17
    s_nop 0
    v_cvt_pk_bf16_f32 v20, v17, v17
    v_and_b32 v19, s16, v20
    v_rcp_f32 v20, v19
    s_nop 0
    v_fma_f32 v17, -v19, v20, 1.0
    v_fma_f32 v17, v17, v20, v20
    v_mul_f32 v18, 0xbfb8aa3b, v17
    v_lshl_add_u32 v20, v6, 4, s75
    ds_write_b128 v20, v[12:15]
    s_cmp_eq_u32 s36, 0
    s_cbranch_scc1 L_a_nos1
    v_lshl_add_u32 v20, v6, 4, s79
    ds_write_b128 v20, v[16:19]
    L_a_nos1:
    s_lshl_b32 s44, s37, 2
    s_lshl_b32 s46, s36, 1
    s_add_u32 s44, s44, s46
    s_lshl_b32 s44, s44, 6
    s_add_u32 s44, s44, 162304
    v_lshl_add_u32 v20, v2, 4, s44
    ds_write_b128 v20, v[232:235]
    ds_write_b128 v20, v[236:239] offset:64
    s_waitcnt lgkmcnt(0)
    s_barrier
    v_lshlrev_b32 v21, 4, v6
    v_add_u32 v20, s75, v21
    ds_read_b64 v[128:129], v20
    v_add_u32 v20, s76, v21
    ds_read_b64 v[130:131], v20
    v_add_u32 v20, s77, v21
    ds_read_b64 v[132:133], v20
    v_add_u32 v20, s78, v21
    ds_read_b64 v[134:135], v20
    v_add_u32 v20, s79, v21
    ds_read_b64 v[136:137], v20
    ds_read_b128 v[140:143], v224
    ds_read_b128 v[144:147], v225
    ds_read_b128 v[148:151], v226
    ds_read_b128 v[152:155], v227
    s_waitcnt lgkmcnt(0)
    v_pk_fma_f32 v[32:33], v[140:141], v[128:129], v[32:33] op_sel_hi:[1,0,1] neg_lo:[0,1,0] neg_hi:[0,1,0]
    v_pk_fma_f32 v[34:35], v[142:143], v[128:129], v[34:35] op_sel_hi:[1,0,1] neg_lo:[0,1,0] neg_hi:[0,1,0]
    v_pk_mul_f32 v[32:33], v[32:33], v[128:129] op_sel:[0,1] op_sel_hi:[1,1]
    v_pk_mul_f32 v[34:35], v[34:35], v[128:129] op_sel:[0,1] op_sel_hi:[1,1]
    v_cvt_pk_bf16_f32 v32, v32, v33
    v_cvt_pk_bf16_f32 v33, v34, v35
    v_add_u32 v34, s70, v200
    ds_write_b64 v34, v[32:33]
    v_pk_fma_f32 v[48:49], v[140:141], v[130:131], v[48:49] op_sel_hi:[1,0,1] neg_lo:[0,1,0] neg_hi:[0,1,0]
    v_pk_fma_f32 v[50:51], v[142:143], v[130:131], v[50:51] op_sel_hi:[1,0,1] neg_lo:[0,1,0] neg_hi:[0,1,0]
    v_pk_mul_f32 v[48:49], v[48:49], v[130:131] op_sel:[0,1] op_sel_hi:[1,1]
    v_pk_mul_f32 v[50:51], v[50:51], v[130:131] op_sel:[0,1] op_sel_hi:[1,1]
    v_cvt_pk_bf16_f32 v48, v48, v49
    v_cvt_pk_bf16_f32 v49, v50, v51
    v_add_u32 v50, s71, v200
    ds_write_b64 v50, v[48:49]
    v_pk_fma_f32 v[64:65], v[140:141], v[132:133], v[64:65] op_sel_hi:[1,0,1] neg_lo:[0,1,0] neg_hi:[0,1,0]
    v_pk_fma_f32 v[66:67], v[142:143], v[132:133], v[66:67] op_sel_hi:[1,0,1] neg_lo:[0,1,0] neg_hi:[0,1,0]
    v_pk_mul_f32 v[64:65], v[64:65], v[132:133] op_sel:[0,1] op_sel_hi:[1,1]
    v_pk_mul_f32 v[66:67], v[66:67], v[132:133] op_sel:[0,1] op_sel_hi:[1,1]
    v_cvt_pk_bf16_f32 v64, v64, v65
    v_cvt_pk_bf16_f32 v65, v66, v67
    v_add_u32 v66, s72, v200
    ds_write_b64 v66, v[64:65]
    v_pk_fma_f32 v[80:81], v[140:141], v[134:135], v[80:81] op_sel_hi:[1,0,1] neg_lo:[0,1,0] neg_hi:[0,1,0]
    v_pk_fma_f32 v[82:83], v[142:143], v[134:135], v[82:83] op_sel_hi:[1,0,1] neg_lo:[0,1,0] neg_hi:[0,1,0]
    v_pk_mul_f32 v[80:81], v[80:81], v[134:135] op_sel:[0,1] op_sel_hi:[1,1]
    v_pk_mul_f32 v[82:83], v[82:83], v[134:135] op_sel:[0,1] op_sel_hi:[1,1]
    v_cvt_pk_bf16_f32 v80, v80, v81
    v_cvt_pk_bf16_f32 v81, v82, v83
    v_add_u32 v82, s73, v200
    ds_write_b64 v82, v[80:81]
    s_cmp_eq_u32 s36, 0
    s_cbranch_scc0 L_g1_a_skip0
    v_pk_fma_f32 v[96:97], v[140:141], v[136:137], v[96:97] op_sel_hi:[1,0,1] neg_lo:[0,1,0] neg_hi:[0,1,0]
    v_pk_fma_f32 v[98:99], v[142:143], v[136:137], v[98:99] op_sel_hi:[1,0,1] neg_lo:[0,1,0] neg_hi:[0,1,0]
    v_pk_mul_f32 v[96:97], v[96:97], v[136:137] op_sel:[0,1] op_sel_hi:[1,1]
    v_pk_mul_f32 v[98:99], v[98:99], v[136:137] op_sel:[0,1] op_sel_hi:[1,1]
    v_cvt_pk_bf16_f32 v96, v96, v97
    v_cvt_pk_bf16_f32 v97, v98, v99
    v_add_u32 v98, s74, v200
    ds_write_b64 v98, v[96:97]
L_g1_a_skip0:
    s_cmp_eq_u32 s50, 15
    s_cbranch_scc1 L_g1_a_skip1
    v_pk_fma_f32 v[36:37], v[144:145], v[128:129], v[36:37] op_sel_hi:[1,0,1] neg_lo:[0,1,0] neg_hi:[0,1,0]
    v_pk_fma_f32 v[38:39], v[146:147], v[128:129], v[38:39] op_sel_hi:[1,0,1] neg_lo:[0,1,0] neg_hi:[0,1,0]
    v_pk_mul_f32 v[36:37], v[36:37], v[128:129] op_sel:[0,1] op_sel_hi:[1,1]
    v_pk_mul_f32 v[38:39], v[38:39], v[128:129] op_sel:[0,1] op_sel_hi:[1,1]
    v_cvt_pk_bf16_f32 v36, v36, v37
    v_cvt_pk_bf16_f32 v37, v38, v39
    v_add_u32 v38, s70, v201
    ds_write_b64 v38, v[36:37]
    v_pk_fma_f32 v[52:53], v[144:145], v[130:131], v[52:53] op_sel_hi:[1,0,1] neg_lo:[0,1,0] neg_hi:[0,1,0]
    v_pk_fma_f32 v[54:55], v[146:147], v[130:131], v[54:55] op_sel_hi:[1,0,1] neg_lo:[0,1,0] neg_hi:[0,1,0]
    v_pk_mul_f32 v[52:53], v[52:53], v[130:131] op_sel:[0,1] op_sel_hi:[1,1]
    v_pk_mul_f32 v[54:55], v[54:55], v[130:131] op_sel:[0,1] op_sel_hi:[1,1]
    v_cvt_pk_bf16_f32 v52, v52, v53
    v_cvt_pk_bf16_f32 v53, v54, v55
    v_add_u32 v54, s71, v201
    ds_write_b64 v54, v[52:53]
    v_pk_fma_f32 v[68:69], v[144:145], v[132:133], v[68:69] op_sel_hi:[1,0,1] neg_lo:[0,1,0] neg_hi:[0,1,0]
    v_pk_fma_f32 v[70:71], v[146:147], v[132:133], v[70:71] op_sel_hi:[1,0,1] neg_lo:[0,1,0] neg_hi:[0,1,0]
    v_pk_mul_f32 v[68:69], v[68:69], v[132:133] op_sel:[0,1] op_sel_hi:[1,1]
    v_pk_mul_f32 v[70:71], v[70:71], v[132:133] op_sel:[0,1] op_sel_hi:[1,1]
    v_cvt_pk_bf16_f32 v68, v68, v69
    v_cvt_pk_bf16_f32 v69, v70, v71
    v_add_u32 v70, s72, v201
    ds_write_b64 v70, v[68:69]
    v_pk_fma_f32 v[84:85], v[144:145], v[134:135], v[84:85] op_sel_hi:[1,0,1] neg_lo:[0,1,0] neg_hi:[0,1,0]
    v_pk_fma_f32 v[86:87], v[146:147], v[134:135], v[86:87] op_sel_hi:[1,0,1] neg_lo:[0,1,0] neg_hi:[0,1,0]
    v_pk_mul_f32 v[84:85], v[84:85], v[134:135] op_sel:[0,1] op_sel_hi:[1,1]
    v_pk_mul_f32 v[86:87], v[86:87], v[134:135] op_sel:[0,1] op_sel_hi:[1,1]
    v_cvt_pk_bf16_f32 v84, v84, v85
    v_cvt_pk_bf16_f32 v85, v86, v87
    v_add_u32 v86, s73, v201
    ds_write_b64 v86, v[84:85]
    s_cmp_eq_u32 s36, 0
    s_cbranch_scc0 L_g1_a_skip1
    v_pk_fma_f32 v[100:101], v[144:145], v[136:137], v[100:101] op_sel_hi:[1,0,1] neg_lo:[0,1,0] neg_hi:[0,1,0]
    v_pk_fma_f32 v[102:103], v[146:147], v[136:137], v[102:103] op_sel_hi:[1,0,1] neg_lo:[0,1,0] neg_hi:[0,1,0]
    v_pk_mul_f32 v[100:101], v[100:101], v[136:137] op_sel:[0,1] op_sel_hi:[1,1]
    v_pk_mul_f32 v[102:103], v[102:103], v[136:137] op_sel:[0,1] op_sel_hi:[1,1]
    v_cvt_pk_bf16_f32 v100, v100, v101
    v_cvt_pk_bf16_f32 v101, v102, v103
    v_add_u32 v102, s74, v201
    ds_write_b64 v102, v[100:101]
L_g1_a_skip1:
    v_pk_fma_f32 v[40:41], v[148:149], v[128:129], v[40:41] op_sel_hi:[1,0,1] neg_lo:[0,1,0] neg_hi:[0,1,0]
    v_pk_fma_f32 v[42:43], v[150:151], v[128:129], v[42:43] op_sel_hi:[1,0,1] neg_lo:[0,1,0] neg_hi:[0,1,0]
    v_pk_mul_f32 v[40:41], v[40:41], v[128:129] op_sel:[0,1] op_sel_hi:[1,1]
    v_pk_mul_f32 v[42:43], v[42:43], v[128:129] op_sel:[0,1] op_sel_hi:[1,1]
    v_cvt_pk_bf16_f32 v40, v40, v41
    v_cvt_pk_bf16_f32 v41, v42, v43
    v_add_u32 v42, s70, v202
    ds_write_b64 v42, v[40:41]
    v_pk_fma_f32 v[56:57], v[148:149], v[130:131], v[56:57] op_sel_hi:[1,0,1] neg_lo:[0,1,0] neg_hi:[0,1,0]
    v_pk_fma_f32 v[58:59], v[150:151], v[130:131], v[58:59] op_sel_hi:[1,0,1] neg_lo:[0,1,0] neg_hi:[0,1,0]
    v_pk_mul_f32 v[56:57], v[56:57], v[130:131] op_sel:[0,1] op_sel_hi:[1,1]
    v_pk_mul_f32 v[58:59], v[58:59], v[130:131] op_sel:[0,1] op_sel_hi:[1,1]
    v_cvt_pk_bf16_f32 v56, v56, v57
    v_cvt_pk_bf16_f32 v57, v58, v59
    v_add_u32 v58, s71, v202
    ds_write_b64 v58, v[56:57]
    v_pk_fma_f32 v[72:73], v[148:149], v[132:133], v[72:73] op_sel_hi:[1,0,1] neg_lo:[0,1,0] neg_hi:[0,1,0]
    v_pk_fma_f32 v[74:75], v[150:151], v[132:133], v[74:75] op_sel_hi:[1,0,1] neg_lo:[0,1,0] neg_hi:[0,1,0]
    v_pk_mul_f32 v[72:73], v[72:73], v[132:133] op_sel:[0,1] op_sel_hi:[1,1]
    v_pk_mul_f32 v[74:75], v[74:75], v[132:133] op_sel:[0,1] op_sel_hi:[1,1]
    v_cvt_pk_bf16_f32 v72, v72, v73
    v_cvt_pk_bf16_f32 v73, v74, v75
    v_add_u32 v74, s72, v202
    ds_write_b64 v74, v[72:73]
    v_pk_fma_f32 v[88:89], v[148:149], v[134:135], v[88:89] op_sel_hi:[1,0,1] neg_lo:[0,1,0] neg_hi:[0,1,0]
    v_pk_fma_f32 v[90:91], v[150:151], v[134:135], v[90:91] op_sel_hi:[1,0,1] neg_lo:[0,1,0] neg_hi:[0,1,0]
    v_pk_mul_f32 v[88:89], v[88:89], v[134:135] op_sel:[0,1] op_sel_hi:[1,1]
    v_pk_mul_f32 v[90:91], v[90:91], v[134:135] op_sel:[0,1] op_sel_hi:[1,1]
    v_cvt_pk_bf16_f32 v88, v88, v89
    v_cvt_pk_bf16_f32 v89, v90, v91
    v_add_u32 v90, s73, v202
    ds_write_b64 v90, v[88:89]
    s_cmp_eq_u32 s36, 0
    s_cbranch_scc0 L_g1_a_skip2
    v_pk_fma_f32 v[104:105], v[148:149], v[136:137], v[104:105] op_sel_hi:[1,0,1] neg_lo:[0,1,0] neg_hi:[0,1,0]
    v_pk_fma_f32 v[106:107], v[150:151], v[136:137], v[106:107] op_sel_hi:[1,0,1] neg_lo:[0,1,0] neg_hi:[0,1,0]
    v_pk_mul_f32 v[104:105], v[104:105], v[136:137] op_sel:[0,1] op_sel_hi:[1,1]
    v_pk_mul_f32 v[106:107], v[106:107], v[136:137] op_sel:[0,1] op_sel_hi:[1,1]
    v_cvt_pk_bf16_f32 v104, v104, v105
    v_cvt_pk_bf16_f32 v105, v106, v107
    v_add_u32 v106, s74, v202
    ds_write_b64 v106, v[104:105]
L_g1_a_skip2:
    s_cmp_eq_u32 s51, 15
    s_cbranch_scc1 L_g1_a_skip3
    v_pk_fma_f32 v[44:45], v[152:153], v[128:129], v[44:45] op_sel_hi:[1,0,1] neg_lo:[0,1,0] neg_hi:[0,1,0]
    v_pk_fma_f32 v[46:47], v[154:155], v[128:129], v[46:47] op_sel_hi:[1,0,1] neg_lo:[0,1,0] neg_hi:[0,1,0]
    v_pk_mul_f32 v[44:45], v[44:45], v[128:129] op_sel:[0,1] op_sel_hi:[1,1]
    v_pk_mul_f32 v[46:47], v[46:47], v[128:129] op_sel:[0,1] op_sel_hi:[1,1]
    v_cvt_pk_bf16_f32 v44, v44, v45
    v_cvt_pk_bf16_f32 v45, v46, v47
    v_add_u32 v46, s70, v203
    ds_write_b64 v46, v[44:45]
    v_pk_fma_f32 v[60:61], v[152:153], v[130:131], v[60:61] op_sel_hi:[1,0,1] neg_lo:[0,1,0] neg_hi:[0,1,0]
    v_pk_fma_f32 v[62:63], v[154:155], v[130:131], v[62:63] op_sel_hi:[1,0,1] neg_lo:[0,1,0] neg_hi:[0,1,0]
    v_pk_mul_f32 v[60:61], v[60:61], v[130:131] op_sel:[0,1] op_sel_hi:[1,1]
    v_pk_mul_f32 v[62:63], v[62:63], v[130:131] op_sel:[0,1] op_sel_hi:[1,1]
    v_cvt_pk_bf16_f32 v60, v60, v61
    v_cvt_pk_bf16_f32 v61, v62, v63
    v_add_u32 v62, s71, v203
    ds_write_b64 v62, v[60:61]
    v_pk_fma_f32 v[76:77], v[152:153], v[132:133], v[76:77] op_sel_hi:[1,0,1] neg_lo:[0,1,0] neg_hi:[0,1,0]
    v_pk_fma_f32 v[78:79], v[154:155], v[132:133], v[78:79] op_sel_hi:[1,0,1] neg_lo:[0,1,0] neg_hi:[0,1,0]
    v_pk_mul_f32 v[76:77], v[76:77], v[132:133] op_sel:[0,1] op_sel_hi:[1,1]
    v_pk_mul_f32 v[78:79], v[78:79], v[132:133] op_sel:[0,1] op_sel_hi:[1,1]
    v_cvt_pk_bf16_f32 v76, v76, v77
    v_cvt_pk_bf16_f32 v77, v78, v79
    v_add_u32 v78, s72, v203
    ds_write_b64 v78, v[76:77]
    v_pk_fma_f32 v[92:93], v[152:153], v[134:135], v[92:93] op_sel_hi:[1,0,1] neg_lo:[0,1,0] neg_hi:[0,1,0]
    v_pk_fma_f32 v[94:95], v[154:155], v[134:135], v[94:95] op_sel_hi:[1,0,1] neg_lo:[0,1,0] neg_hi:[0,1,0]
    v_pk_mul_f32 v[92:93], v[92:93], v[134:135] op_sel:[0,1] op_sel_hi:[1,1]
    v_pk_mul_f32 v[94:95], v[94:95], v[134:135] op_sel:[0,1] op_sel_hi:[1,1]
    v_cvt_pk_bf16_f32 v92, v92, v93
    v_cvt_pk_bf16_f32 v93, v94, v95
    v_add_u32 v94, s73, v203
    ds_write_b64 v94, v[92:93]
    s_cmp_eq_u32 s36, 0
    s_cbranch_scc0 L_g1_a_skip3
    v_pk_fma_f32 v[108:109], v[152:153], v[136:137], v[108:109] op_sel_hi:[1,0,1] neg_lo:[0,1,0] neg_hi:[0,1,0]
    v_pk_fma_f32 v[110:111], v[154:155], v[136:137], v[110:111] op_sel_hi:[1,0,1] neg_lo:[0,1,0] neg_hi:[0,1,0]
    v_pk_mul_f32 v[108:109], v[108:109], v[136:137] op_sel:[0,1] op_sel_hi:[1,1]
    v_pk_mul_f32 v[110:111], v[110:111], v[136:137] op_sel:[0,1] op_sel_hi:[1,1]
    v_cvt_pk_bf16_f32 v108, v108, v109
    v_cvt_pk_bf16_f32 v109, v110, v111
    v_add_u32 v110, s74, v203
    ds_write_b64 v110, v[108:109]
L_g1_a_skip3:
    s_waitcnt lgkmcnt(0)
    s_barrier
    ds_read_b64 v[72:73], v204 offset:0
    ds_read_b64 v[74:75], v204 offset:8
    ds_read_b64 v[76:77], v204 offset:15616
    ds_read_b64 v[78:79], v204 offset:15624
    ds_read_b64 v[80:81], v204 offset:31232
    ds_read_b64 v[82:83], v204 offset:31240
    ds_read_b64 v[84:85], v204 offset:46848
    ds_read_b64 v[86:87], v204 offset:46856
    ds_read_b64 v[32:33], v205 offset:160
    ds_read_b64 v[34:35], v205 offset:168
    ds_read_b64 v[36:37], v204 offset:160
    ds_read_b64 v[38:39], v204 offset:168
    ds_read_b64 v[40:41], v204 offset:15776
    ds_read_b64 v[42:43], v204 offset:15784
    ds_read_b64 v[44:45], v204 offset:31392
    ds_read_b64 v[46:47], v204 offset:31400
    ds_read_b64 v[48:49], v204 offset:47008
    ds_read_b64 v[50:51], v204 offset:47016
    ds_read_b64_tr_b16 v[52:53], v207 offset:320
    ds_read_b64_tr_b16 v[62:63], v207 offset:352
    ds_read_b64_tr_b16 v[54:55], v206 offset:320
    ds_read_b64_tr_b16 v[64:65], v206 offset:352
    ds_read_b64_tr_b16 v[56:57], v206 offset:15936
    ds_read_b64_tr_b16 v[66:67], v206 offset:15968
    ds_read_b64_tr_b16 v[58:59], v206 offset:31552
    ds_read_b64_tr_b16 v[68:69], v206 offset:31584
    ds_read_b64_tr_b16 v[60:61], v206 offset:47168
    ds_read_b64_tr_b16 v[70:71], v206 offset:47200
    s_cmp_eq_u32 s33, 0
    s_cselect_b64 s[60:61], 0, s[80:81]
    s_cselect_b64 s[62:63], 0, s[82:83]
    s_cselect_b64 s[64:65], 0, s[84:85]
    s_cselect_b64 s[66:67], 0, s[86:87]
    s_mov_b32 s18, 0x3ea52b5c
    s_mov_b32 s19, 0x3ea52b5c
    v_mov_b32 v29, 0xff800000
    s_waitcnt lgkmcnt(10)
    v_cndmask_b32 v72, 0, v72, s[38:39]
    v_cndmask_b32 v73, 0, v73, s[38:39]
    v_cndmask_b32 v74, 0, v74, s[96:97]
    v_cndmask_b32 v75, 0, v75, s[96:97]
    v_cndmask_b32 v76, 0, v76, s[38:39]
    v_cndmask_b32 v77, 0, v77, s[38:39]
    v_cndmask_b32 v78, 0, v78, s[96:97]
    v_cndmask_b32 v79, 0, v79, s[96:97]
    v_cndmask_b32 v80, 0, v80, s[38:39]
    v_cndmask_b32 v81, 0, v81, s[38:39]
    v_cndmask_b32 v82, 0, v82, s[96:97]
    v_cndmask_b32 v83, 0, v83, s[96:97]
    v_cndmask_b32 v84, 0, v84, s[38:39]
    v_cndmask_b32 v85, 0, v85, s[38:39]
    v_cndmask_b32 v86, 0, v86, s[96:97]
    v_cndmask_b32 v87, 0, v87, s[96:97]
    s_nop 1
    v_mfma_f32_16x16x32_bf16 v[88:91], v[32:35], v[72:75], 0
    v_mfma_f32_16x16x32_bf16 v[92:95], v[36:39], v[72:75], 0
    v_mfma_f32_16x16x32_bf16 v[96:99], v[36:39], v[76:79], 0
    v_mfma_f32_16x16x32_bf16 v[100:103], v[40:43], v[76:79], 0
    v_mfma_f32_16x16x32_bf16 v[104:107], v[40:43], v[80:83], 0
    v_mfma_f32_16x16x32_bf16 v[108:111], v[44:47], v[80:83], 0
    v_mfma_f32_16x16x32_bf16 v[112:115], v[44:47], v[84:87], 0
    v_mfma_f32_16x16x32_bf16 v[116:119], v[48:51], v[84:87], 0
    s_nop 7
    v_cndmask_b32 v88, v29, v88, s[60:61]
    v_cndmask_b32 v92, v29, v92, s[88:89]
    v_cndmask_b32 v89, v29, v89, s[62:63]
    v_cndmask_b32 v93, v29, v93, s[90:91]
    v_cndmask_b32 v90, v29, v90, s[64:65]
    v_cndmask_b32 v94, v29, v94, s[92:93]
    v_cndmask_b32 v91, v29, v91, s[66:67]
    v_cndmask_b32 v95, v29, v95, s[94:95]
    v_max3_f32 v24, v88, v89, v90
    v_max3_f32 v24, v24, v91, v92
    v_max3_f32 v24, v24, v93, v94
    v_max_f32 v24, v24, v95
    v_mov_b32 v25, v24
    s_nop 1
    v_permlane32_swap_b32 v24, v25
    s_nop 1
    v_max_f32 v24, v24, v25
    v_mov_b32 v25, v24
    s_nop 1
    v_permlane16_swap_b32 v24, v25
    s_nop 1
    v_max_f32 v24, v24, v25
    v_mul_f32 v24, s18, v24
    v_pk_fma_f32 v[88:89], v[88:89], s[18:19], v[24:25] op_sel_hi:[1,1,0] neg_lo:[0,0,1] neg_hi:[0,0,1]
    v_pk_fma_f32 v[90:91], v[90:91], s[18:19], v[24:25] op_sel_hi:[1,1,0] neg_lo:[0,0,1] neg_hi:[0,0,1]
    v_pk_fma_f32 v[92:93], v[92:93], s[18:19], v[24:25] op_sel_hi:[1,1,0] neg_lo:[0,0,1] neg_hi:[0,0,1]
    v_pk_fma_f32 v[94:95], v[94:95], s[18:19], v[24:25] op_sel_hi:[1,1,0] neg_lo:[0,0,1] neg_hi:[0,0,1]
    v_exp_f32 v88, v88
    v_exp_f32 v89, v89
    v_exp_f32 v90, v90
    v_exp_f32 v91, v91
    v_exp_f32 v92, v92
    v_exp_f32 v93, v93
    v_exp_f32 v94, v94
    v_exp_f32 v95, v95
    s_nop 0
    v_pk_add_f32 v[24:25], v[88:89], v[90:91]
    v_pk_add_f32 v[30:31], v[92:93], v[94:95]
    v_pk_add_f32 v[24:25], v[24:25], v[30:31]
    v_add_f32 v24, v24, v25
    v_mov_b32 v25, v24
    s_nop 1
    v_permlane32_swap_b32 v24, v25
    s_nop 1
    v_add_f32 v24, v24, v25
    v_mov_b32 v25, v24
    s_nop 1
    v_permlane16_swap_b32 v24, v25
    s_nop 1
    v_add_f32 v24, v24, v25
    v_rcp_f32 v24, v24
    s_nop 0
    v_pk_mul_f32 v[88:89], v[88:89], v[24:25] op_sel_hi:[1,0]
    v_pk_mul_f32 v[90:91], v[90:91], v[24:25] op_sel_hi:[1,0]
    v_pk_mul_f32 v[92:93], v[92:93], v[24:25] op_sel_hi:[1,0]
    v_pk_mul_f32 v[94:95], v[94:95], v[24:25] op_sel_hi:[1,0]
    v_cvt_pk_bf16_f32 v120, v88, v89
    v_cvt_pk_bf16_f32 v121, v90, v91
    v_cvt_pk_bf16_f32 v122, v92, v93
    v_cvt_pk_bf16_f32 v123, v94, v95
    v_cndmask_b32 v96, v29, v96, s[80:81]
    v_cndmask_b32 v100, v29, v100, s[88:89]
    v_cndmask_b32 v97, v29, v97, s[82:83]
    v_cndmask_b32 v101, v29, v101, s[90:91]
    v_cndmask_b32 v98, v29, v98, s[84:85]
    v_cndmask_b32 v102, v29, v102, s[92:93]
    v_cndmask_b32 v99, v29, v99, s[86:87]
    v_cndmask_b32 v103, v29, v103, s[94:95]
    v_max3_f32 v26, v96, v97, v98
    v_max3_f32 v26, v26, v99, v100
    v_max3_f32 v26, v26, v101, v102
    v_max_f32 v26, v26, v103
    v_mov_b32 v27, v26
    s_nop 1
    v_permlane32_swap_b32 v26, v27
    s_nop 1
    v_max_f32 v26, v26, v27
    v_mov_b32 v27, v26
    s_nop 1
    v_permlane16_swap_b32 v26, v27
    s_nop 1
    v_max_f32 v26, v26, v27
    v_mul_f32 v26, s18, v26
    v_pk_fma_f32 v[96:97], v[96:97], s[18:19], v[26:27] op_sel_hi:[1,1,0] neg_lo:[0,0,1] neg_hi:[0,0,1]
    v_pk_fma_f32 v[98:99], v[98:99], s[18:19], v[26:27] op_sel_hi:[1,1,0] neg_lo:[0,0,1] neg_hi:[0,0,1]
    v_pk_fma_f32 v[100:101], v[100:101], s[18:19], v[26:27] op_sel_hi:[1,1,0] neg_lo:[0,0,1] neg_hi:[0,0,1]
    v_pk_fma_f32 v[102:103], v[102:103], s[18:19], v[26:27] op_sel_hi:[1,1,0] neg_lo:[0,0,1] neg_hi:[0,0,1]
    v_exp_f32 v96, v96
    v_exp_f32 v97, v97
    v_exp_f32 v98, v98
    v_exp_f32 v99, v99
    v_exp_f32 v100, v100
    v_exp_f32 v101, v101
    v_exp_f32 v102, v102
    v_exp_f32 v103, v103
    s_nop 0
    v_pk_add_f32 v[26:27], v[96:97], v[98:99]
    v_pk_add_f32 v[30:31], v[100:101], v[102:103]
    v_pk_add_f32 v[26:27], v[26:27], v[30:31]
    v_add_f32 v26, v26, v27
    v_mov_b32 v27, v26
    s_nop 1
    v_permlane32_swap_b32 v26, v27
    s_nop 1
    v_add_f32 v26, v26, v27
    v_mov_b32 v27, v26
    s_nop 1
    v_permlane16_swap_b32 v26, v27
    s_nop 1
    v_add_f32 v26, v26, v27
    v_rcp_f32 v26, v26
    s_nop 0
    v_pk_mul_f32 v[96:97], v[96:97], v[26:27] op_sel_hi:[1,0]
    v_pk_mul_f32 v[98:99], v[98:99], v[26:27] op_sel_hi:[1,0]
    v_pk_mul_f32 v[100:101], v[100:101], v[26:27] op_sel_hi:[1,0]
    v_pk_mul_f32 v[102:103], v[102:103], v[26:27] op_sel_hi:[1,0]
    v_cvt_pk_bf16_f32 v124, v96, v97
    v_cvt_pk_bf16_f32 v125, v98, v99
    v_cvt_pk_bf16_f32 v126, v100, v101
    v_cvt_pk_bf16_f32 v127, v102, v103
    v_cndmask_b32 v104, v29, v104, s[80:81]
    v_cndmask_b32 v108, v29, v108, s[88:89]
    v_cndmask_b32 v105, v29, v105, s[82:83]
    v_cndmask_b32 v109, v29, v109, s[90:91]
    v_cndmask_b32 v106, v29, v106, s[84:85]
    v_cndmask_b32 v110, v29, v110, s[92:93]
    v_cndmask_b32 v107, v29, v107, s[86:87]
    v_cndmask_b32 v111, v29, v111, s[94:95]
    v_max3_f32 v24, v104, v105, v106
    v_max3_f32 v24, v24, v107, v108
    v_max3_f32 v24, v24, v109, v110
    v_max_f32 v24, v24, v111
    v_mov_b32 v25, v24
    s_nop 1
    v_permlane32_swap_b32 v24, v25
    s_nop 1
    v_max_f32 v24, v24, v25
    v_mov_b32 v25, v24
    s_nop 1
    v_permlane16_swap_b32 v24, v25
    s_nop 1
    v_max_f32 v24, v24, v25
    v_mul_f32 v24, s18, v24
    v_pk_fma_f32 v[104:105], v[104:105], s[18:19], v[24:25] op_sel_hi:[1,1,0] neg_lo:[0,0,1] neg_hi:[0,0,1]
    v_pk_fma_f32 v[106:107], v[106:107], s[18:19], v[24:25] op_sel_hi:[1,1,0] neg_lo:[0,0,1] neg_hi:[0,0,1]
    v_pk_fma_f32 v[108:109], v[108:109], s[18:19], v[24:25] op_sel_hi:[1,1,0] neg_lo:[0,0,1] neg_hi:[0,0,1]
    v_pk_fma_f32 v[110:111], v[110:111], s[18:19], v[24:25] op_sel_hi:[1,1,0] neg_lo:[0,0,1] neg_hi:[0,0,1]
    v_exp_f32 v104, v104
    v_exp_f32 v105, v105
    v_exp_f32 v106, v106
    v_exp_f32 v107, v107
    v_exp_f32 v108, v108
    v_exp_f32 v109, v109
    v_exp_f32 v110, v110
    v_exp_f32 v111, v111
    s_nop 0
    v_pk_add_f32 v[24:25], v[104:105], v[106:107]
    v_pk_add_f32 v[30:31], v[108:109], v[110:111]
    v_pk_add_f32 v[24:25], v[24:25], v[30:31]
    v_add_f32 v24, v24, v25
    v_mov_b32 v25, v24
    s_nop 1
    v_permlane32_swap_b32 v24, v25
    s_nop 1
    v_add_f32 v24, v24, v25
    v_mov_b32 v25, v24
    s_nop 1
    v_permlane16_swap_b32 v24, v25
    s_nop 1
    v_add_f32 v24, v24, v25
    v_rcp_f32 v24, v24
    s_nop 0
    v_pk_mul_f32 v[104:105], v[104:105], v[24:25] op_sel_hi:[1,0]
    v_pk_mul_f32 v[106:107], v[106:107], v[24:25] op_sel_hi:[1,0]
    v_pk_mul_f32 v[108:109], v[108:109], v[24:25] op_sel_hi:[1,0]
    v_pk_mul_f32 v[110:111], v[110:111], v[24:25] op_sel_hi:[1,0]
    v_cvt_pk_bf16_f32 v128, v104, v105
    v_cvt_pk_bf16_f32 v129, v106, v107
    v_cvt_pk_bf16_f32 v130, v108, v109
    v_cvt_pk_bf16_f32 v131, v110, v111
    v_cndmask_b32 v112, v29, v112, s[80:81]
    v_cndmask_b32 v116, v29, v116, s[88:89]
    v_cndmask_b32 v113, v29, v113, s[82:83]
    v_cndmask_b32 v117, v29, v117, s[90:91]
    v_cndmask_b32 v114, v29, v114, s[84:85]
    v_cndmask_b32 v118, v29, v118, s[92:93]
    v_cndmask_b32 v115, v29, v115, s[86:87]
    v_cndmask_b32 v119, v29, v119, s[94:95]
    v_max3_f32 v26, v112, v113, v114
    v_max3_f32 v26, v26, v115, v116
    v_max3_f32 v26, v26, v117, v118
    v_max_f32 v26, v26, v119
    v_mov_b32 v27, v26
    s_nop 1
    v_permlane32_swap_b32 v26, v27
    s_nop 1
    v_max_f32 v26, v26, v27
    v_mov_b32 v27, v26
    s_nop 1
    v_permlane16_swap_b32 v26, v27
    s_nop 1
    v_max_f32 v26, v26, v27
    v_mul_f32 v26, s18, v26
    v_pk_fma_f32 v[112:113], v[112:113], s[18:19], v[26:27] op_sel_hi:[1,1,0] neg_lo:[0,0,1] neg_hi:[0,0,1]
    v_pk_fma_f32 v[114:115], v[114:115], s[18:19], v[26:27] op_sel_hi:[1,1,0] neg_lo:[0,0,1] neg_hi:[0,0,1]
    v_pk_fma_f32 v[116:117], v[116:117], s[18:19], v[26:27] op_sel_hi:[1,1,0] neg_lo:[0,0,1] neg_hi:[0,0,1]
    v_pk_fma_f32 v[118:119], v[118:119], s[18:19], v[26:27] op_sel_hi:[1,1,0] neg_lo:[0,0,1] neg_hi:[0,0,1]
    v_exp_f32 v112, v112
    v_exp_f32 v113, v113
    v_exp_f32 v114, v114
    v_exp_f32 v115, v115
    v_exp_f32 v116, v116
    v_exp_f32 v117, v117
    v_exp_f32 v118, v118
    v_exp_f32 v119, v119
    s_nop 0
    v_pk_add_f32 v[26:27], v[112:113], v[114:115]
    v_pk_add_f32 v[30:31], v[116:117], v[118:119]
    v_pk_add_f32 v[26:27], v[26:27], v[30:31]
    v_add_f32 v26, v26, v27
    v_mov_b32 v27, v26
    s_nop 1
    v_permlane32_swap_b32 v26, v27
    s_nop 1
    v_add_f32 v26, v26, v27
    v_mov_b32 v27, v26
    s_nop 1
    v_permlane16_swap_b32 v26, v27
    s_nop 1
    v_add_f32 v26, v26, v27
    v_rcp_f32 v26, v26
    s_nop 0
    v_pk_mul_f32 v[112:113], v[112:113], v[26:27] op_sel_hi:[1,0]
    v_pk_mul_f32 v[114:115], v[114:115], v[26:27] op_sel_hi:[1,0]
    v_pk_mul_f32 v[116:117], v[116:117], v[26:27] op_sel_hi:[1,0]
    v_pk_mul_f32 v[118:119], v[118:119], v[26:27] op_sel_hi:[1,0]
    v_cvt_pk_bf16_f32 v132, v112, v113
    v_cvt_pk_bf16_f32 v133, v114, v115
    v_cvt_pk_bf16_f32 v134, v116, v117
    v_cvt_pk_bf16_f32 v135, v118, v119
    s_waitcnt lgkmcnt(0)
    s_nop 1
    v_mfma_f32_16x16x32_bf16 v[136:139], v[52:55], v[120:123], 0
    v_mfma_f32_16x16x32_bf16 v[140:143], v[62:65], v[120:123], 0
    v_mfma_f32_16x16x32_bf16 v[144:147], v[54:57], v[124:127], 0
    v_mfma_f32_16x16x32_bf16 v[148:151], v[64:67], v[124:127], 0
    v_mfma_f32_16x16x32_bf16 v[152:155], v[56:59], v[128:131], 0
    v_mfma_f32_16x16x32_bf16 v[156:159], v[66:69], v[128:131], 0
    v_mfma_f32_16x16x32_bf16 v[160:163], v[58:61], v[132:135], 0
    v_mfma_f32_16x16x32_bf16 v[164:167], v[68:71], v[132:135], 0
    s_nop 7
    v_cvt_pk_bf16_f32 v136, v136, v137
    v_cvt_pk_bf16_f32 v137, v138, v139
    v_cvt_pk_bf16_f32 v140, v140, v141
    v_cvt_pk_bf16_f32 v141, v142, v143
    s_mov_b32 s44, 0
    buffer_store_dwordx2 v[136:137], v218, s[12:15], s44 offen
    v_cvt_pk_bf16_f32 v144, v144, v145
    v_cvt_pk_bf16_f32 v145, v146, v147
    v_cvt_pk_bf16_f32 v148, v148, v149
    v_cvt_pk_bf16_f32 v149, v150, v151
    s_mov_b32 s44, 139264
    buffer_store_dwordx2 v[144:145], v218, s[12:15], s44 offen
    v_cvt_pk_bf16_f32 v152, v152, v153
    v_cvt_pk_bf16_f32 v153, v154, v155
    v_cvt_pk_bf16_f32 v156, v156, v157
    v_cvt_pk_bf16_f32 v157, v158, v159
    s_mov_b32 s44, 278528
    buffer_store_dwordx2 v[152:153], v218, s[12:15], s44 offen
    v_cvt_pk_bf16_f32 v160, v160, v161
    v_cvt_pk_bf16_f32 v161, v162, v163
    v_cvt_pk_bf16_f32 v164, v164, v165
    v_cvt_pk_bf16_f32 v165, v166, v167
    s_mov_b32 s44, 417792
    buffer_store_dwordx2 v[160:161], v218, s[12:15], s44 offen
    s_mov_b64 exec, 0xffff
    s_mov_b32 s44, 0
    buffer_store_dwordx2 v[140:141], v219, s[12:15], s44 offen
    s_mov_b32 s44, 139264
    buffer_store_dwordx2 v[148:149], v219, s[12:15], s44 offen
    s_mov_b32 s44, 278528
    buffer_store_dwordx2 v[156:157], v219, s[12:15], s44 offen
    s_mov_b32 s44, 417792
    buffer_store_dwordx2 v[164:165], v219, s[12:15], s44 offen
    s_mov_b64 exec, -1
L_g1_done:
    s_endpgm
    L_a_s4_a_0_o:
    s_add_u32 m0, s42, 10240
    s_nop 0
    buffer_load_dwordx4 v19, s[28:31], s47 offen lds
    s_branch L_a_s4_a_0
    L_a_s4_a_2_o:
    s_add_u32 m0, s42, 28672
    s_nop 0
    buffer_load_dwordx4 v19, s[28:31], s47 offen lds
    s_branch L_a_s4_a_2
    L_a_s4_a0_4_o:
    s_add_u32 m0, s42, 47104
    s_nop 0
    buffer_load_dwordx4 v19, s[28:31], s47 offen lds
    s_branch L_a_s4_a0_4
    L_a_s4_a0_6_o:
    s_add_u32 m0, s42, 10240
    s_nop 0
    buffer_load_dwordx4 v19, s[28:31], s47 offen lds
    s_branch L_a_s4_a0_6
    L_a_s4_a0_8_o:
    s_add_u32 m0, s42, 28672
    s_nop 0
    buffer_load_dwordx4 v19, s[28:31], s47 offen lds
    s_branch L_a_s4_a0_8
    L_a_s4_a0_10_o:
    s_add_u32 m0, s42, 47104
    s_nop 0
    buffer_load_dwordx4 v19, s[28:31], s47 offen lds
    s_branch L_a_s4_a0_10
    L_a_s4_a0_12_o:
    s_add_u32 m0, s42, 10240
    s_nop 0
    buffer_load_dwordx4 v19, s[28:31], s47 offen lds
    s_branch L_a_s4_a0_12
    L_a_s4_a0_14_o:
    s_add_u32 m0, s42, 28672
    s_nop 0
    buffer_load_dwordx4 v19, s[28:31], s47 offen lds
    s_branch L_a_s4_a0_14
    L_a_s4_a0_16_o:
    s_add_u32 m0, s42, 47104
    s_nop 0
    buffer_load_dwordx4 v19, s[28:31], s47 offen lds
    s_branch L_a_s4_a0_16
    L_a_s4_a0_18_o:
    s_add_u32 m0, s42, 10240
    s_nop 0
    buffer_load_dwordx4 v19, s[28:31], s47 offen lds
    s_branch L_a_s4_a0_18
    L_a_s4_a1_4_o:
    s_add_u32 m0, s42, 47104
    s_nop 0
    buffer_load_dwordx4 v19, s[28:31], s47 offen lds
    s_branch L_a_s4_a1_4
    L_a_s4_a1_6_o:
    s_add_u32 m0, s42, 10240
    s_nop 0
    buffer_load_dwordx4 v19, s[28:31], s47 offen lds
    s_branch L_a_s4_a1_6
    L_a_s4_a1_8_o:
    s_add_u32 m0, s42, 28672
    s_nop 0
    buffer_load_dwordx4 v19, s[28:31], s47 offen lds
    s_branch L_a_s4_a1_8
    L_a_s4_a1_10_o:
    s_add_u32 m0, s42, 47104
    s_nop 0
    buffer_load_dwordx4 v19, s[28:31], s47 offen lds
    s_branch L_a_s4_a1_10
    L_a_s4_a1_12_o:
    s_add_u32 m0, s42, 10240
    s_nop 0
    buffer_load_dwordx4 v19, s[28:31], s47 offen lds
    s_branch L_a_s4_a1_12
    L_a_s4_a1_14_o:
    s_add_u32 m0, s42, 28672
    s_nop 0
    buffer_load_dwordx4 v19, s[28:31], s47 offen lds
    s_branch L_a_s4_a1_14
    L_a_s4_a1_16_o:
    s_add_u32 m0, s42, 47104
    s_nop 0
    buffer_load_dwordx4 v19, s[28:31], s47 offen lds
    s_branch L_a_s4_a1_16
    L_a_s4_a1_18_o:
    s_add_u32 m0, s42, 10240
    s_nop 0
    buffer_load_dwordx4 v19, s[28:31], s47 offen lds
    s_branch L_a_s4_a1_18
L_g1_glu:
    s_mov_b32 s16, s8
    s_mov_b32 s17, s9
    s_mov_b32 s18, 1966080
    s_mov_b32 s19, 0x00020000
    s_mov_b32 s20, s10
    s_mov_b32 s21, s11
    s_mov_b32 s22, 1966080
    s_mov_b32 s23, 0x00020000
    s_cmp_lt_u32 s32, 4
    s_cselect_b32 s24, s8, s10
    s_cselect_b32 s25, s9, s11
    s_mov_b32 s26, 1966080
    s_mov_b32 s27, 0x00020000
    s_mov_b32 s43, 12288
    s_cselect_b32 s43, 0, s43
    s_lshl_b32 s40, s32, 10
    s_add_u32 s41, s40, 49152
    s_add_u32 s42, s40, 61440
    s_lshl_b32 s44, s37, 10
    s_add_u32 s43, s43, s44
    s_add_u32 s43, s43, 57344
    s_lshl_b32 s44, s33, 4
    s_add_u32 s44, s44, s32
    s_mul_i32 s44, s44, 10240
    v_add_u32 v10, s44, v7
    v_add_u32 v11, 81920, v10
    s_mul_i32 s45, s34, 384
    s_lshl_b32 s44, s32, 6
    v_add_u32 v20, s44, v0
    v_mul_u32_u24 v21, 1366, v20
    v_lshrrev_b32 v21, 16, v21
    v_mul_u32_u24 v22, 48, v21
    v_sub_u32 v22, v20, v22
    v_and_b32 v23, 7, v21
    v_lshlrev_b32 v23, 1, v23
    v_xor_b32 v22, v22, v23
    v_cmp_le_u32 vcc, 24, v22
    s_nop 1
    v_cndmask_b32 v23, 0, 1, vcc
    v_mul_u32_u24 v24, 24, v23
    v_sub_u32 v22, v22, v24
    v_lshl_add_u32 v21, v23, 4, v21
    v_lshrrev_b32 v25, 1, v21
    v_and_b32 v25, 4, v25
    v_lshlrev_b32 v26, 1, v21
    v_and_b32 v26, 8, v26
    v_and_b32 v24, 0x13, v21
    v_or3_b32 v24, v24, v25, v26
    v_mul_u32_u24 v24, 3072, v24
    v_lshl_add_u32 v24, v22, 4, v24
    v_add_u32 v12, s45, v24
    s_add_u32 s46, s37, 8
    s_lshl_b32 s44, s46, 6
    v_add_u32 v20, s44, v0
    v_mul_u32_u24 v21, 1366, v20
    v_lshrrev_b32 v21, 16, v21
    v_mul_u32_u24 v22, 48, v21
    v_sub_u32 v22, v20, v22
    v_and_b32 v23, 7, v21
    v_lshlrev_b32 v23, 1, v23
    v_xor_b32 v22, v22, v23
    v_cmp_le_u32 vcc, 24, v22
    s_nop 1
    v_cndmask_b32 v23, 0, 1, vcc
    v_mul_u32_u24 v24, 24, v23
    v_sub_u32 v22, v22, v24
    v_lshl_add_u32 v21, v23, 4, v21
    v_lshrrev_b32 v25, 1, v21
    v_and_b32 v25, 4, v25
    v_lshlrev_b32 v26, 1, v21
    v_and_b32 v26, 8, v26
    v_and_b32 v24, 0x13, v21
    v_or3_b32 v24, v24, v25, v26
    v_mul_u32_u24 v24, 3072, v24
    v_lshl_add_u32 v24, v22, 4, v24
    v_add_u32 v13, s45, v24
    s_mov_b32 s47, 0
    s_mov_b32 s48, 0
    s_add_u32 m0, s40, 0
    s_nop 0
    buffer_load_dwordx4 v10, s[28:31], s47 offen lds
    s_add_u32 m0, s40, 8192
    s_nop 0
    buffer_load_dwordx4 v11, s[28:31], s47 offen lds
    s_add_u32 s47, s47, 128
    s_add_u32 m0, s41, 0
    s_nop 0
    buffer_load_dwordx4 v12, s[16:19], s48 offen lds
    s_add_u32 m0, s42, 0
    s_nop 0
    buffer_load_dwordx4 v12, s[20:23], s48 offen lds
    s_add_u32 m0, s43, 0
    s_nop 0
    buffer_load_dwordx4 v13, s[24:27], s48 offen lds
    s_add_u32 s48, s48, 98304
    s_add_u32 m0, s41, 24576
    s_nop 0
    buffer_load_dwordx4 v12, s[16:19], s48 offen lds
    s_add_u32 m0, s42, 24576
    s_nop 0
    buffer_load_dwordx4 v12, s[20:23], s48 offen lds
    s_add_u32 m0, s43, 24576
    s_nop 0
    buffer_load_dwordx4 v13, s[24:27], s48 offen lds
    s_add_u32 s48, s48, 98304
    s_add_u32 m0, s40, 16384
    s_nop 0
    buffer_load_dwordx4 v10, s[28:31], s47 offen lds
    s_add_u32 m0, s40, 24576
    s_nop 0
    buffer_load_dwordx4 v11, s[28:31], s47 offen lds
    s_add_u32 s47, s47, 128
    s_add_u32 m0, s41, 49152
    s_nop 0
    buffer_load_dwordx4 v12, s[16:19], s48 offen lds
    s_add_u32 m0, s42, 49152
    s_nop 0
    buffer_load_dwordx4 v12, s[20:23], s48 offen lds
    s_add_u32 m0, s43, 49152
    s_nop 0
    buffer_load_dwordx4 v13, s[24:27], s48 offen lds
    s_add_u32 s48, s48, 98304
    s_add_u32 m0, s41, 73728
    s_nop 0
    buffer_load_dwordx4 v12, s[16:19], s48 offen lds
    s_add_u32 m0, s42, 73728
    s_nop 0
    buffer_load_dwordx4 v12, s[20:23], s48 offen lds
    s_add_u32 m0, s43, 73728
    s_nop 0
    buffer_load_dwordx4 v13, s[24:27], s48 offen lds
    s_add_u32 s48, s48, 98304
    s_add_u32 s44, s37, 0
    s_and_b32 s44, s44, 3
    s_lshl_b32 s46, s36, 2
    s_add_u32 s44, s44, s46
    s_lshl_b32 s44, s44, 11
    v_add_u32 v208, s44, v8
    v_xor_b32 v212, 64, v208
    s_add_u32 s44, s37, 1
    s_and_b32 s44, s44, 3
    s_lshl_b32 s46, s36, 2
    s_add_u32 s44, s44, s46
    s_lshl_b32 s44, s44, 11
    v_add_u32 v209, s44, v8
    v_xor_b32 v213, 64, v209
    s_add_u32 s44, s37, 2
    s_and_b32 s44, s44, 3
    s_lshl_b32 s46, s36, 2
    s_add_u32 s44, s44, s46
    s_lshl_b32 s44, s44, 11
    v_add_u32 v210, s44, v8
    v_xor_b32 v214, 64, v210
    s_add_u32 s44, s37, 3
    s_and_b32 s44, s44, 3
    s_lshl_b32 s46, s36, 2
    s_add_u32 s44, s44, s46
    s_lshl_b32 s44, s44, 11
    v_add_u32 v211, s44, v8
    v_xor_b32 v215, 64, v211
    v_and_b32 v20, 7, v9
    v_lshrrev_b32 v21, 1, v2
    v_mul_u32_u24 v21, 12, v21
    s_mul_i32 s44, s37, 3
    v_add_u32 v21, s44, v21
    v_mul_u32_u24 v22, 768, v20
    v_lshl_add_u32 v22, v4, 3, v22
    v_add_u32 v22, 49152, v22
    s_mul_i32 s44, s36, 12288
    s_sub_u32 s46, 12288, s44
    v_add_u32 v23, 0, v21
    v_xor_b32 v23, v23, v20
    v_lshl_add_u32 v23, v23, 5, v22
    v_add_u32 v216, s44, v23
    v_add_u32 v219, s46, v23
    v_add_u32 v222, 49152, v216
    v_add_u32 v225, 49152, v219
    v_add_u32 v23, 1, v21
    v_xor_b32 v23, v23, v20
    v_lshl_add_u32 v23, v23, 5, v22
    v_add_u32 v217, s44, v23
    v_add_u32 v220, s46, v23
    v_add_u32 v223, 49152, v217
    v_add_u32 v226, 49152, v220
    v_add_u32 v23, 2, v21
    v_xor_b32 v23, v23, v20
    v_lshl_add_u32 v23, v23, 5, v22
    v_add_u32 v218, s44, v23
    v_add_u32 v221, s46, v23
    v_add_u32 v224, 49152, v218
    v_add_u32 v227, 49152, v221
    s_lshl_b32 s44, s33, 1
    v_and_b32 v14, 1, v0
    v_add_u32 v14, s44, v14
    v_mul_u32_u24 v14, 3072, v14
    v_bfe_u32 v20, v0, 1, 2
    v_min_u32 v20, 2, v20
    v_lshl_add_u32 v14, v20, 7, v14
    v_add_u32 v14, s45, v14
    s_lshl_b32 s44, s33, 7
    v_add_u32 v15, s44, v0
    v_mul_u32_u24 v15, 1280, v15
    s_waitcnt vmcnt(11)
    s_barrier
    ds_read_b128 v[128:131], v208 offset:0
    ds_read_b128 v[132:135], v209 offset:0
    ds_read_b128 v[136:139], v210 offset:0
    ds_read_b128 v[140:143], v211 offset:0
    ds_read_b64_tr_b16 v[144:145], v216 offset:0
    ds_read_b64_tr_b16 v[146:147], v216 offset:6144
    ds_read_b64_tr_b16 v[148:149], v217 offset:0
    ds_read_b64_tr_b16 v[150:151], v217 offset:6144
    ds_read_b64_tr_b16 v[152:153], v218 offset:0
    ds_read_b64_tr_b16 v[154:155], v218 offset:6144
    ds_read_b64_tr_b16 v[156:157], v219 offset:0
    ds_read_b64_tr_b16 v[158:159], v219 offset:6144
    ds_read_b64_tr_b16 v[160:161], v220 offset:0
    ds_read_b64_tr_b16 v[162:163], v220 offset:6144
    ds_read_b64_tr_b16 v[164:165], v221 offset:0
    ds_read_b64_tr_b16 v[166:167], v221 offset:6144
    s_waitcnt vmcnt(8) lgkmcnt(0)
    s_barrier
    s_mul_i32 s44, s33, 12
    s_add_u32 s44, s44, 128
    v_min_u32 v20, 11, v0
    v_add_u32 v20, s44, v20
    v_mul_u32_u24 v20, 3072, v20
    v_add_u32 v20, s45, v20
    s_cmp_eq_u32 s32, 0
    s_cbranch_scc0 L_tlb_g0_0
    buffer_load_dword v244, v20, s[16:19], 0 offen offset:0
L_tlb_g0_0:
    s_cmp_eq_u32 s32, 1
    s_cbranch_scc0 L_tlb_g1_0
    buffer_load_dword v244, v20, s[20:23], 0 offen offset:0
L_tlb_g1_0:
    s_cmp_eq_u32 s32, 2
    s_cbranch_scc0 L_tlb_g2_0
    buffer_load_dword v244, v20, s[16:19], 0 offen offset:128
L_tlb_g2_0:
    s_cmp_eq_u32 s32, 3
    s_cbranch_scc0 L_tlb_g3_0
    buffer_load_dword v244, v20, s[20:23], 0 offen offset:128
L_tlb_g3_0:
    s_cmp_eq_u32 s32, 4
    s_cbranch_scc0 L_tlb_g4_0
    buffer_load_dword v244, v20, s[16:19], 0 offen offset:256
L_tlb_g4_0:
    s_cmp_eq_u32 s32, 5
    s_cbranch_scc0 L_tlb_g5_0
    buffer_load_dword v244, v20, s[20:23], 0 offen offset:256
L_tlb_g5_0:
    v_mfma_f32_16x16x32_bf16 v[32:35], v[144:147], v[128:131], 0
    s_add_u32 m0, s40, 32768
    s_nop 0
    buffer_load_dwordx4 v10, s[28:31], s47 offen lds
    v_mfma_f32_16x16x32_bf16 v[56:59], v[144:147], v[132:135], 0
    ds_read_b128 v[168:171], v212 offset:0
    v_lshlrev_b32 v20, 16, v128
    v_mfma_f32_16x16x32_bf16 v[80:83], v[144:147], v[136:139], 0
    ds_read_b128 v[172:175], v213 offset:0
    v_and_b32 v21, s69, v128
    v_mfma_f32_16x16x32_bf16 v[104:107], v[144:147], v[140:143], 0
    ds_read_b128 v[176:179], v214 offset:0
    v_mov_b32 v24, v20
    v_mfma_f32_16x16x32_bf16 v[36:39], v[148:151], v[128:131], 0
    v_mov_b32 v25, v21
    v_mfma_f32_16x16x32_bf16 v[60:63], v[148:151], v[132:135], 0
    s_add_u32 m0, s40, 40960
    s_nop 0
    buffer_load_dwordx4 v11, s[28:31], s47 offen lds
    ds_read_b128 v[180:183], v215 offset:0
    v_mul_f32 v26, v20, v20
    v_mfma_f32_16x16x32_bf16 v[84:87], v[148:151], v[136:139], 0
    ds_read_b64_tr_b16 v[184:185], v216 offset:24576
    v_mul_f32 v27, v21, v21
    v_mfma_f32_16x16x32_bf16 v[108:111], v[148:151], v[140:143], 0
    ds_read_b64_tr_b16 v[186:187], v216 offset:30720
    v_lshlrev_b32 v22, 16, v129
    v_mfma_f32_16x16x32_bf16 v[40:43], v[152:155], v[128:131], 0
    v_and_b32 v23, s69, v129
    v_mfma_f32_16x16x32_bf16 v[64:67], v[152:155], v[132:135], 0
    s_add_u32 s47, s47, 128
    s_add_u32 m0, s41, 0
    s_nop 0
    buffer_load_dwordx4 v12, s[16:19], s48 offen lds
    ds_read_b64_tr_b16 v[188:189], v217 offset:24576
    v_mfma_f32_16x16x32_bf16 v[88:91], v[152:155], v[136:139], 0
    ds_read_b64_tr_b16 v[190:191], v217 offset:30720
    v_add_f32 v24, v24, v22
    v_mfma_f32_16x16x32_bf16 v[112:115], v[152:155], v[140:143], 0
    ds_read_b64_tr_b16 v[192:193], v218 offset:24576
    v_add_f32 v25, v25, v23
    v_mfma_f32_16x16x32_bf16 v[44:47], v[156:159], v[128:131], 0
    v_fmac_f32 v26, v22, v22
    v_mfma_f32_16x16x32_bf16 v[68:71], v[156:159], v[132:135], 0
    s_add_u32 m0, s42, 0
    s_nop 0
    buffer_load_dwordx4 v12, s[20:23], s48 offen lds
    ds_read_b64_tr_b16 v[194:195], v218 offset:30720
    v_fmac_f32 v27, v23, v23
    v_mfma_f32_16x16x32_bf16 v[92:95], v[156:159], v[136:139], 0
    ds_read_b64_tr_b16 v[196:197], v219 offset:24576
    v_lshlrev_b32 v20, 16, v130
    v_mfma_f32_16x16x32_bf16 v[116:119], v[156:159], v[140:143], 0
    ds_read_b64_tr_b16 v[198:199], v219 offset:30720
    v_and_b32 v21, s69, v130
    v_mfma_f32_16x16x32_bf16 v[48:51], v[160:163], v[128:131], 0
    v_add_f32 v24, v24, v20
    v_mfma_f32_16x16x32_bf16 v[72:75], v[160:163], v[132:135], 0
    s_add_u32 m0, s43, 0
    s_nop 0
    buffer_load_dwordx4 v13, s[24:27], s48 offen lds
    ds_read_b64_tr_b16 v[200:201], v220 offset:24576
    v_add_f32 v25, v25, v21
    v_mfma_f32_16x16x32_bf16 v[96:99], v[160:163], v[136:139], 0
    ds_read_b64_tr_b16 v[202:203], v220 offset:30720
    v_mfma_f32_16x16x32_bf16 v[120:123], v[160:163], v[140:143], 0
    ds_read_b64_tr_b16 v[204:205], v221 offset:24576
    v_fmac_f32 v26, v20, v20
    v_mfma_f32_16x16x32_bf16 v[52:55], v[164:167], v[128:131], 0
    ds_read_b64_tr_b16 v[206:207], v221 offset:30720
    v_fmac_f32 v27, v21, v21
    v_mfma_f32_16x16x32_bf16 v[76:79], v[164:167], v[132:135], 0
    s_add_u32 s48, s48, 98304
    v_lshlrev_b32 v22, 16, v131
    v_mfma_f32_16x16x32_bf16 v[100:103], v[164:167], v[136:139], 0
    v_and_b32 v23, s69, v131
    v_mfma_f32_16x16x32_bf16 v[124:127], v[164:167], v[140:143], 0
    v_add_f32 v24, v24, v22
    v_mfma_f32_16x16x32_bf16 v[232:235], v[144:147], v[228:231], 0
    v_add_f32 v25, v25, v23
    v_mfma_f32_16x16x32_bf16 v[236:239], v[148:151], v[228:231], 0
    v_fmac_f32 v26, v22, v22
    v_mfma_f32_16x16x32_bf16 v[240:243], v[152:155], v[228:231], 0
    v_fmac_f32 v27, v23, v23
    s_waitcnt vmcnt(8) lgkmcnt(0)
    s_barrier
    v_mfma_f32_16x16x32_bf16 v[32:35], v[184:187], v[168:171], v[32:35]
    s_add_u32 m0, s41, 24576
    s_nop 0
    buffer_load_dwordx4 v12, s[16:19], s48 offen lds
    v_mfma_f32_16x16x32_bf16 v[56:59], v[184:187], v[172:175], v[56:59]
    ds_read_b128 v[128:131], v208 offset:16384
    v_lshlrev_b32 v20, 16, v168
    v_mfma_f32_16x16x32_bf16 v[80:83], v[184:187], v[176:179], v[80:83]
    ds_read_b128 v[132:135], v209 offset:16384
    v_and_b32 v21, s69, v168
    v_mfma_f32_16x16x32_bf16 v[104:107], v[184:187], v[180:183], v[104:107]
    ds_read_b128 v[136:139], v210 offset:16384
    v_add_f32 v24, v24, v20
    v_mfma_f32_16x16x32_bf16 v[36:39], v[188:191], v[168:171], v[36:39]
    v_add_f32 v25, v25, v21
    v_mfma_f32_16x16x32_bf16 v[60:63], v[188:191], v[172:175], v[60:63]
    ds_read_b128 v[140:143], v211 offset:16384
    v_fmac_f32 v26, v20, v20
    v_mfma_f32_16x16x32_bf16 v[84:87], v[188:191], v[176:179], v[84:87]
    ds_read_b64_tr_b16 v[144:145], v222 offset:0
    v_fmac_f32 v27, v21, v21
    v_mfma_f32_16x16x32_bf16 v[108:111], v[188:191], v[180:183], v[108:111]
    s_add_u32 m0, s42, 24576
    s_nop 0
    buffer_load_dwordx4 v12, s[20:23], s48 offen lds
    ds_read_b64_tr_b16 v[146:147], v222 offset:6144
    v_lshlrev_b32 v22, 16, v169
    v_mfma_f32_16x16x32_bf16 v[40:43], v[192:195], v[168:171], v[40:43]
    v_and_b32 v23, s69, v169
    v_mfma_f32_16x16x32_bf16 v[64:67], v[192:195], v[172:175], v[64:67]
    ds_read_b64_tr_b16 v[148:149], v223 offset:0
    v_mfma_f32_16x16x32_bf16 v[88:91], v[192:195], v[176:179], v[88:91]
    ds_read_b64_tr_b16 v[150:151], v223 offset:6144
    v_add_f32 v24, v24, v22
    v_mfma_f32_16x16x32_bf16 v[112:115], v[192:195], v[180:183], v[112:115]
    ds_read_b64_tr_b16 v[152:153], v224 offset:0
    v_add_f32 v25, v25, v23
    v_mfma_f32_16x16x32_bf16 v[44:47], v[196:199], v[168:171], v[44:47]
    v_fmac_f32 v26, v22, v22
    v_mfma_f32_16x16x32_bf16 v[68:71], v[196:199], v[172:175], v[68:71]
    s_add_u32 m0, s43, 24576
    s_nop 0
    buffer_load_dwordx4 v13, s[24:27], s48 offen lds
    ds_read_b64_tr_b16 v[154:155], v224 offset:6144
    v_fmac_f32 v27, v23, v23
    v_mfma_f32_16x16x32_bf16 v[92:95], v[196:199], v[176:179], v[92:95]
    ds_read_b64_tr_b16 v[156:157], v225 offset:0
    v_lshlrev_b32 v20, 16, v170
    v_mfma_f32_16x16x32_bf16 v[116:119], v[196:199], v[180:183], v[116:119]
    ds_read_b64_tr_b16 v[158:159], v225 offset:6144
    v_and_b32 v21, s69, v170
    v_mfma_f32_16x16x32_bf16 v[48:51], v[200:203], v[168:171], v[48:51]
    v_add_f32 v24, v24, v20
    v_mfma_f32_16x16x32_bf16 v[72:75], v[200:203], v[172:175], v[72:75]
    ds_read_b64_tr_b16 v[160:161], v226 offset:0
    v_add_f32 v25, v25, v21
    v_mfma_f32_16x16x32_bf16 v[96:99], v[200:203], v[176:179], v[96:99]
    ds_read_b64_tr_b16 v[162:163], v226 offset:6144
    v_mfma_f32_16x16x32_bf16 v[120:123], v[200:203], v[180:183], v[120:123]
    s_add_u32 s48, s48, 98304
    ds_read_b64_tr_b16 v[164:165], v227 offset:0
    v_fmac_f32 v26, v20, v20
    v_mfma_f32_16x16x32_bf16 v[52:55], v[204:207], v[168:171], v[52:55]
    ds_read_b64_tr_b16 v[166:167], v227 offset:6144
    v_fmac_f32 v27, v21, v21
    v_mfma_f32_16x16x32_bf16 v[76:79], v[204:207], v[172:175], v[76:79]
    v_lshlrev_b32 v22, 16, v171
    v_mfma_f32_16x16x32_bf16 v[100:103], v[204:207], v[176:179], v[100:103]
    v_and_b32 v23, s69, v171
    v_mfma_f32_16x16x32_bf16 v[124:127], v[204:207], v[180:183], v[124:127]
    v_add_f32 v24, v24, v22
    v_mfma_f32_16x16x32_bf16 v[232:235], v[184:187], v[228:231], v[232:235]
    v_add_f32 v25, v25, v23
    v_mfma_f32_16x16x32_bf16 v[236:239], v[188:191], v[228:231], v[236:239]
    v_fmac_f32 v26, v22, v22
    v_mfma_f32_16x16x32_bf16 v[240:243], v[192:195], v[228:231], v[240:243]
    v_fmac_f32 v27, v23, v23
    s_waitcnt vmcnt(8) lgkmcnt(0)
    s_barrier
    v_mfma_f32_16x16x32_bf16 v[32:35], v[144:147], v[128:131], v[32:35]
    s_add_u32 m0, s40, 0
    s_nop 0
    buffer_load_dwordx4 v10, s[28:31], s47 offen lds
    v_mfma_f32_16x16x32_bf16 v[56:59], v[144:147], v[132:135], v[56:59]
    ds_read_b128 v[168:171], v212 offset:16384
    v_lshlrev_b32 v20, 16, v128
    v_mfma_f32_16x16x32_bf16 v[80:83], v[144:147], v[136:139], v[80:83]
    ds_read_b128 v[172:175], v213 offset:16384
    v_and_b32 v21, s69, v128
    v_mfma_f32_16x16x32_bf16 v[104:107], v[144:147], v[140:143], v[104:107]
    ds_read_b128 v[176:179], v214 offset:16384
    v_add_f32 v24, v24, v20
    v_mfma_f32_16x16x32_bf16 v[36:39], v[148:151], v[128:131], v[36:39]
    v_add_f32 v25, v25, v21
    v_mfma_f32_16x16x32_bf16 v[60:63], v[148:151], v[132:135], v[60:63]
    s_add_u32 m0, s40, 8192
    s_nop 0
    buffer_load_dwordx4 v11, s[28:31], s47 offen lds
    ds_read_b128 v[180:183], v215 offset:16384
    v_fmac_f32 v26, v20, v20
    v_mfma_f32_16x16x32_bf16 v[84:87], v[148:151], v[136:139], v[84:87]
    ds_read_b64_tr_b16 v[184:185], v222 offset:24576
    v_fmac_f32 v27, v21, v21
    v_mfma_f32_16x16x32_bf16 v[108:111], v[148:151], v[140:143], v[108:111]
    ds_read_b64_tr_b16 v[186:187], v222 offset:30720
    v_lshlrev_b32 v22, 16, v129
    v_mfma_f32_16x16x32_bf16 v[40:43], v[152:155], v[128:131], v[40:43]
    v_and_b32 v23, s69, v129
    v_mfma_f32_16x16x32_bf16 v[64:67], v[152:155], v[132:135], v[64:67]
    s_add_u32 s47, s47, 128
    s_add_u32 m0, s41, 49152
    s_nop 0
    buffer_load_dwordx4 v12, s[16:19], s48 offen lds
    ds_read_b64_tr_b16 v[188:189], v223 offset:24576
    v_mfma_f32_16x16x32_bf16 v[88:91], v[152:155], v[136:139], v[88:91]
    ds_read_b64_tr_b16 v[190:191], v223 offset:30720
    v_add_f32 v24, v24, v22
    v_mfma_f32_16x16x32_bf16 v[112:115], v[152:155], v[140:143], v[112:115]
    ds_read_b64_tr_b16 v[192:193], v224 offset:24576
    v_add_f32 v25, v25, v23
    v_mfma_f32_16x16x32_bf16 v[44:47], v[156:159], v[128:131], v[44:47]
    v_fmac_f32 v26, v22, v22
    v_mfma_f32_16x16x32_bf16 v[68:71], v[156:159], v[132:135], v[68:71]
    s_add_u32 m0, s42, 49152
    s_nop 0
    buffer_load_dwordx4 v12, s[20:23], s48 offen lds
    ds_read_b64_tr_b16 v[194:195], v224 offset:30720
    v_fmac_f32 v27, v23, v23
    v_mfma_f32_16x16x32_bf16 v[92:95], v[156:159], v[136:139], v[92:95]
    ds_read_b64_tr_b16 v[196:197], v225 offset:24576
    v_lshlrev_b32 v20, 16, v130
    v_mfma_f32_16x16x32_bf16 v[116:119], v[156:159], v[140:143], v[116:119]
    ds_read_b64_tr_b16 v[198:199], v225 offset:30720
    v_and_b32 v21, s69, v130
    v_mfma_f32_16x16x32_bf16 v[48:51], v[160:163], v[128:131], v[48:51]
    v_add_f32 v24, v24, v20
    v_mfma_f32_16x16x32_bf16 v[72:75], v[160:163], v[132:135], v[72:75]
    s_add_u32 m0, s43, 49152
    s_nop 0
    buffer_load_dwordx4 v13, s[24:27], s48 offen lds
    ds_read_b64_tr_b16 v[200:201], v226 offset:24576
    v_add_f32 v25, v25, v21
    v_mfma_f32_16x16x32_bf16 v[96:99], v[160:163], v[136:139], v[96:99]
    ds_read_b64_tr_b16 v[202:203], v226 offset:30720
    v_mfma_f32_16x16x32_bf16 v[120:123], v[160:163], v[140:143], v[120:123]
    ds_read_b64_tr_b16 v[204:205], v227 offset:24576
    v_fmac_f32 v26, v20, v20
    v_mfma_f32_16x16x32_bf16 v[52:55], v[164:167], v[128:131], v[52:55]
    ds_read_b64_tr_b16 v[206:207], v227 offset:30720
    v_fmac_f32 v27, v21, v21
    v_mfma_f32_16x16x32_bf16 v[76:79], v[164:167], v[132:135], v[76:79]
    s_add_u32 s48, s48, 98304
    v_lshlrev_b32 v22, 16, v131
    v_mfma_f32_16x16x32_bf16 v[100:103], v[164:167], v[136:139], v[100:103]
    v_and_b32 v23, s69, v131
    v_mfma_f32_16x16x32_bf16 v[124:127], v[164:167], v[140:143], v[124:127]
    v_add_f32 v24, v24, v22
    v_mfma_f32_16x16x32_bf16 v[232:235], v[144:147], v[228:231], v[232:235]
    v_add_f32 v25, v25, v23
    v_mfma_f32_16x16x32_bf16 v[236:239], v[148:151], v[228:231], v[236:239]
    v_fmac_f32 v26, v22, v22
    v_mfma_f32_16x16x32_bf16 v[240:243], v[152:155], v[228:231], v[240:243]
    v_fmac_f32 v27, v23, v23
    s_waitcnt vmcnt(8) lgkmcnt(0)
    s_barrier
    s_mul_i32 s44, s33, 10
    s_add_u32 s44, s44, 320
    v_min_u32 v20, 9, v0
    v_add_u32 v20, s44, v20
    v_mul_u32_u24 v20, 3072, v20
    v_add_u32 v20, s45, v20
    s_cmp_eq_u32 s32, 0
    s_cbranch_scc0 L_tlb_g0_1
    buffer_load_dword v244, v20, s[16:19], 0 offen offset:0
L_tlb_g0_1:
    s_cmp_eq_u32 s32, 1
    s_cbranch_scc0 L_tlb_g1_1
    buffer_load_dword v244, v20, s[20:23], 0 offen offset:0
L_tlb_g1_1:
    s_cmp_eq_u32 s32, 2
    s_cbranch_scc0 L_tlb_g2_1
    buffer_load_dword v244, v20, s[16:19], 0 offen offset:128
L_tlb_g2_1:
    s_cmp_eq_u32 s32, 3
    s_cbranch_scc0 L_tlb_g3_1
    buffer_load_dword v244, v20, s[20:23], 0 offen offset:128
L_tlb_g3_1:
    s_cmp_eq_u32 s32, 4
    s_cbranch_scc0 L_tlb_g4_1
    buffer_load_dword v244, v20, s[16:19], 0 offen offset:256
L_tlb_g4_1:
    s_cmp_eq_u32 s32, 5
    s_cbranch_scc0 L_tlb_g5_1
    buffer_load_dword v244, v20, s[20:23], 0 offen offset:256
L_tlb_g5_1:
    v_mfma_f32_16x16x32_bf16 v[32:35], v[184:187], v[168:171], v[32:35]
    s_add_u32 m0, s41, 73728
    s_nop 0
    buffer_load_dwordx4 v12, s[16:19], s48 offen lds
    v_mfma_f32_16x16x32_bf16 v[56:59], v[184:187], v[172:175], v[56:59]
    ds_read_b128 v[128:131], v208 offset:32768
    v_lshlrev_b32 v20, 16, v168
    v_mfma_f32_16x16x32_bf16 v[80:83], v[184:187], v[176:179], v[80:83]
    ds_read_b128 v[132:135], v209 offset:32768
    v_and_b32 v21, s69, v168
    v_mfma_f32_16x16x32_bf16 v[104:107], v[184:187], v[180:183], v[104:107]
    ds_read_b128 v[136:139], v210 offset:32768
    v_add_f32 v24, v24, v20
    v_mfma_f32_16x16x32_bf16 v[36:39], v[188:191], v[168:171], v[36:39]
    v_add_f32 v25, v25, v21
    v_mfma_f32_16x16x32_bf16 v[60:63], v[188:191], v[172:175], v[60:63]
    ds_read_b128 v[140:143], v211 offset:32768
    v_fmac_f32 v26, v20, v20
    v_mfma_f32_16x16x32_bf16 v[84:87], v[188:191], v[176:179], v[84:87]
    ds_read_b64_tr_b16 v[144:145], v216 offset:0
    v_fmac_f32 v27, v21, v21
    v_mfma_f32_16x16x32_bf16 v[108:111], v[188:191], v[180:183], v[108:111]
    s_add_u32 m0, s42, 73728
    s_nop 0
    buffer_load_dwordx4 v12, s[20:23], s48 offen lds
    ds_read_b64_tr_b16 v[146:147], v216 offset:6144
    v_lshlrev_b32 v22, 16, v169
    v_mfma_f32_16x16x32_bf16 v[40:43], v[192:195], v[168:171], v[40:43]
    v_and_b32 v23, s69, v169
    v_mfma_f32_16x16x32_bf16 v[64:67], v[192:195], v[172:175], v[64:67]
    ds_read_b64_tr_b16 v[148:149], v217 offset:0
    v_mfma_f32_16x16x32_bf16 v[88:91], v[192:195], v[176:179], v[88:91]
    ds_read_b64_tr_b16 v[150:151], v217 offset:6144
    v_add_f32 v24, v24, v22
    v_mfma_f32_16x16x32_bf16 v[112:115], v[192:195], v[180:183], v[112:115]
    ds_read_b64_tr_b16 v[152:153], v218 offset:0
    v_add_f32 v25, v25, v23
    v_mfma_f32_16x16x32_bf16 v[44:47], v[196:199], v[168:171], v[44:47]
    v_fmac_f32 v26, v22, v22
    v_mfma_f32_16x16x32_bf16 v[68:71], v[196:199], v[172:175], v[68:71]
    s_add_u32 m0, s43, 73728
    s_nop 0
    buffer_load_dwordx4 v13, s[24:27], s48 offen lds
    ds_read_b64_tr_b16 v[154:155], v218 offset:6144
    v_fmac_f32 v27, v23, v23
    v_mfma_f32_16x16x32_bf16 v[92:95], v[196:199], v[176:179], v[92:95]
    ds_read_b64_tr_b16 v[156:157], v219 offset:0
    v_lshlrev_b32 v20, 16, v170
    v_mfma_f32_16x16x32_bf16 v[116:119], v[196:199], v[180:183], v[116:119]
    ds_read_b64_tr_b16 v[158:159], v219 offset:6144
    v_and_b32 v21, s69, v170
    v_mfma_f32_16x16x32_bf16 v[48:51], v[200:203], v[168:171], v[48:51]
    v_add_f32 v24, v24, v20
    v_mfma_f32_16x16x32_bf16 v[72:75], v[200:203], v[172:175], v[72:75]
    ds_read_b64_tr_b16 v[160:161], v220 offset:0
    v_add_f32 v25, v25, v21
    v_mfma_f32_16x16x32_bf16 v[96:99], v[200:203], v[176:179], v[96:99]
    ds_read_b64_tr_b16 v[162:163], v220 offset:6144
    v_mfma_f32_16x16x32_bf16 v[120:123], v[200:203], v[180:183], v[120:123]
    s_add_u32 s48, s48, 98304
    ds_read_b64_tr_b16 v[164:165], v221 offset:0
    v_fmac_f32 v26, v20, v20
    v_mfma_f32_16x16x32_bf16 v[52:55], v[204:207], v[168:171], v[52:55]
    ds_read_b64_tr_b16 v[166:167], v221 offset:6144
    v_fmac_f32 v27, v21, v21
    v_mfma_f32_16x16x32_bf16 v[76:79], v[204:207], v[172:175], v[76:79]
    v_lshlrev_b32 v22, 16, v171
    v_mfma_f32_16x16x32_bf16 v[100:103], v[204:207], v[176:179], v[100:103]
    v_and_b32 v23, s69, v171
    v_mfma_f32_16x16x32_bf16 v[124:127], v[204:207], v[180:183], v[124:127]
    v_add_f32 v24, v24, v22
    v_mfma_f32_16x16x32_bf16 v[232:235], v[184:187], v[228:231], v[232:235]
    v_add_f32 v25, v25, v23
    v_mfma_f32_16x16x32_bf16 v[236:239], v[188:191], v[228:231], v[236:239]
    v_fmac_f32 v26, v22, v22
    v_mfma_f32_16x16x32_bf16 v[240:243], v[192:195], v[228:231], v[240:243]
    v_fmac_f32 v27, v23, v23
    s_waitcnt vmcnt(8) lgkmcnt(0)
    s_barrier
    v_mfma_f32_16x16x32_bf16 v[32:35], v[144:147], v[128:131], v[32:35]
    s_add_u32 m0, s40, 16384
    s_nop 0
    buffer_load_dwordx4 v10, s[28:31], s47 offen lds
    v_mfma_f32_16x16x32_bf16 v[56:59], v[144:147], v[132:135], v[56:59]
    ds_read_b128 v[168:171], v212 offset:32768
    v_lshlrev_b32 v20, 16, v128
    v_mfma_f32_16x16x32_bf16 v[80:83], v[144:147], v[136:139], v[80:83]
    ds_read_b128 v[172:175], v213 offset:32768
    v_and_b32 v21, s69, v128
    v_mfma_f32_16x16x32_bf16 v[104:107], v[144:147], v[140:143], v[104:107]
    ds_read_b128 v[176:179], v214 offset:32768
    v_add_f32 v24, v24, v20
    v_mfma_f32_16x16x32_bf16 v[36:39], v[148:151], v[128:131], v[36:39]
    v_add_f32 v25, v25, v21
    v_mfma_f32_16x16x32_bf16 v[60:63], v[148:151], v[132:135], v[60:63]
    s_add_u32 m0, s40, 24576
    s_nop 0
    buffer_load_dwordx4 v11, s[28:31], s47 offen lds
    ds_read_b128 v[180:183], v215 offset:32768
    v_fmac_f32 v26, v20, v20
    v_mfma_f32_16x16x32_bf16 v[84:87], v[148:151], v[136:139], v[84:87]
    ds_read_b64_tr_b16 v[184:185], v216 offset:24576
    v_fmac_f32 v27, v21, v21
    v_mfma_f32_16x16x32_bf16 v[108:111], v[148:151], v[140:143], v[108:111]
    ds_read_b64_tr_b16 v[186:187], v216 offset:30720
    v_lshlrev_b32 v22, 16, v129
    v_mfma_f32_16x16x32_bf16 v[40:43], v[152:155], v[128:131], v[40:43]
    v_and_b32 v23, s69, v129
    v_mfma_f32_16x16x32_bf16 v[64:67], v[152:155], v[132:135], v[64:67]
    s_add_u32 s47, s47, 128
    s_add_u32 m0, s41, 0
    s_nop 0
    buffer_load_dwordx4 v12, s[16:19], s48 offen lds
    ds_read_b64_tr_b16 v[188:189], v217 offset:24576
    v_mfma_f32_16x16x32_bf16 v[88:91], v[152:155], v[136:139], v[88:91]
    ds_read_b64_tr_b16 v[190:191], v217 offset:30720
    v_add_f32 v24, v24, v22
    v_mfma_f32_16x16x32_bf16 v[112:115], v[152:155], v[140:143], v[112:115]
    ds_read_b64_tr_b16 v[192:193], v218 offset:24576
    v_add_f32 v25, v25, v23
    v_mfma_f32_16x16x32_bf16 v[44:47], v[156:159], v[128:131], v[44:47]
    v_fmac_f32 v26, v22, v22
    v_mfma_f32_16x16x32_bf16 v[68:71], v[156:159], v[132:135], v[68:71]
    s_add_u32 m0, s42, 0
    s_nop 0
    buffer_load_dwordx4 v12, s[20:23], s48 offen lds
    ds_read_b64_tr_b16 v[194:195], v218 offset:30720
    v_fmac_f32 v27, v23, v23
    v_mfma_f32_16x16x32_bf16 v[92:95], v[156:159], v[136:139], v[92:95]
    ds_read_b64_tr_b16 v[196:197], v219 offset:24576
    v_lshlrev_b32 v20, 16, v130
    v_mfma_f32_16x16x32_bf16 v[116:119], v[156:159], v[140:143], v[116:119]
    ds_read_b64_tr_b16 v[198:199], v219 offset:30720
    v_and_b32 v21, s69, v130
    v_mfma_f32_16x16x32_bf16 v[48:51], v[160:163], v[128:131], v[48:51]
    v_add_f32 v24, v24, v20
    v_mfma_f32_16x16x32_bf16 v[72:75], v[160:163], v[132:135], v[72:75]
    s_add_u32 m0, s43, 0
    s_nop 0
    buffer_load_dwordx4 v13, s[24:27], s48 offen lds
    ds_read_b64_tr_b16 v[200:201], v220 offset:24576
    v_add_f32 v25, v25, v21
    v_mfma_f32_16x16x32_bf16 v[96:99], v[160:163], v[136:139], v[96:99]
    ds_read_b64_tr_b16 v[202:203], v220 offset:30720
    v_mfma_f32_16x16x32_bf16 v[120:123], v[160:163], v[140:143], v[120:123]
    ds_read_b64_tr_b16 v[204:205], v221 offset:24576
    v_fmac_f32 v26, v20, v20
    v_mfma_f32_16x16x32_bf16 v[52:55], v[164:167], v[128:131], v[52:55]
    ds_read_b64_tr_b16 v[206:207], v221 offset:30720
    v_fmac_f32 v27, v21, v21
    v_mfma_f32_16x16x32_bf16 v[76:79], v[164:167], v[132:135], v[76:79]
    s_add_u32 s48, s48, 98304
    v_lshlrev_b32 v22, 16, v131
    v_mfma_f32_16x16x32_bf16 v[100:103], v[164:167], v[136:139], v[100:103]
    v_and_b32 v23, s69, v131
    v_mfma_f32_16x16x32_bf16 v[124:127], v[164:167], v[140:143], v[124:127]
    v_add_f32 v24, v24, v22
    v_mfma_f32_16x16x32_bf16 v[232:235], v[144:147], v[228:231], v[232:235]
    v_add_f32 v25, v25, v23
    v_mfma_f32_16x16x32_bf16 v[236:239], v[148:151], v[228:231], v[236:239]
    v_fmac_f32 v26, v22, v22
    v_mfma_f32_16x16x32_bf16 v[240:243], v[152:155], v[228:231], v[240:243]
    v_fmac_f32 v27, v23, v23
    s_waitcnt vmcnt(8) lgkmcnt(0)
    s_barrier
    v_mfma_f32_16x16x32_bf16 v[32:35], v[184:187], v[168:171], v[32:35]
    s_add_u32 m0, s41, 24576
    s_nop 0
    buffer_load_dwordx4 v12, s[16:19], s48 offen lds
    v_mfma_f32_16x16x32_bf16 v[56:59], v[184:187], v[172:175], v[56:59]
    ds_read_b128 v[128:131], v208 offset:0
    v_lshlrev_b32 v20, 16, v168
    v_mfma_f32_16x16x32_bf16 v[80:83], v[184:187], v[176:179], v[80:83]
    ds_read_b128 v[132:135], v209 offset:0
    v_and_b32 v21, s69, v168
    v_mfma_f32_16x16x32_bf16 v[104:107], v[184:187], v[180:183], v[104:107]
    ds_read_b128 v[136:139], v210 offset:0
    v_add_f32 v24, v24, v20
    v_mfma_f32_16x16x32_bf16 v[36:39], v[188:191], v[168:171], v[36:39]
    v_add_f32 v25, v25, v21
    v_mfma_f32_16x16x32_bf16 v[60:63], v[188:191], v[172:175], v[60:63]
    ds_read_b128 v[140:143], v211 offset:0
    v_fmac_f32 v26, v20, v20
    v_mfma_f32_16x16x32_bf16 v[84:87], v[188:191], v[176:179], v[84:87]
    ds_read_b64_tr_b16 v[144:145], v222 offset:0
    v_fmac_f32 v27, v21, v21
    v_mfma_f32_16x16x32_bf16 v[108:111], v[188:191], v[180:183], v[108:111]
    s_add_u32 m0, s42, 24576
    s_nop 0
    buffer_load_dwordx4 v12, s[20:23], s48 offen lds
    ds_read_b64_tr_b16 v[146:147], v222 offset:6144
    v_lshlrev_b32 v22, 16, v169
    v_mfma_f32_16x16x32_bf16 v[40:43], v[192:195], v[168:171], v[40:43]
    v_and_b32 v23, s69, v169
    v_mfma_f32_16x16x32_bf16 v[64:67], v[192:195], v[172:175], v[64:67]
    ds_read_b64_tr_b16 v[148:149], v223 offset:0
    v_mfma_f32_16x16x32_bf16 v[88:91], v[192:195], v[176:179], v[88:91]
    ds_read_b64_tr_b16 v[150:151], v223 offset:6144
    v_add_f32 v24, v24, v22
    v_mfma_f32_16x16x32_bf16 v[112:115], v[192:195], v[180:183], v[112:115]
    ds_read_b64_tr_b16 v[152:153], v224 offset:0
    v_add_f32 v25, v25, v23
    v_mfma_f32_16x16x32_bf16 v[44:47], v[196:199], v[168:171], v[44:47]
    v_fmac_f32 v26, v22, v22
    v_mfma_f32_16x16x32_bf16 v[68:71], v[196:199], v[172:175], v[68:71]
    s_add_u32 m0, s43, 24576
    s_nop 0
    buffer_load_dwordx4 v13, s[24:27], s48 offen lds
    ds_read_b64_tr_b16 v[154:155], v224 offset:6144
    v_fmac_f32 v27, v23, v23
    v_mfma_f32_16x16x32_bf16 v[92:95], v[196:199], v[176:179], v[92:95]
    ds_read_b64_tr_b16 v[156:157], v225 offset:0
    v_lshlrev_b32 v20, 16, v170
    v_mfma_f32_16x16x32_bf16 v[116:119], v[196:199], v[180:183], v[116:119]
    ds_read_b64_tr_b16 v[158:159], v225 offset:6144
    v_and_b32 v21, s69, v170
    v_mfma_f32_16x16x32_bf16 v[48:51], v[200:203], v[168:171], v[48:51]
    v_add_f32 v24, v24, v20
    v_mfma_f32_16x16x32_bf16 v[72:75], v[200:203], v[172:175], v[72:75]
    ds_read_b64_tr_b16 v[160:161], v226 offset:0
    v_add_f32 v25, v25, v21
    v_mfma_f32_16x16x32_bf16 v[96:99], v[200:203], v[176:179], v[96:99]
    ds_read_b64_tr_b16 v[162:163], v226 offset:6144
    v_mfma_f32_16x16x32_bf16 v[120:123], v[200:203], v[180:183], v[120:123]
    s_add_u32 s48, s48, 98304
    ds_read_b64_tr_b16 v[164:165], v227 offset:0
    v_fmac_f32 v26, v20, v20
    v_mfma_f32_16x16x32_bf16 v[52:55], v[204:207], v[168:171], v[52:55]
    ds_read_b64_tr_b16 v[166:167], v227 offset:6144
    v_fmac_f32 v27, v21, v21
    v_mfma_f32_16x16x32_bf16 v[76:79], v[204:207], v[172:175], v[76:79]
    v_lshlrev_b32 v22, 16, v171
    v_mfma_f32_16x16x32_bf16 v[100:103], v[204:207], v[176:179], v[100:103]
    v_and_b32 v23, s69, v171
    v_mfma_f32_16x16x32_bf16 v[124:127], v[204:207], v[180:183], v[124:127]
    v_add_f32 v24, v24, v22
    v_mfma_f32_16x16x32_bf16 v[232:235], v[184:187], v[228:231], v[232:235]
    v_add_f32 v25, v25, v23
    v_mfma_f32_16x16x32_bf16 v[236:239], v[188:191], v[228:231], v[236:239]
    v_fmac_f32 v26, v22, v22
    v_mfma_f32_16x16x32_bf16 v[240:243], v[192:195], v[228:231], v[240:243]
    v_fmac_f32 v27, v23, v23
    s_waitcnt vmcnt(8) lgkmcnt(0)
    s_barrier
    s_mul_i32 s44, s33, 10
    s_add_u32 s44, s44, 480
    v_min_u32 v20, 9, v0
    v_add_u32 v20, s44, v20
    v_mul_u32_u24 v20, 3072, v20
    v_add_u32 v20, s45, v20
    s_cmp_eq_u32 s32, 0
    s_cbranch_scc0 L_tlb_g0_2
    buffer_load_dword v244, v20, s[16:19], 0 offen offset:0
L_tlb_g0_2:
    s_cmp_eq_u32 s32, 1
    s_cbranch_scc0 L_tlb_g1_2
    buffer_load_dword v244, v20, s[20:23], 0 offen offset:0
L_tlb_g1_2:
    s_cmp_eq_u32 s32, 2
    s_cbranch_scc0 L_tlb_g2_2
    buffer_load_dword v244, v20, s[16:19], 0 offen offset:128
L_tlb_g2_2:
    s_cmp_eq_u32 s32, 3
    s_cbranch_scc0 L_tlb_g3_2
    buffer_load_dword v244, v20, s[20:23], 0 offen offset:128
L_tlb_g3_2:
    s_cmp_eq_u32 s32, 4
    s_cbranch_scc0 L_tlb_g4_2
    buffer_load_dword v244, v20, s[16:19], 0 offen offset:256
L_tlb_g4_2:
    s_cmp_eq_u32 s32, 5
    s_cbranch_scc0 L_tlb_g5_2
    buffer_load_dword v244, v20, s[20:23], 0 offen offset:256
L_tlb_g5_2:
    v_mfma_f32_16x16x32_bf16 v[32:35], v[144:147], v[128:131], v[32:35]
    s_add_u32 m0, s40, 32768
    s_nop 0
    buffer_load_dwordx4 v10, s[28:31], s47 offen lds
    v_mfma_f32_16x16x32_bf16 v[56:59], v[144:147], v[132:135], v[56:59]
    ds_read_b128 v[168:171], v212 offset:0
    v_lshlrev_b32 v20, 16, v128
    v_mfma_f32_16x16x32_bf16 v[80:83], v[144:147], v[136:139], v[80:83]
    ds_read_b128 v[172:175], v213 offset:0
    v_and_b32 v21, s69, v128
    v_mfma_f32_16x16x32_bf16 v[104:107], v[144:147], v[140:143], v[104:107]
    ds_read_b128 v[176:179], v214 offset:0
    v_add_f32 v24, v24, v20
    v_mfma_f32_16x16x32_bf16 v[36:39], v[148:151], v[128:131], v[36:39]
    v_add_f32 v25, v25, v21
    v_mfma_f32_16x16x32_bf16 v[60:63], v[148:151], v[132:135], v[60:63]
    s_add_u32 m0, s40, 40960
    s_nop 0
    buffer_load_dwordx4 v11, s[28:31], s47 offen lds
    ds_read_b128 v[180:183], v215 offset:0
    v_fmac_f32 v26, v20, v20
    v_mfma_f32_16x16x32_bf16 v[84:87], v[148:151], v[136:139], v[84:87]
    ds_read_b64_tr_b16 v[184:185], v222 offset:24576
    v_fmac_f32 v27, v21, v21
    v_mfma_f32_16x16x32_bf16 v[108:111], v[148:151], v[140:143], v[108:111]
    ds_read_b64_tr_b16 v[186:187], v222 offset:30720
    v_lshlrev_b32 v22, 16, v129
    v_mfma_f32_16x16x32_bf16 v[40:43], v[152:155], v[128:131], v[40:43]
    v_and_b32 v23, s69, v129
    v_mfma_f32_16x16x32_bf16 v[64:67], v[152:155], v[132:135], v[64:67]
    s_add_u32 s47, s47, 128
    s_add_u32 m0, s41, 49152
    s_nop 0
    buffer_load_dwordx4 v12, s[16:19], s48 offen lds
    ds_read_b64_tr_b16 v[188:189], v223 offset:24576
    v_mfma_f32_16x16x32_bf16 v[88:91], v[152:155], v[136:139], v[88:91]
    ds_read_b64_tr_b16 v[190:191], v223 offset:30720
    v_add_f32 v24, v24, v22
    v_mfma_f32_16x16x32_bf16 v[112:115], v[152:155], v[140:143], v[112:115]
    ds_read_b64_tr_b16 v[192:193], v224 offset:24576
    v_add_f32 v25, v25, v23
    v_mfma_f32_16x16x32_bf16 v[44:47], v[156:159], v[128:131], v[44:47]
    v_fmac_f32 v26, v22, v22
    v_mfma_f32_16x16x32_bf16 v[68:71], v[156:159], v[132:135], v[68:71]
    s_add_u32 m0, s42, 49152
    s_nop 0
    buffer_load_dwordx4 v12, s[20:23], s48 offen lds
    ds_read_b64_tr_b16 v[194:195], v224 offset:30720
    v_fmac_f32 v27, v23, v23
    v_mfma_f32_16x16x32_bf16 v[92:95], v[156:159], v[136:139], v[92:95]
    ds_read_b64_tr_b16 v[196:197], v225 offset:24576
    v_lshlrev_b32 v20, 16, v130
    v_mfma_f32_16x16x32_bf16 v[116:119], v[156:159], v[140:143], v[116:119]
    ds_read_b64_tr_b16 v[198:199], v225 offset:30720
    v_and_b32 v21, s69, v130
    v_mfma_f32_16x16x32_bf16 v[48:51], v[160:163], v[128:131], v[48:51]
    v_add_f32 v24, v24, v20
    v_mfma_f32_16x16x32_bf16 v[72:75], v[160:163], v[132:135], v[72:75]
    s_add_u32 m0, s43, 49152
    s_nop 0
    buffer_load_dwordx4 v13, s[24:27], s48 offen lds
    ds_read_b64_tr_b16 v[200:201], v226 offset:24576
    v_add_f32 v25, v25, v21
    v_mfma_f32_16x16x32_bf16 v[96:99], v[160:163], v[136:139], v[96:99]
    ds_read_b64_tr_b16 v[202:203], v226 offset:30720
    v_mfma_f32_16x16x32_bf16 v[120:123], v[160:163], v[140:143], v[120:123]
    ds_read_b64_tr_b16 v[204:205], v227 offset:24576
    v_fmac_f32 v26, v20, v20
    v_mfma_f32_16x16x32_bf16 v[52:55], v[164:167], v[128:131], v[52:55]
    ds_read_b64_tr_b16 v[206:207], v227 offset:30720
    v_fmac_f32 v27, v21, v21
    v_mfma_f32_16x16x32_bf16 v[76:79], v[164:167], v[132:135], v[76:79]
    s_add_u32 s48, s48, 98304
    v_lshlrev_b32 v22, 16, v131
    v_mfma_f32_16x16x32_bf16 v[100:103], v[164:167], v[136:139], v[100:103]
    v_and_b32 v23, s69, v131
    v_mfma_f32_16x16x32_bf16 v[124:127], v[164:167], v[140:143], v[124:127]
    v_add_f32 v24, v24, v22
    v_mfma_f32_16x16x32_bf16 v[232:235], v[144:147], v[228:231], v[232:235]
    v_add_f32 v25, v25, v23
    v_mfma_f32_16x16x32_bf16 v[236:239], v[148:151], v[228:231], v[236:239]
    v_fmac_f32 v26, v22, v22
    v_mfma_f32_16x16x32_bf16 v[240:243], v[152:155], v[228:231], v[240:243]
    v_fmac_f32 v27, v23, v23
    s_waitcnt vmcnt(8) lgkmcnt(0)
    s_barrier
    v_mfma_f32_16x16x32_bf16 v[32:35], v[184:187], v[168:171], v[32:35]
    s_add_u32 m0, s41, 73728
    s_nop 0
    buffer_load_dwordx4 v12, s[16:19], s48 offen lds
    v_mfma_f32_16x16x32_bf16 v[56:59], v[184:187], v[172:175], v[56:59]
    ds_read_b128 v[128:131], v208 offset:16384
    v_lshlrev_b32 v20, 16, v168
    v_mfma_f32_16x16x32_bf16 v[80:83], v[184:187], v[176:179], v[80:83]
    ds_read_b128 v[132:135], v209 offset:16384
    v_and_b32 v21, s69, v168
    v_mfma_f32_16x16x32_bf16 v[104:107], v[184:187], v[180:183], v[104:107]
    ds_read_b128 v[136:139], v210 offset:16384
    v_add_f32 v24, v24, v20
    v_mfma_f32_16x16x32_bf16 v[36:39], v[188:191], v[168:171], v[36:39]
    v_add_f32 v25, v25, v21
    v_mfma_f32_16x16x32_bf16 v[60:63], v[188:191], v[172:175], v[60:63]
    ds_read_b128 v[140:143], v211 offset:16384
    v_fmac_f32 v26, v20, v20
    v_mfma_f32_16x16x32_bf16 v[84:87], v[188:191], v[176:179], v[84:87]
    ds_read_b64_tr_b16 v[144:145], v216 offset:0
    v_fmac_f32 v27, v21, v21
    v_mfma_f32_16x16x32_bf16 v[108:111], v[188:191], v[180:183], v[108:111]
    s_add_u32 m0, s42, 73728
    s_nop 0
    buffer_load_dwordx4 v12, s[20:23], s48 offen lds
    ds_read_b64_tr_b16 v[146:147], v216 offset:6144
    v_lshlrev_b32 v22, 16, v169
    v_mfma_f32_16x16x32_bf16 v[40:43], v[192:195], v[168:171], v[40:43]
    v_and_b32 v23, s69, v169
    v_mfma_f32_16x16x32_bf16 v[64:67], v[192:195], v[172:175], v[64:67]
    ds_read_b64_tr_b16 v[148:149], v217 offset:0
    v_mfma_f32_16x16x32_bf16 v[88:91], v[192:195], v[176:179], v[88:91]
    ds_read_b64_tr_b16 v[150:151], v217 offset:6144
    v_add_f32 v24, v24, v22
    v_mfma_f32_16x16x32_bf16 v[112:115], v[192:195], v[180:183], v[112:115]
    ds_read_b64_tr_b16 v[152:153], v218 offset:0
    v_add_f32 v25, v25, v23
    v_mfma_f32_16x16x32_bf16 v[44:47], v[196:199], v[168:171], v[44:47]
    v_fmac_f32 v26, v22, v22
    v_mfma_f32_16x16x32_bf16 v[68:71], v[196:199], v[172:175], v[68:71]
    s_add_u32 m0, s43, 73728
    s_nop 0
    buffer_load_dwordx4 v13, s[24:27], s48 offen lds
    ds_read_b64_tr_b16 v[154:155], v218 offset:6144
    v_fmac_f32 v27, v23, v23
    v_mfma_f32_16x16x32_bf16 v[92:95], v[196:199], v[176:179], v[92:95]
    ds_read_b64_tr_b16 v[156:157], v219 offset:0
    v_lshlrev_b32 v20, 16, v170
    v_mfma_f32_16x16x32_bf16 v[116:119], v[196:199], v[180:183], v[116:119]
    ds_read_b64_tr_b16 v[158:159], v219 offset:6144
    v_and_b32 v21, s69, v170
    v_mfma_f32_16x16x32_bf16 v[48:51], v[200:203], v[168:171], v[48:51]
    v_add_f32 v24, v24, v20
    v_mfma_f32_16x16x32_bf16 v[72:75], v[200:203], v[172:175], v[72:75]
    ds_read_b64_tr_b16 v[160:161], v220 offset:0
    v_add_f32 v25, v25, v21
    v_mfma_f32_16x16x32_bf16 v[96:99], v[200:203], v[176:179], v[96:99]
    ds_read_b64_tr_b16 v[162:163], v220 offset:6144
    v_mfma_f32_16x16x32_bf16 v[120:123], v[200:203], v[180:183], v[120:123]
    s_add_u32 s48, s48, 98304
    ds_read_b64_tr_b16 v[164:165], v221 offset:0
    v_fmac_f32 v26, v20, v20
    v_mfma_f32_16x16x32_bf16 v[52:55], v[204:207], v[168:171], v[52:55]
    ds_read_b64_tr_b16 v[166:167], v221 offset:6144
    v_fmac_f32 v27, v21, v21
    v_mfma_f32_16x16x32_bf16 v[76:79], v[204:207], v[172:175], v[76:79]
    v_lshlrev_b32 v22, 16, v171
    v_mfma_f32_16x16x32_bf16 v[100:103], v[204:207], v[176:179], v[100:103]
    v_and_b32 v23, s69, v171
    v_mfma_f32_16x16x32_bf16 v[124:127], v[204:207], v[180:183], v[124:127]
    v_add_f32 v24, v24, v22
    v_mfma_f32_16x16x32_bf16 v[232:235], v[184:187], v[228:231], v[232:235]
    v_add_f32 v25, v25, v23
    v_mfma_f32_16x16x32_bf16 v[236:239], v[188:191], v[228:231], v[236:239]
    v_fmac_f32 v26, v22, v22
    v_mfma_f32_16x16x32_bf16 v[240:243], v[192:195], v[228:231], v[240:243]
    v_fmac_f32 v27, v23, v23
    s_waitcnt vmcnt(8) lgkmcnt(0)
    s_barrier
    v_mfma_f32_16x16x32_bf16 v[32:35], v[144:147], v[128:131], v[32:35]
    s_add_u32 m0, s40, 0
    s_nop 0
    buffer_load_dwordx4 v10, s[28:31], s47 offen lds
    v_mfma_f32_16x16x32_bf16 v[56:59], v[144:147], v[132:135], v[56:59]
    ds_read_b128 v[168:171], v212 offset:16384
    v_lshlrev_b32 v20, 16, v128
    v_mfma_f32_16x16x32_bf16 v[80:83], v[144:147], v[136:139], v[80:83]
    ds_read_b128 v[172:175], v213 offset:16384
    v_and_b32 v21, s69, v128
    v_mfma_f32_16x16x32_bf16 v[104:107], v[144:147], v[140:143], v[104:107]
    ds_read_b128 v[176:179], v214 offset:16384
    v_add_f32 v24, v24, v20
    v_mfma_f32_16x16x32_bf16 v[36:39], v[148:151], v[128:131], v[36:39]
    v_add_f32 v25, v25, v21
    v_mfma_f32_16x16x32_bf16 v[60:63], v[148:151], v[132:135], v[60:63]
    s_add_u32 m0, s40, 8192
    s_nop 0
    buffer_load_dwordx4 v11, s[28:31], s47 offen lds
    ds_read_b128 v[180:183], v215 offset:16384
    v_fmac_f32 v26, v20, v20
    v_mfma_f32_16x16x32_bf16 v[84:87], v[148:151], v[136:139], v[84:87]
    ds_read_b64_tr_b16 v[184:185], v216 offset:24576
    v_fmac_f32 v27, v21, v21
    v_mfma_f32_16x16x32_bf16 v[108:111], v[148:151], v[140:143], v[108:111]
    ds_read_b64_tr_b16 v[186:187], v216 offset:30720
    v_lshlrev_b32 v22, 16, v129
    v_mfma_f32_16x16x32_bf16 v[40:43], v[152:155], v[128:131], v[40:43]
    v_and_b32 v23, s69, v129
    v_mfma_f32_16x16x32_bf16 v[64:67], v[152:155], v[132:135], v[64:67]
    s_add_u32 s47, s47, 128
    s_add_u32 m0, s41, 0
    s_nop 0
    buffer_load_dwordx4 v12, s[16:19], s48 offen lds
    ds_read_b64_tr_b16 v[188:189], v217 offset:24576
    v_mfma_f32_16x16x32_bf16 v[88:91], v[152:155], v[136:139], v[88:91]
    ds_read_b64_tr_b16 v[190:191], v217 offset:30720
    v_add_f32 v24, v24, v22
    v_mfma_f32_16x16x32_bf16 v[112:115], v[152:155], v[140:143], v[112:115]
    ds_read_b64_tr_b16 v[192:193], v218 offset:24576
    v_add_f32 v25, v25, v23
    v_mfma_f32_16x16x32_bf16 v[44:47], v[156:159], v[128:131], v[44:47]
    v_fmac_f32 v26, v22, v22
    v_mfma_f32_16x16x32_bf16 v[68:71], v[156:159], v[132:135], v[68:71]
    s_add_u32 m0, s42, 0
    s_nop 0
    buffer_load_dwordx4 v12, s[20:23], s48 offen lds
    ds_read_b64_tr_b16 v[194:195], v218 offset:30720
    v_fmac_f32 v27, v23, v23
    v_mfma_f32_16x16x32_bf16 v[92:95], v[156:159], v[136:139], v[92:95]
    ds_read_b64_tr_b16 v[196:197], v219 offset:24576
    v_lshlrev_b32 v20, 16, v130
    v_mfma_f32_16x16x32_bf16 v[116:119], v[156:159], v[140:143], v[116:119]
    ds_read_b64_tr_b16 v[198:199], v219 offset:30720
    v_and_b32 v21, s69, v130
    v_mfma_f32_16x16x32_bf16 v[48:51], v[160:163], v[128:131], v[48:51]
    v_add_f32 v24, v24, v20
    v_mfma_f32_16x16x32_bf16 v[72:75], v[160:163], v[132:135], v[72:75]
    s_add_u32 m0, s43, 0
    s_nop 0
    buffer_load_dwordx4 v13, s[24:27], s48 offen lds
    ds_read_b64_tr_b16 v[200:201], v220 offset:24576
    v_add_f32 v25, v25, v21
    v_mfma_f32_16x16x32_bf16 v[96:99], v[160:163], v[136:139], v[96:99]
    ds_read_b64_tr_b16 v[202:203], v220 offset:30720
    v_mfma_f32_16x16x32_bf16 v[120:123], v[160:163], v[140:143], v[120:123]
    ds_read_b64_tr_b16 v[204:205], v221 offset:24576
    v_fmac_f32 v26, v20, v20
    v_mfma_f32_16x16x32_bf16 v[52:55], v[164:167], v[128:131], v[52:55]
    ds_read_b64_tr_b16 v[206:207], v221 offset:30720
    v_fmac_f32 v27, v21, v21
    v_mfma_f32_16x16x32_bf16 v[76:79], v[164:167], v[132:135], v[76:79]
    s_add_u32 s48, s48, 98304
    v_lshlrev_b32 v22, 16, v131
    v_mfma_f32_16x16x32_bf16 v[100:103], v[164:167], v[136:139], v[100:103]
    v_and_b32 v23, s69, v131
    v_mfma_f32_16x16x32_bf16 v[124:127], v[164:167], v[140:143], v[124:127]
    v_add_f32 v24, v24, v22
    v_mfma_f32_16x16x32_bf16 v[232:235], v[144:147], v[228:231], v[232:235]
    v_add_f32 v25, v25, v23
    v_mfma_f32_16x16x32_bf16 v[236:239], v[148:151], v[228:231], v[236:239]
    v_fmac_f32 v26, v22, v22
    v_mfma_f32_16x16x32_bf16 v[240:243], v[152:155], v[228:231], v[240:243]
    v_fmac_f32 v27, v23, v23
    s_waitcnt vmcnt(8) lgkmcnt(0)
    s_barrier
    s_mul_i32 s58, s2, 3
    s_add_u32 s58, s58, s32
    s_cmp_lt_u32 s32, 3
    s_cselect_b32 s58, s58, 4095
    s_cmp_lt_u32 s58, 680
    s_cbranch_scc0 L_b2_skip1_g
    s_mul_i32 s59, s58, 6554
    s_lshr_b32 s59, s59, 16
    s_mul_i32 s60, s59, 10
    s_sub_u32 s60, s58, s60
    s_cmp_lt_u32 s59, 20
    s_cselect_b32 s64, s52, s54
    s_cselect_b32 s65, s53, s55
    s_mov_b32 s66, 1966080
    s_cselect_b32 s66, 819200, s66
    s_mov_b32 s67, 0x00020000
    s_sub_u32 s61, s59, 20
    s_cmp_lt_u32 s59, 20
    s_cselect_b32 s61, s59, s61
    s_mul_i32 s61, s61, 40960
    s_lshl_b32 s62, s60, 7
    s_add_u32 s61, s61, s62
    s_lshl_b32 s62, s32, 12
    s_add_u32 s62, s62, 147456
    v_lshrrev_b32 v20, 3, v0
    v_and_b32 v21, 7, v0
    v_add_u32 v22, 0, v20
    v_lshrrev_b32 v246, 1, v22
    v_and_b32 v246, 4, v246
    v_lshlrev_b32 v247, 1, v22
    v_and_b32 v247, 8, v247
    v_and_b32 v23, 0x13, v22
    v_or3_b32 v23, v23, v246, v247
    v_mul_u32_u24 v23, 1280, v23
    v_lshl_add_u32 v23, v21, 4, v23
    s_add_u32 m0, s62, 0
    s_nop 0
    buffer_load_dwordx4 v23, s[64:67], s61 offen lds
    v_add_u32 v22, 8, v20
    v_lshrrev_b32 v246, 1, v22
    v_and_b32 v246, 4, v246
    v_lshlrev_b32 v247, 1, v22
    v_and_b32 v247, 8, v247
    v_and_b32 v23, 0x13, v22
    v_or3_b32 v23, v23, v246, v247
    v_mul_u32_u24 v23, 1280, v23
    v_lshl_add_u32 v23, v21, 4, v23
    s_add_u32 m0, s62, 1024
    s_nop 0
    buffer_load_dwordx4 v23, s[64:67], s61 offen lds
    v_add_u32 v22, 16, v20
    v_lshrrev_b32 v246, 1, v22
    v_and_b32 v246, 4, v246
    v_lshlrev_b32 v247, 1, v22
    v_and_b32 v247, 8, v247
    v_and_b32 v23, 0x13, v22
    v_or3_b32 v23, v23, v246, v247
    v_mul_u32_u24 v23, 1280, v23
    v_lshl_add_u32 v23, v21, 4, v23
    s_add_u32 m0, s62, 2048
    s_nop 0
    buffer_load_dwordx4 v23, s[64:67], s61 offen lds
    v_add_u32 v22, 24, v20
    v_lshrrev_b32 v246, 1, v22
    v_and_b32 v246, 4, v246
    v_lshlrev_b32 v247, 1, v22
    v_and_b32 v247, 8, v247
    v_and_b32 v23, 0x13, v22
    v_or3_b32 v23, v23, v246, v247
    v_mul_u32_u24 v23, 1280, v23
    v_lshl_add_u32 v23, v21, 4, v23
    s_add_u32 m0, s62, 3072
    s_nop 0
    buffer_load_dwordx4 v23, s[64:67], s61 offen lds
L_b2_skip1_g:
    v_mfma_f32_16x16x32_bf16 v[32:35], v[184:187], v[168:171], v[32:35]
    s_add_u32 m0, s41, 24576
    s_nop 0
    buffer_load_dwordx4 v12, s[16:19], s48 offen lds
    v_mfma_f32_16x16x32_bf16 v[56:59], v[184:187], v[172:175], v[56:59]
    ds_read_b128 v[128:131], v208 offset:32768
    v_lshlrev_b32 v20, 16, v168
    v_mfma_f32_16x16x32_bf16 v[80:83], v[184:187], v[176:179], v[80:83]
    ds_read_b128 v[132:135], v209 offset:32768
    v_and_b32 v21, s69, v168
    v_mfma_f32_16x16x32_bf16 v[104:107], v[184:187], v[180:183], v[104:107]
    ds_read_b128 v[136:139], v210 offset:32768
    v_add_f32 v24, v24, v20
    v_mfma_f32_16x16x32_bf16 v[36:39], v[188:191], v[168:171], v[36:39]
    v_add_f32 v25, v25, v21
    v_mfma_f32_16x16x32_bf16 v[60:63], v[188:191], v[172:175], v[60:63]
    ds_read_b128 v[140:143], v211 offset:32768
    v_fmac_f32 v26, v20, v20
    v_mfma_f32_16x16x32_bf16 v[84:87], v[188:191], v[176:179], v[84:87]
    ds_read_b64_tr_b16 v[144:145], v222 offset:0
    v_fmac_f32 v27, v21, v21
    v_mfma_f32_16x16x32_bf16 v[108:111], v[188:191], v[180:183], v[108:111]
    s_add_u32 m0, s42, 24576
    s_nop 0
    buffer_load_dwordx4 v12, s[20:23], s48 offen lds
    ds_read_b64_tr_b16 v[146:147], v222 offset:6144
    v_lshlrev_b32 v22, 16, v169
    v_mfma_f32_16x16x32_bf16 v[40:43], v[192:195], v[168:171], v[40:43]
    v_and_b32 v23, s69, v169
    v_mfma_f32_16x16x32_bf16 v[64:67], v[192:195], v[172:175], v[64:67]
    ds_read_b64_tr_b16 v[148:149], v223 offset:0
    v_mfma_f32_16x16x32_bf16 v[88:91], v[192:195], v[176:179], v[88:91]
    ds_read_b64_tr_b16 v[150:151], v223 offset:6144
    v_add_f32 v24, v24, v22
    v_mfma_f32_16x16x32_bf16 v[112:115], v[192:195], v[180:183], v[112:115]
    ds_read_b64_tr_b16 v[152:153], v224 offset:0
    v_add_f32 v25, v25, v23
    v_mfma_f32_16x16x32_bf16 v[44:47], v[196:199], v[168:171], v[44:47]
    v_fmac_f32 v26, v22, v22
    v_mfma_f32_16x16x32_bf16 v[68:71], v[196:199], v[172:175], v[68:71]
    s_add_u32 m0, s43, 24576
    s_nop 0
    buffer_load_dwordx4 v13, s[24:27], s48 offen lds
    ds_read_b64_tr_b16 v[154:155], v224 offset:6144
    v_fmac_f32 v27, v23, v23
    v_mfma_f32_16x16x32_bf16 v[92:95], v[196:199], v[176:179], v[92:95]
    ds_read_b64_tr_b16 v[156:157], v225 offset:0
    v_lshlrev_b32 v20, 16, v170
    v_mfma_f32_16x16x32_bf16 v[116:119], v[196:199], v[180:183], v[116:119]
    ds_read_b64_tr_b16 v[158:159], v225 offset:6144
    v_and_b32 v21, s69, v170
    v_mfma_f32_16x16x32_bf16 v[48:51], v[200:203], v[168:171], v[48:51]
    v_add_f32 v24, v24, v20
    v_mfma_f32_16x16x32_bf16 v[72:75], v[200:203], v[172:175], v[72:75]
    ds_read_b64_tr_b16 v[160:161], v226 offset:0
    v_add_f32 v25, v25, v21
    v_mfma_f32_16x16x32_bf16 v[96:99], v[200:203], v[176:179], v[96:99]
    ds_read_b64_tr_b16 v[162:163], v226 offset:6144
    v_mfma_f32_16x16x32_bf16 v[120:123], v[200:203], v[180:183], v[120:123]
    s_add_u32 s48, s48, 98304
    ds_read_b64_tr_b16 v[164:165], v227 offset:0
    v_fmac_f32 v26, v20, v20
    v_mfma_f32_16x16x32_bf16 v[52:55], v[204:207], v[168:171], v[52:55]
    ds_read_b64_tr_b16 v[166:167], v227 offset:6144
    v_fmac_f32 v27, v21, v21
    v_mfma_f32_16x16x32_bf16 v[76:79], v[204:207], v[172:175], v[76:79]
    v_lshlrev_b32 v22, 16, v171
    v_mfma_f32_16x16x32_bf16 v[100:103], v[204:207], v[176:179], v[100:103]
    v_and_b32 v23, s69, v171
    v_mfma_f32_16x16x32_bf16 v[124:127], v[204:207], v[180:183], v[124:127]
    v_add_f32 v24, v24, v22
    v_mfma_f32_16x16x32_bf16 v[232:235], v[184:187], v[228:231], v[232:235]
    v_add_f32 v25, v25, v23
    v_mfma_f32_16x16x32_bf16 v[236:239], v[188:191], v[228:231], v[236:239]
    v_fmac_f32 v26, v22, v22
    v_mfma_f32_16x16x32_bf16 v[240:243], v[192:195], v[228:231], v[240:243]
    v_fmac_f32 v27, v23, v23
    s_waitcnt vmcnt(8) lgkmcnt(0)
    s_barrier
    v_mfma_f32_16x16x32_bf16 v[32:35], v[144:147], v[128:131], v[32:35]
    s_add_u32 m0, s40, 16384
    s_nop 0
    buffer_load_dwordx4 v10, s[28:31], s47 offen lds
    v_mfma_f32_16x16x32_bf16 v[56:59], v[144:147], v[132:135], v[56:59]
    ds_read_b128 v[168:171], v212 offset:32768
    v_lshlrev_b32 v20, 16, v128
    v_mfma_f32_16x16x32_bf16 v[80:83], v[144:147], v[136:139], v[80:83]
    ds_read_b128 v[172:175], v213 offset:32768
    v_and_b32 v21, s69, v128
    v_mfma_f32_16x16x32_bf16 v[104:107], v[144:147], v[140:143], v[104:107]
    ds_read_b128 v[176:179], v214 offset:32768
    v_add_f32 v24, v24, v20
    v_mfma_f32_16x16x32_bf16 v[36:39], v[148:151], v[128:131], v[36:39]
    v_add_f32 v25, v25, v21
    v_mfma_f32_16x16x32_bf16 v[60:63], v[148:151], v[132:135], v[60:63]
    s_add_u32 m0, s40, 24576
    s_nop 0
    buffer_load_dwordx4 v11, s[28:31], s47 offen lds
    ds_read_b128 v[180:183], v215 offset:32768
    v_fmac_f32 v26, v20, v20
    v_mfma_f32_16x16x32_bf16 v[84:87], v[148:151], v[136:139], v[84:87]
    ds_read_b64_tr_b16 v[184:185], v222 offset:24576
    v_fmac_f32 v27, v21, v21
    v_mfma_f32_16x16x32_bf16 v[108:111], v[148:151], v[140:143], v[108:111]
    ds_read_b64_tr_b16 v[186:187], v222 offset:30720
    v_lshlrev_b32 v22, 16, v129
    v_mfma_f32_16x16x32_bf16 v[40:43], v[152:155], v[128:131], v[40:43]
    v_and_b32 v23, s69, v129
    v_mfma_f32_16x16x32_bf16 v[64:67], v[152:155], v[132:135], v[64:67]
    s_add_u32 s47, s47, 128
    s_add_u32 m0, s41, 49152
    s_nop 0
    buffer_load_dwordx4 v12, s[16:19], s48 offen lds
    ds_read_b64_tr_b16 v[188:189], v223 offset:24576
    v_mfma_f32_16x16x32_bf16 v[88:91], v[152:155], v[136:139], v[88:91]
    ds_read_b64_tr_b16 v[190:191], v223 offset:30720
    v_add_f32 v24, v24, v22
    v_mfma_f32_16x16x32_bf16 v[112:115], v[152:155], v[140:143], v[112:115]
    ds_read_b64_tr_b16 v[192:193], v224 offset:24576
    v_add_f32 v25, v25, v23
    v_mfma_f32_16x16x32_bf16 v[44:47], v[156:159], v[128:131], v[44:47]
    v_fmac_f32 v26, v22, v22
    v_mfma_f32_16x16x32_bf16 v[68:71], v[156:159], v[132:135], v[68:71]
    s_add_u32 m0, s42, 49152
    s_nop 0
    buffer_load_dwordx4 v12, s[20:23], s48 offen lds
    ds_read_b64_tr_b16 v[194:195], v224 offset:30720
    v_fmac_f32 v27, v23, v23
    v_mfma_f32_16x16x32_bf16 v[92:95], v[156:159], v[136:139], v[92:95]
    ds_read_b64_tr_b16 v[196:197], v225 offset:24576
    v_lshlrev_b32 v20, 16, v130
    v_mfma_f32_16x16x32_bf16 v[116:119], v[156:159], v[140:143], v[116:119]
    ds_read_b64_tr_b16 v[198:199], v225 offset:30720
    v_and_b32 v21, s69, v130
    v_mfma_f32_16x16x32_bf16 v[48:51], v[160:163], v[128:131], v[48:51]
    v_add_f32 v24, v24, v20
    v_mfma_f32_16x16x32_bf16 v[72:75], v[160:163], v[132:135], v[72:75]
    s_add_u32 m0, s43, 49152
    s_nop 0
    buffer_load_dwordx4 v13, s[24:27], s48 offen lds
    ds_read_b64_tr_b16 v[200:201], v226 offset:24576
    v_add_f32 v25, v25, v21
    v_mfma_f32_16x16x32_bf16 v[96:99], v[160:163], v[136:139], v[96:99]
    ds_read_b64_tr_b16 v[202:203], v226 offset:30720
    v_mfma_f32_16x16x32_bf16 v[120:123], v[160:163], v[140:143], v[120:123]
    ds_read_b64_tr_b16 v[204:205], v227 offset:24576
    v_fmac_f32 v26, v20, v20
    v_mfma_f32_16x16x32_bf16 v[52:55], v[164:167], v[128:131], v[52:55]
    ds_read_b64_tr_b16 v[206:207], v227 offset:30720
    v_fmac_f32 v27, v21, v21
    v_mfma_f32_16x16x32_bf16 v[76:79], v[164:167], v[132:135], v[76:79]
    s_add_u32 s48, s48, 98304
    v_lshlrev_b32 v22, 16, v131
    v_mfma_f32_16x16x32_bf16 v[100:103], v[164:167], v[136:139], v[100:103]
    v_and_b32 v23, s69, v131
    v_mfma_f32_16x16x32_bf16 v[124:127], v[164:167], v[140:143], v[124:127]
    v_add_f32 v24, v24, v22
    v_mfma_f32_16x16x32_bf16 v[232:235], v[144:147], v[228:231], v[232:235]
    v_add_f32 v25, v25, v23
    v_mfma_f32_16x16x32_bf16 v[236:239], v[148:151], v[228:231], v[236:239]
    v_fmac_f32 v26, v22, v22
    v_mfma_f32_16x16x32_bf16 v[240:243], v[152:155], v[228:231], v[240:243]
    v_fmac_f32 v27, v23, v23
    s_waitcnt vmcnt(8) lgkmcnt(0)
    s_barrier
    v_mfma_f32_16x16x32_bf16 v[32:35], v[184:187], v[168:171], v[32:35]
    s_add_u32 m0, s41, 73728
    s_nop 0
    buffer_load_dwordx4 v12, s[16:19], s48 offen lds
    v_mfma_f32_16x16x32_bf16 v[56:59], v[184:187], v[172:175], v[56:59]
    ds_read_b128 v[128:131], v208 offset:0
    v_lshlrev_b32 v20, 16, v168
    v_mfma_f32_16x16x32_bf16 v[80:83], v[184:187], v[176:179], v[80:83]
    ds_read_b128 v[132:135], v209 offset:0
    v_and_b32 v21, s69, v168
    v_mfma_f32_16x16x32_bf16 v[104:107], v[184:187], v[180:183], v[104:107]
    ds_read_b128 v[136:139], v210 offset:0
    v_add_f32 v24, v24, v20
    v_mfma_f32_16x16x32_bf16 v[36:39], v[188:191], v[168:171], v[36:39]
    v_add_f32 v25, v25, v21
    v_mfma_f32_16x16x32_bf16 v[60:63], v[188:191], v[172:175], v[60:63]
    ds_read_b128 v[140:143], v211 offset:0
    v_fmac_f32 v26, v20, v20
    v_mfma_f32_16x16x32_bf16 v[84:87], v[188:191], v[176:179], v[84:87]
    ds_read_b64_tr_b16 v[144:145], v216 offset:0
    v_fmac_f32 v27, v21, v21
    v_mfma_f32_16x16x32_bf16 v[108:111], v[188:191], v[180:183], v[108:111]
    s_add_u32 m0, s42, 73728
    s_nop 0
    buffer_load_dwordx4 v12, s[20:23], s48 offen lds
    ds_read_b64_tr_b16 v[146:147], v216 offset:6144
    v_lshlrev_b32 v22, 16, v169
    v_mfma_f32_16x16x32_bf16 v[40:43], v[192:195], v[168:171], v[40:43]
    v_and_b32 v23, s69, v169
    v_mfma_f32_16x16x32_bf16 v[64:67], v[192:195], v[172:175], v[64:67]
    ds_read_b64_tr_b16 v[148:149], v217 offset:0
    v_mfma_f32_16x16x32_bf16 v[88:91], v[192:195], v[176:179], v[88:91]
    ds_read_b64_tr_b16 v[150:151], v217 offset:6144
    v_add_f32 v24, v24, v22
    v_mfma_f32_16x16x32_bf16 v[112:115], v[192:195], v[180:183], v[112:115]
    ds_read_b64_tr_b16 v[152:153], v218 offset:0
    v_add_f32 v25, v25, v23
    v_mfma_f32_16x16x32_bf16 v[44:47], v[196:199], v[168:171], v[44:47]
    v_fmac_f32 v26, v22, v22
    v_mfma_f32_16x16x32_bf16 v[68:71], v[196:199], v[172:175], v[68:71]
    s_add_u32 m0, s43, 73728
    s_nop 0
    buffer_load_dwordx4 v13, s[24:27], s48 offen lds
    ds_read_b64_tr_b16 v[154:155], v218 offset:6144
    v_fmac_f32 v27, v23, v23
    v_mfma_f32_16x16x32_bf16 v[92:95], v[196:199], v[176:179], v[92:95]
    ds_read_b64_tr_b16 v[156:157], v219 offset:0
    v_lshlrev_b32 v20, 16, v170
    v_mfma_f32_16x16x32_bf16 v[116:119], v[196:199], v[180:183], v[116:119]
    ds_read_b64_tr_b16 v[158:159], v219 offset:6144
    v_and_b32 v21, s69, v170
    v_mfma_f32_16x16x32_bf16 v[48:51], v[200:203], v[168:171], v[48:51]
    v_add_f32 v24, v24, v20
    v_mfma_f32_16x16x32_bf16 v[72:75], v[200:203], v[172:175], v[72:75]
    ds_read_b64_tr_b16 v[160:161], v220 offset:0
    v_add_f32 v25, v25, v21
    v_mfma_f32_16x16x32_bf16 v[96:99], v[200:203], v[176:179], v[96:99]
    ds_read_b64_tr_b16 v[162:163], v220 offset:6144
    v_mfma_f32_16x16x32_bf16 v[120:123], v[200:203], v[180:183], v[120:123]
    s_add_u32 s48, s48, 98304
    ds_read_b64_tr_b16 v[164:165], v221 offset:0
    v_fmac_f32 v26, v20, v20
    v_mfma_f32_16x16x32_bf16 v[52:55], v[204:207], v[168:171], v[52:55]
    ds_read_b64_tr_b16 v[166:167], v221 offset:6144
    v_fmac_f32 v27, v21, v21
    v_mfma_f32_16x16x32_bf16 v[76:79], v[204:207], v[172:175], v[76:79]
    v_lshlrev_b32 v22, 16, v171
    v_mfma_f32_16x16x32_bf16 v[100:103], v[204:207], v[176:179], v[100:103]
    v_and_b32 v23, s69, v171
    v_mfma_f32_16x16x32_bf16 v[124:127], v[204:207], v[180:183], v[124:127]
    v_add_f32 v24, v24, v22
    v_mfma_f32_16x16x32_bf16 v[232:235], v[184:187], v[228:231], v[232:235]
    v_add_f32 v25, v25, v23
    v_mfma_f32_16x16x32_bf16 v[236:239], v[188:191], v[228:231], v[236:239]
    v_fmac_f32 v26, v22, v22
    v_mfma_f32_16x16x32_bf16 v[240:243], v[192:195], v[228:231], v[240:243]
    v_fmac_f32 v27, v23, v23
    s_waitcnt vmcnt(8) lgkmcnt(0)
    s_barrier
    v_mfma_f32_16x16x32_bf16 v[32:35], v[144:147], v[128:131], v[32:35]
    s_add_u32 m0, s40, 32768
    s_nop 0
    buffer_load_dwordx4 v10, s[28:31], s47 offen lds
    v_mfma_f32_16x16x32_bf16 v[56:59], v[144:147], v[132:135], v[56:59]
    ds_read_b128 v[168:171], v212 offset:0
    v_lshlrev_b32 v20, 16, v128
    v_mfma_f32_16x16x32_bf16 v[80:83], v[144:147], v[136:139], v[80:83]
    ds_read_b128 v[172:175], v213 offset:0
    v_and_b32 v21, s69, v128
    v_mfma_f32_16x16x32_bf16 v[104:107], v[144:147], v[140:143], v[104:107]
    ds_read_b128 v[176:179], v214 offset:0
    v_add_f32 v24, v24, v20
    v_mfma_f32_16x16x32_bf16 v[36:39], v[148:151], v[128:131], v[36:39]
    v_add_f32 v25, v25, v21
    v_mfma_f32_16x16x32_bf16 v[60:63], v[148:151], v[132:135], v[60:63]
    s_add_u32 m0, s40, 40960
    s_nop 0
    buffer_load_dwordx4 v11, s[28:31], s47 offen lds
    ds_read_b128 v[180:183], v215 offset:0
    v_fmac_f32 v26, v20, v20
    v_mfma_f32_16x16x32_bf16 v[84:87], v[148:151], v[136:139], v[84:87]
    ds_read_b64_tr_b16 v[184:185], v216 offset:24576
    v_fmac_f32 v27, v21, v21
    v_mfma_f32_16x16x32_bf16 v[108:111], v[148:151], v[140:143], v[108:111]
    ds_read_b64_tr_b16 v[186:187], v216 offset:30720
    v_lshlrev_b32 v22, 16, v129
    v_mfma_f32_16x16x32_bf16 v[40:43], v[152:155], v[128:131], v[40:43]
    v_and_b32 v23, s69, v129
    v_mfma_f32_16x16x32_bf16 v[64:67], v[152:155], v[132:135], v[64:67]
    s_add_u32 s47, s47, 128
    s_add_u32 m0, s41, 0
    s_nop 0
    buffer_load_dwordx4 v12, s[16:19], s48 offen lds
    ds_read_b64_tr_b16 v[188:189], v217 offset:24576
    v_mfma_f32_16x16x32_bf16 v[88:91], v[152:155], v[136:139], v[88:91]
    ds_read_b64_tr_b16 v[190:191], v217 offset:30720
    v_add_f32 v24, v24, v22
    v_mfma_f32_16x16x32_bf16 v[112:115], v[152:155], v[140:143], v[112:115]
    ds_read_b64_tr_b16 v[192:193], v218 offset:24576
    v_add_f32 v25, v25, v23
    v_mfma_f32_16x16x32_bf16 v[44:47], v[156:159], v[128:131], v[44:47]
    v_fmac_f32 v26, v22, v22
    v_mfma_f32_16x16x32_bf16 v[68:71], v[156:159], v[132:135], v[68:71]
    s_add_u32 m0, s42, 0
    s_nop 0
    buffer_load_dwordx4 v12, s[20:23], s48 offen lds
    ds_read_b64_tr_b16 v[194:195], v218 offset:30720
    v_fmac_f32 v27, v23, v23
    v_mfma_f32_16x16x32_bf16 v[92:95], v[156:159], v[136:139], v[92:95]
    ds_read_b64_tr_b16 v[196:197], v219 offset:24576
    v_lshlrev_b32 v20, 16, v130
    v_mfma_f32_16x16x32_bf16 v[116:119], v[156:159], v[140:143], v[116:119]
    ds_read_b64_tr_b16 v[198:199], v219 offset:30720
    v_and_b32 v21, s69, v130
    v_mfma_f32_16x16x32_bf16 v[48:51], v[160:163], v[128:131], v[48:51]
    v_add_f32 v24, v24, v20
    v_mfma_f32_16x16x32_bf16 v[72:75], v[160:163], v[132:135], v[72:75]
    s_add_u32 m0, s43, 0
    s_nop 0
    buffer_load_dwordx4 v13, s[24:27], s48 offen lds
    ds_read_b64_tr_b16 v[200:201], v220 offset:24576
    v_add_f32 v25, v25, v21
    v_mfma_f32_16x16x32_bf16 v[96:99], v[160:163], v[136:139], v[96:99]
    ds_read_b64_tr_b16 v[202:203], v220 offset:30720
    v_mfma_f32_16x16x32_bf16 v[120:123], v[160:163], v[140:143], v[120:123]
    ds_read_b64_tr_b16 v[204:205], v221 offset:24576
    v_fmac_f32 v26, v20, v20
    v_mfma_f32_16x16x32_bf16 v[52:55], v[164:167], v[128:131], v[52:55]
    ds_read_b64_tr_b16 v[206:207], v221 offset:30720
    v_fmac_f32 v27, v21, v21
    v_mfma_f32_16x16x32_bf16 v[76:79], v[164:167], v[132:135], v[76:79]
    s_add_u32 s48, s48, 98304
    v_lshlrev_b32 v22, 16, v131
    v_mfma_f32_16x16x32_bf16 v[100:103], v[164:167], v[136:139], v[100:103]
    v_and_b32 v23, s69, v131
    v_mfma_f32_16x16x32_bf16 v[124:127], v[164:167], v[140:143], v[124:127]
    v_add_f32 v24, v24, v22
    v_mfma_f32_16x16x32_bf16 v[232:235], v[144:147], v[228:231], v[232:235]
    v_add_f32 v25, v25, v23
    v_mfma_f32_16x16x32_bf16 v[236:239], v[148:151], v[228:231], v[236:239]
    v_fmac_f32 v26, v22, v22
    v_mfma_f32_16x16x32_bf16 v[240:243], v[152:155], v[228:231], v[240:243]
    v_fmac_f32 v27, v23, v23
    s_waitcnt vmcnt(8) lgkmcnt(0)
    s_barrier
    v_mfma_f32_16x16x32_bf16 v[32:35], v[184:187], v[168:171], v[32:35]
    s_add_u32 m0, s41, 24576
    s_nop 0
    buffer_load_dwordx4 v12, s[16:19], s48 offen lds
    v_mfma_f32_16x16x32_bf16 v[56:59], v[184:187], v[172:175], v[56:59]
    ds_read_b128 v[128:131], v208 offset:16384
    v_lshlrev_b32 v20, 16, v168
    v_mfma_f32_16x16x32_bf16 v[80:83], v[184:187], v[176:179], v[80:83]
    ds_read_b128 v[132:135], v209 offset:16384
    v_and_b32 v21, s69, v168
    v_mfma_f32_16x16x32_bf16 v[104:107], v[184:187], v[180:183], v[104:107]
    ds_read_b128 v[136:139], v210 offset:16384
    v_add_f32 v24, v24, v20
    v_mfma_f32_16x16x32_bf16 v[36:39], v[188:191], v[168:171], v[36:39]
    v_add_f32 v25, v25, v21
    v_mfma_f32_16x16x32_bf16 v[60:63], v[188:191], v[172:175], v[60:63]
    ds_read_b128 v[140:143], v211 offset:16384
    v_fmac_f32 v26, v20, v20
    v_mfma_f32_16x16x32_bf16 v[84:87], v[188:191], v[176:179], v[84:87]
    ds_read_b64_tr_b16 v[144:145], v222 offset:0
    v_fmac_f32 v27, v21, v21
    v_mfma_f32_16x16x32_bf16 v[108:111], v[188:191], v[180:183], v[108:111]
    s_add_u32 m0, s42, 24576
    s_nop 0
    buffer_load_dwordx4 v12, s[20:23], s48 offen lds
    ds_read_b64_tr_b16 v[146:147], v222 offset:6144
    v_lshlrev_b32 v22, 16, v169
    v_mfma_f32_16x16x32_bf16 v[40:43], v[192:195], v[168:171], v[40:43]
    v_and_b32 v23, s69, v169
    v_mfma_f32_16x16x32_bf16 v[64:67], v[192:195], v[172:175], v[64:67]
    ds_read_b64_tr_b16 v[148:149], v223 offset:0
    v_mfma_f32_16x16x32_bf16 v[88:91], v[192:195], v[176:179], v[88:91]
    ds_read_b64_tr_b16 v[150:151], v223 offset:6144
    v_add_f32 v24, v24, v22
    v_mfma_f32_16x16x32_bf16 v[112:115], v[192:195], v[180:183], v[112:115]
    ds_read_b64_tr_b16 v[152:153], v224 offset:0
    v_add_f32 v25, v25, v23
    v_mfma_f32_16x16x32_bf16 v[44:47], v[196:199], v[168:171], v[44:47]
    v_fmac_f32 v26, v22, v22
    v_mfma_f32_16x16x32_bf16 v[68:71], v[196:199], v[172:175], v[68:71]
    s_add_u32 m0, s43, 24576
    s_nop 0
    buffer_load_dwordx4 v13, s[24:27], s48 offen lds
    ds_read_b64_tr_b16 v[154:155], v224 offset:6144
    v_fmac_f32 v27, v23, v23
    v_mfma_f32_16x16x32_bf16 v[92:95], v[196:199], v[176:179], v[92:95]
    ds_read_b64_tr_b16 v[156:157], v225 offset:0
    v_lshlrev_b32 v20, 16, v170
    v_mfma_f32_16x16x32_bf16 v[116:119], v[196:199], v[180:183], v[116:119]
    ds_read_b64_tr_b16 v[158:159], v225 offset:6144
    v_and_b32 v21, s69, v170
    v_mfma_f32_16x16x32_bf16 v[48:51], v[200:203], v[168:171], v[48:51]
    v_add_f32 v24, v24, v20
    v_mfma_f32_16x16x32_bf16 v[72:75], v[200:203], v[172:175], v[72:75]
    ds_read_b64_tr_b16 v[160:161], v226 offset:0
    v_add_f32 v25, v25, v21
    v_mfma_f32_16x16x32_bf16 v[96:99], v[200:203], v[176:179], v[96:99]
    ds_read_b64_tr_b16 v[162:163], v226 offset:6144
    v_mfma_f32_16x16x32_bf16 v[120:123], v[200:203], v[180:183], v[120:123]
    s_add_u32 s48, s48, 98304
    ds_read_b64_tr_b16 v[164:165], v227 offset:0
    v_fmac_f32 v26, v20, v20
    v_mfma_f32_16x16x32_bf16 v[52:55], v[204:207], v[168:171], v[52:55]
    ds_read_b64_tr_b16 v[166:167], v227 offset:6144
    v_fmac_f32 v27, v21, v21
    v_mfma_f32_16x16x32_bf16 v[76:79], v[204:207], v[172:175], v[76:79]
    v_lshlrev_b32 v22, 16, v171
    v_mfma_f32_16x16x32_bf16 v[100:103], v[204:207], v[176:179], v[100:103]
    v_and_b32 v23, s69, v171
    v_mfma_f32_16x16x32_bf16 v[124:127], v[204:207], v[180:183], v[124:127]
    v_add_f32 v24, v24, v22
    v_mfma_f32_16x16x32_bf16 v[232:235], v[184:187], v[228:231], v[232:235]
    v_add_f32 v25, v25, v23
    v_mfma_f32_16x16x32_bf16 v[236:239], v[188:191], v[228:231], v[236:239]
    v_fmac_f32 v26, v22, v22
    v_mfma_f32_16x16x32_bf16 v[240:243], v[192:195], v[228:231], v[240:243]
    v_fmac_f32 v27, v23, v23
    s_waitcnt vmcnt(8) lgkmcnt(0)
    s_barrier
    v_mfma_f32_16x16x32_bf16 v[32:35], v[144:147], v[128:131], v[32:35]
    s_add_u32 m0, s40, 0
    s_nop 0
    buffer_load_dwordx4 v10, s[28:31], s47 offen lds
    v_mfma_f32_16x16x32_bf16 v[56:59], v[144:147], v[132:135], v[56:59]
    ds_read_b128 v[168:171], v212 offset:16384
    v_lshlrev_b32 v20, 16, v128
    v_mfma_f32_16x16x32_bf16 v[80:83], v[144:147], v[136:139], v[80:83]
    ds_read_b128 v[172:175], v213 offset:16384
    v_and_b32 v21, s69, v128
    v_mfma_f32_16x16x32_bf16 v[104:107], v[144:147], v[140:143], v[104:107]
    ds_read_b128 v[176:179], v214 offset:16384
    v_add_f32 v24, v24, v20
    v_mfma_f32_16x16x32_bf16 v[36:39], v[148:151], v[128:131], v[36:39]
    v_add_f32 v25, v25, v21
    v_mfma_f32_16x16x32_bf16 v[60:63], v[148:151], v[132:135], v[60:63]
    s_add_u32 m0, s40, 8192
    s_nop 0
    buffer_load_dwordx4 v11, s[28:31], s47 offen lds
    ds_read_b128 v[180:183], v215 offset:16384
    v_fmac_f32 v26, v20, v20
    v_mfma_f32_16x16x32_bf16 v[84:87], v[148:151], v[136:139], v[84:87]
    ds_read_b64_tr_b16 v[184:185], v222 offset:24576
    v_fmac_f32 v27, v21, v21
    v_mfma_f32_16x16x32_bf16 v[108:111], v[148:151], v[140:143], v[108:111]
    ds_read_b64_tr_b16 v[186:187], v222 offset:30720
    v_lshlrev_b32 v22, 16, v129
    v_mfma_f32_16x16x32_bf16 v[40:43], v[152:155], v[128:131], v[40:43]
    v_and_b32 v23, s69, v129
    v_mfma_f32_16x16x32_bf16 v[64:67], v[152:155], v[132:135], v[64:67]
    s_add_u32 s47, s47, 128
    s_add_u32 m0, s41, 49152
    s_nop 0
    buffer_load_dwordx4 v12, s[16:19], s48 offen lds
    ds_read_b64_tr_b16 v[188:189], v223 offset:24576
    v_mfma_f32_16x16x32_bf16 v[88:91], v[152:155], v[136:139], v[88:91]
    ds_read_b64_tr_b16 v[190:191], v223 offset:30720
    v_add_f32 v24, v24, v22
    v_mfma_f32_16x16x32_bf16 v[112:115], v[152:155], v[140:143], v[112:115]
    ds_read_b64_tr_b16 v[192:193], v224 offset:24576
    v_add_f32 v25, v25, v23
    v_mfma_f32_16x16x32_bf16 v[44:47], v[156:159], v[128:131], v[44:47]
    v_fmac_f32 v26, v22, v22
    v_mfma_f32_16x16x32_bf16 v[68:71], v[156:159], v[132:135], v[68:71]
    s_add_u32 m0, s42, 49152
    s_nop 0
    buffer_load_dwordx4 v12, s[20:23], s48 offen lds
    ds_read_b64_tr_b16 v[194:195], v224 offset:30720
    v_fmac_f32 v27, v23, v23
    v_mfma_f32_16x16x32_bf16 v[92:95], v[156:159], v[136:139], v[92:95]
    ds_read_b64_tr_b16 v[196:197], v225 offset:24576
    v_lshlrev_b32 v20, 16, v130
    v_mfma_f32_16x16x32_bf16 v[116:119], v[156:159], v[140:143], v[116:119]
    ds_read_b64_tr_b16 v[198:199], v225 offset:30720
    v_and_b32 v21, s69, v130
    v_mfma_f32_16x16x32_bf16 v[48:51], v[160:163], v[128:131], v[48:51]
    v_add_f32 v24, v24, v20
    v_mfma_f32_16x16x32_bf16 v[72:75], v[160:163], v[132:135], v[72:75]
    s_add_u32 m0, s43, 49152
    s_nop 0
    buffer_load_dwordx4 v13, s[24:27], s48 offen lds
    ds_read_b64_tr_b16 v[200:201], v226 offset:24576
    v_add_f32 v25, v25, v21
    v_mfma_f32_16x16x32_bf16 v[96:99], v[160:163], v[136:139], v[96:99]
    ds_read_b64_tr_b16 v[202:203], v226 offset:30720
    v_mfma_f32_16x16x32_bf16 v[120:123], v[160:163], v[140:143], v[120:123]
    ds_read_b64_tr_b16 v[204:205], v227 offset:24576
    v_fmac_f32 v26, v20, v20
    v_mfma_f32_16x16x32_bf16 v[52:55], v[164:167], v[128:131], v[52:55]
    ds_read_b64_tr_b16 v[206:207], v227 offset:30720
    v_fmac_f32 v27, v21, v21
    v_mfma_f32_16x16x32_bf16 v[76:79], v[164:167], v[132:135], v[76:79]
    s_add_u32 s48, s48, 98304
    v_lshlrev_b32 v22, 16, v131
    v_mfma_f32_16x16x32_bf16 v[100:103], v[164:167], v[136:139], v[100:103]
    v_and_b32 v23, s69, v131
    v_mfma_f32_16x16x32_bf16 v[124:127], v[164:167], v[140:143], v[124:127]
    v_add_f32 v24, v24, v22
    v_mfma_f32_16x16x32_bf16 v[232:235], v[144:147], v[228:231], v[232:235]
    v_add_f32 v25, v25, v23
    v_mfma_f32_16x16x32_bf16 v[236:239], v[148:151], v[228:231], v[236:239]
    v_fmac_f32 v26, v22, v22
    v_mfma_f32_16x16x32_bf16 v[240:243], v[152:155], v[228:231], v[240:243]
    v_fmac_f32 v27, v23, v23
    s_waitcnt vmcnt(8) lgkmcnt(0)
    s_barrier
    s_cmp_lt_u32 s58, 680
    s_cbranch_scc0 L_b2_skip2_g
    v_lshlrev_b32 v1, 7, v9
    v_lshl_add_u32 v1, v4, 3, v1
    v_add_u32 v1, s62, v1
    ds_read_b64_tr_b16 v[244:245], v1 offset:0
    ds_read_b64_tr_b16 v[246:247], v1 offset:1024
    ds_read_b64_tr_b16 v[248:249], v1 offset:32
    ds_read_b64_tr_b16 v[250:251], v1 offset:1056
    ds_read_b64_tr_b16 v[252:253], v1 offset:64
    ds_read_b64_tr_b16 v[254:255], v1 offset:1088
    ds_read_b64_tr_b16 v[20:21], v1 offset:96
    ds_read_b64_tr_b16 v[22:23], v1 offset:1120
    s_waitcnt lgkmcnt(0)
    s_lshl_b32 s61, s60, 2
    s_add_u32 s61, s61, 0
    s_mul_i32 s62, s61, 13108
    s_lshr_b32 s62, s62, 16
    s_mul_i32 s63, s62, 5
    s_sub_u32 s63, s61, s63
    s_mul_i32 s62, s62, 68
    s_add_u32 s62, s62, s59
    s_mul_i32 s62, s62, 5
    s_add_u32 s62, s62, s63
    s_lshl_b32 s62, s62, 10
    s_add_u32 s62, s62, 9437184
    buffer_store_dwordx4 v[244:247], v5, s[12:15], s62 offen sc0 sc1
    s_lshl_b32 s61, s60, 2
    s_add_u32 s61, s61, 1
    s_mul_i32 s62, s61, 13108
    s_lshr_b32 s62, s62, 16
    s_mul_i32 s63, s62, 5
    s_sub_u32 s63, s61, s63
    s_mul_i32 s62, s62, 68
    s_add_u32 s62, s62, s59
    s_mul_i32 s62, s62, 5
    s_add_u32 s62, s62, s63
    s_lshl_b32 s62, s62, 10
    s_add_u32 s62, s62, 9437184
    buffer_store_dwordx4 v[248:251], v5, s[12:15], s62 offen sc0 sc1
    s_lshl_b32 s61, s60, 2
    s_add_u32 s61, s61, 2
    s_mul_i32 s62, s61, 13108
    s_lshr_b32 s62, s62, 16
    s_mul_i32 s63, s62, 5
    s_sub_u32 s63, s61, s63
    s_mul_i32 s62, s62, 68
    s_add_u32 s62, s62, s59
    s_mul_i32 s62, s62, 5
    s_add_u32 s62, s62, s63
    s_lshl_b32 s62, s62, 10
    s_add_u32 s62, s62, 9437184
    buffer_store_dwordx4 v[252:255], v5, s[12:15], s62 offen sc0 sc1
    s_lshl_b32 s61, s60, 2
    s_add_u32 s61, s61, 3
    s_mul_i32 s62, s61, 13108
    s_lshr_b32 s62, s62, 16
    s_mul_i32 s63, s62, 5
    s_sub_u32 s63, s61, s63
    s_mul_i32 s62, s62, 68
    s_add_u32 s62, s62, s59
    s_mul_i32 s62, s62, 5
    s_add_u32 s62, s62, s63
    s_lshl_b32 s62, s62, 10
    s_add_u32 s62, s62, 9437184
    buffer_store_dwordx4 v[20:23], v5, s[12:15], s62 offen sc0 sc1
    s_nop 4
L_b2_skip2_g:
    v_mfma_f32_16x16x32_bf16 v[32:35], v[184:187], v[168:171], v[32:35]
    s_add_u32 m0, s41, 73728
    s_nop 0
    buffer_load_dwordx4 v12, s[16:19], s48 offen lds
    v_mfma_f32_16x16x32_bf16 v[56:59], v[184:187], v[172:175], v[56:59]
    ds_read_b128 v[128:131], v208 offset:32768
    v_lshlrev_b32 v20, 16, v168
    v_mfma_f32_16x16x32_bf16 v[80:83], v[184:187], v[176:179], v[80:83]
    ds_read_b128 v[132:135], v209 offset:32768
    v_and_b32 v21, s69, v168
    v_mfma_f32_16x16x32_bf16 v[104:107], v[184:187], v[180:183], v[104:107]
    ds_read_b128 v[136:139], v210 offset:32768
    v_add_f32 v24, v24, v20
    v_mfma_f32_16x16x32_bf16 v[36:39], v[188:191], v[168:171], v[36:39]
    v_add_f32 v25, v25, v21
    v_mfma_f32_16x16x32_bf16 v[60:63], v[188:191], v[172:175], v[60:63]
    ds_read_b128 v[140:143], v211 offset:32768
    v_fmac_f32 v26, v20, v20
    v_mfma_f32_16x16x32_bf16 v[84:87], v[188:191], v[176:179], v[84:87]
    ds_read_b64_tr_b16 v[144:145], v216 offset:0
    v_fmac_f32 v27, v21, v21
    v_mfma_f32_16x16x32_bf16 v[108:111], v[188:191], v[180:183], v[108:111]
    s_add_u32 m0, s42, 73728
    s_nop 0
    buffer_load_dwordx4 v12, s[20:23], s48 offen lds
    ds_read_b64_tr_b16 v[146:147], v216 offset:6144
    v_lshlrev_b32 v22, 16, v169
    v_mfma_f32_16x16x32_bf16 v[40:43], v[192:195], v[168:171], v[40:43]
    v_and_b32 v23, s69, v169
    v_mfma_f32_16x16x32_bf16 v[64:67], v[192:195], v[172:175], v[64:67]
    ds_read_b64_tr_b16 v[148:149], v217 offset:0
    v_mfma_f32_16x16x32_bf16 v[88:91], v[192:195], v[176:179], v[88:91]
    ds_read_b64_tr_b16 v[150:151], v217 offset:6144
    v_add_f32 v24, v24, v22
    v_mfma_f32_16x16x32_bf16 v[112:115], v[192:195], v[180:183], v[112:115]
    ds_read_b64_tr_b16 v[152:153], v218 offset:0
    v_add_f32 v25, v25, v23
    v_mfma_f32_16x16x32_bf16 v[44:47], v[196:199], v[168:171], v[44:47]
    v_fmac_f32 v26, v22, v22
    v_mfma_f32_16x16x32_bf16 v[68:71], v[196:199], v[172:175], v[68:71]
    s_add_u32 m0, s43, 73728
    s_nop 0
    buffer_load_dwordx4 v13, s[24:27], s48 offen lds
    ds_read_b64_tr_b16 v[154:155], v218 offset:6144
    v_fmac_f32 v27, v23, v23
    v_mfma_f32_16x16x32_bf16 v[92:95], v[196:199], v[176:179], v[92:95]
    ds_read_b64_tr_b16 v[156:157], v219 offset:0
    v_lshlrev_b32 v20, 16, v170
    v_mfma_f32_16x16x32_bf16 v[116:119], v[196:199], v[180:183], v[116:119]
    ds_read_b64_tr_b16 v[158:159], v219 offset:6144
    v_and_b32 v21, s69, v170
    v_mfma_f32_16x16x32_bf16 v[48:51], v[200:203], v[168:171], v[48:51]
    v_add_f32 v24, v24, v20
    v_mfma_f32_16x16x32_bf16 v[72:75], v[200:203], v[172:175], v[72:75]
    ds_read_b64_tr_b16 v[160:161], v220 offset:0
    v_add_f32 v25, v25, v21
    v_mfma_f32_16x16x32_bf16 v[96:99], v[200:203], v[176:179], v[96:99]
    ds_read_b64_tr_b16 v[162:163], v220 offset:6144
    v_mfma_f32_16x16x32_bf16 v[120:123], v[200:203], v[180:183], v[120:123]
    s_add_u32 s48, s48, 98304
    ds_read_b64_tr_b16 v[164:165], v221 offset:0
    v_fmac_f32 v26, v20, v20
    v_mfma_f32_16x16x32_bf16 v[52:55], v[204:207], v[168:171], v[52:55]
    ds_read_b64_tr_b16 v[166:167], v221 offset:6144
    v_fmac_f32 v27, v21, v21
    v_mfma_f32_16x16x32_bf16 v[76:79], v[204:207], v[172:175], v[76:79]
    v_lshlrev_b32 v22, 16, v171
    v_mfma_f32_16x16x32_bf16 v[100:103], v[204:207], v[176:179], v[100:103]
    v_and_b32 v23, s69, v171
    v_mfma_f32_16x16x32_bf16 v[124:127], v[204:207], v[180:183], v[124:127]
    v_add_f32 v24, v24, v22
    v_mfma_f32_16x16x32_bf16 v[232:235], v[184:187], v[228:231], v[232:235]
    v_add_f32 v25, v25, v23
    v_mfma_f32_16x16x32_bf16 v[236:239], v[188:191], v[228:231], v[236:239]
    v_fmac_f32 v26, v22, v22
    v_mfma_f32_16x16x32_bf16 v[240:243], v[192:195], v[228:231], v[240:243]
    v_fmac_f32 v27, v23, v23
    s_waitcnt vmcnt(8) lgkmcnt(0)
    s_barrier
    v_mfma_f32_16x16x32_bf16 v[32:35], v[144:147], v[128:131], v[32:35]
    v_mfma_f32_16x16x32_bf16 v[56:59], v[144:147], v[132:135], v[56:59]
    ds_read_b128 v[168:171], v212 offset:32768
    v_lshlrev_b32 v20, 16, v128
    v_mfma_f32_16x16x32_bf16 v[80:83], v[144:147], v[136:139], v[80:83]
    ds_read_b128 v[172:175], v213 offset:32768
    v_and_b32 v21, s69, v128
    v_mfma_f32_16x16x32_bf16 v[104:107], v[144:147], v[140:143], v[104:107]
    ds_read_b128 v[176:179], v214 offset:32768
    v_add_f32 v24, v24, v20
    v_mfma_f32_16x16x32_bf16 v[36:39], v[148:151], v[128:131], v[36:39]
    v_add_f32 v25, v25, v21
    v_mfma_f32_16x16x32_bf16 v[60:63], v[148:151], v[132:135], v[60:63]
    ds_read_b128 v[180:183], v215 offset:32768
    v_fmac_f32 v26, v20, v20
    v_mfma_f32_16x16x32_bf16 v[84:87], v[148:151], v[136:139], v[84:87]
    ds_read_b64_tr_b16 v[184:185], v216 offset:24576
    v_fmac_f32 v27, v21, v21
    v_mfma_f32_16x16x32_bf16 v[108:111], v[148:151], v[140:143], v[108:111]
    ds_read_b64_tr_b16 v[186:187], v216 offset:30720
    v_lshlrev_b32 v22, 16, v129
    v_mfma_f32_16x16x32_bf16 v[40:43], v[152:155], v[128:131], v[40:43]
    v_and_b32 v23, s69, v129
    v_mfma_f32_16x16x32_bf16 v[64:67], v[152:155], v[132:135], v[64:67]
    ds_read_b64_tr_b16 v[188:189], v217 offset:24576
    v_mfma_f32_16x16x32_bf16 v[88:91], v[152:155], v[136:139], v[88:91]
    ds_read_b64_tr_b16 v[190:191], v217 offset:30720
    v_add_f32 v24, v24, v22
    v_mfma_f32_16x16x32_bf16 v[112:115], v[152:155], v[140:143], v[112:115]
    ds_read_b64_tr_b16 v[192:193], v218 offset:24576
    v_add_f32 v25, v25, v23
    v_mfma_f32_16x16x32_bf16 v[44:47], v[156:159], v[128:131], v[44:47]
    v_fmac_f32 v26, v22, v22
    v_mfma_f32_16x16x32_bf16 v[68:71], v[156:159], v[132:135], v[68:71]
    ds_read_b64_tr_b16 v[194:195], v218 offset:30720
    v_fmac_f32 v27, v23, v23
    v_mfma_f32_16x16x32_bf16 v[92:95], v[156:159], v[136:139], v[92:95]
    ds_read_b64_tr_b16 v[196:197], v219 offset:24576
    v_lshlrev_b32 v20, 16, v130
    v_mfma_f32_16x16x32_bf16 v[116:119], v[156:159], v[140:143], v[116:119]
    ds_read_b64_tr_b16 v[198:199], v219 offset:30720
    v_and_b32 v21, s69, v130
    v_mfma_f32_16x16x32_bf16 v[48:51], v[160:163], v[128:131], v[48:51]
    v_add_f32 v24, v24, v20
    v_mfma_f32_16x16x32_bf16 v[72:75], v[160:163], v[132:135], v[72:75]
    ds_read_b64_tr_b16 v[200:201], v220 offset:24576
    v_add_f32 v25, v25, v21
    v_mfma_f32_16x16x32_bf16 v[96:99], v[160:163], v[136:139], v[96:99]
    ds_read_b64_tr_b16 v[202:203], v220 offset:30720
    v_mfma_f32_16x16x32_bf16 v[120:123], v[160:163], v[140:143], v[120:123]
    ds_read_b64_tr_b16 v[204:205], v221 offset:24576
    v_fmac_f32 v26, v20, v20
    v_mfma_f32_16x16x32_bf16 v[52:55], v[164:167], v[128:131], v[52:55]
    ds_read_b64_tr_b16 v[206:207], v221 offset:30720
    v_fmac_f32 v27, v21, v21
    v_mfma_f32_16x16x32_bf16 v[76:79], v[164:167], v[132:135], v[76:79]
    v_lshlrev_b32 v22, 16, v131
    v_mfma_f32_16x16x32_bf16 v[100:103], v[164:167], v[136:139], v[100:103]
    v_and_b32 v23, s69, v131
    v_mfma_f32_16x16x32_bf16 v[124:127], v[164:167], v[140:143], v[124:127]
    v_add_f32 v24, v24, v22
    v_mfma_f32_16x16x32_bf16 v[232:235], v[144:147], v[228:231], v[232:235]
    v_add_f32 v25, v25, v23
    v_mfma_f32_16x16x32_bf16 v[236:239], v[148:151], v[228:231], v[236:239]
    v_fmac_f32 v26, v22, v22
    v_mfma_f32_16x16x32_bf16 v[240:243], v[152:155], v[228:231], v[240:243]
    v_fmac_f32 v27, v23, v23
    s_waitcnt vmcnt(3) lgkmcnt(0)
    s_barrier
    v_mfma_f32_16x16x32_bf16 v[32:35], v[184:187], v[168:171], v[32:35]
    v_mfma_f32_16x16x32_bf16 v[56:59], v[184:187], v[172:175], v[56:59]
    ds_read_b128 v[128:131], v208 offset:0
    v_lshlrev_b32 v20, 16, v168
    v_mfma_f32_16x16x32_bf16 v[80:83], v[184:187], v[176:179], v[80:83]
    ds_read_b128 v[132:135], v209 offset:0
    v_and_b32 v21, s69, v168
    v_mfma_f32_16x16x32_bf16 v[104:107], v[184:187], v[180:183], v[104:107]
    ds_read_b128 v[136:139], v210 offset:0
    v_add_f32 v24, v24, v20
    v_mfma_f32_16x16x32_bf16 v[36:39], v[188:191], v[168:171], v[36:39]
    v_add_f32 v25, v25, v21
    v_mfma_f32_16x16x32_bf16 v[60:63], v[188:191], v[172:175], v[60:63]
    ds_read_b128 v[140:143], v211 offset:0
    v_fmac_f32 v26, v20, v20
    v_mfma_f32_16x16x32_bf16 v[84:87], v[188:191], v[176:179], v[84:87]
    ds_read_b64_tr_b16 v[144:145], v222 offset:0
    v_fmac_f32 v27, v21, v21
    v_mfma_f32_16x16x32_bf16 v[108:111], v[188:191], v[180:183], v[108:111]
    ds_read_b64_tr_b16 v[146:147], v222 offset:6144
    v_lshlrev_b32 v22, 16, v169
    v_mfma_f32_16x16x32_bf16 v[40:43], v[192:195], v[168:171], v[40:43]
    v_and_b32 v23, s69, v169
    v_mfma_f32_16x16x32_bf16 v[64:67], v[192:195], v[172:175], v[64:67]
    ds_read_b64_tr_b16 v[148:149], v223 offset:0
    v_mfma_f32_16x16x32_bf16 v[88:91], v[192:195], v[176:179], v[88:91]
    ds_read_b64_tr_b16 v[150:151], v223 offset:6144
    v_add_f32 v24, v24, v22
    v_mfma_f32_16x16x32_bf16 v[112:115], v[192:195], v[180:183], v[112:115]
    ds_read_b64_tr_b16 v[152:153], v224 offset:0
    v_add_f32 v25, v25, v23
    v_mfma_f32_16x16x32_bf16 v[44:47], v[196:199], v[168:171], v[44:47]
    v_fmac_f32 v26, v22, v22
    v_mfma_f32_16x16x32_bf16 v[68:71], v[196:199], v[172:175], v[68:71]
    ds_read_b64_tr_b16 v[154:155], v224 offset:6144
    v_fmac_f32 v27, v23, v23
    v_mfma_f32_16x16x32_bf16 v[92:95], v[196:199], v[176:179], v[92:95]
    ds_read_b64_tr_b16 v[156:157], v225 offset:0
    v_lshlrev_b32 v20, 16, v170
    v_mfma_f32_16x16x32_bf16 v[116:119], v[196:199], v[180:183], v[116:119]
    ds_read_b64_tr_b16 v[158:159], v225 offset:6144
    v_and_b32 v21, s69, v170
    v_mfma_f32_16x16x32_bf16 v[48:51], v[200:203], v[168:171], v[48:51]
    v_add_f32 v24, v24, v20
    v_mfma_f32_16x16x32_bf16 v[72:75], v[200:203], v[172:175], v[72:75]
    ds_read_b64_tr_b16 v[160:161], v226 offset:0
    v_add_f32 v25, v25, v21
    v_mfma_f32_16x16x32_bf16 v[96:99], v[200:203], v[176:179], v[96:99]
    ds_read_b64_tr_b16 v[162:163], v226 offset:6144
    v_mfma_f32_16x16x32_bf16 v[120:123], v[200:203], v[180:183], v[120:123]
    ds_read_b64_tr_b16 v[164:165], v227 offset:0
    v_fmac_f32 v26, v20, v20
    v_mfma_f32_16x16x32_bf16 v[52:55], v[204:207], v[168:171], v[52:55]
    ds_read_b64_tr_b16 v[166:167], v227 offset:6144
    v_fmac_f32 v27, v21, v21
    v_mfma_f32_16x16x32_bf16 v[76:79], v[204:207], v[172:175], v[76:79]
    v_lshlrev_b32 v22, 16, v171
    v_mfma_f32_16x16x32_bf16 v[100:103], v[204:207], v[176:179], v[100:103]
    v_and_b32 v23, s69, v171
    v_mfma_f32_16x16x32_bf16 v[124:127], v[204:207], v[180:183], v[124:127]
    v_add_f32 v24, v24, v22
    v_mfma_f32_16x16x32_bf16 v[232:235], v[184:187], v[228:231], v[232:235]
    v_add_f32 v25, v25, v23
    v_mfma_f32_16x16x32_bf16 v[236:239], v[188:191], v[228:231], v[236:239]
    v_fmac_f32 v26, v22, v22
    v_mfma_f32_16x16x32_bf16 v[240:243], v[192:195], v[228:231], v[240:243]
    v_fmac_f32 v27, v23, v23
    s_waitcnt vmcnt(0) lgkmcnt(0)
    s_barrier
    v_mfma_f32_16x16x32_bf16 v[32:35], v[144:147], v[128:131], v[32:35]
    v_mfma_f32_16x16x32_bf16 v[56:59], v[144:147], v[132:135], v[56:59]
    ds_read_b128 v[168:171], v212 offset:0
    v_lshlrev_b32 v20, 16, v128
    v_mfma_f32_16x16x32_bf16 v[80:83], v[144:147], v[136:139], v[80:83]
    ds_read_b128 v[172:175], v213 offset:0
    v_and_b32 v21, s69, v128
    v_mfma_f32_16x16x32_bf16 v[104:107], v[144:147], v[140:143], v[104:107]
    ds_read_b128 v[176:179], v214 offset:0
    v_add_f32 v24, v24, v20
    v_mfma_f32_16x16x32_bf16 v[36:39], v[148:151], v[128:131], v[36:39]
    v_add_f32 v25, v25, v21
    v_mfma_f32_16x16x32_bf16 v[60:63], v[148:151], v[132:135], v[60:63]
    ds_read_b128 v[180:183], v215 offset:0
    v_fmac_f32 v26, v20, v20
    v_mfma_f32_16x16x32_bf16 v[84:87], v[148:151], v[136:139], v[84:87]
    ds_read_b64_tr_b16 v[184:185], v222 offset:24576
    v_fmac_f32 v27, v21, v21
    v_mfma_f32_16x16x32_bf16 v[108:111], v[148:151], v[140:143], v[108:111]
    ds_read_b64_tr_b16 v[186:187], v222 offset:30720
    v_lshlrev_b32 v22, 16, v129
    v_mfma_f32_16x16x32_bf16 v[40:43], v[152:155], v[128:131], v[40:43]
    v_and_b32 v23, s69, v129
    v_mfma_f32_16x16x32_bf16 v[64:67], v[152:155], v[132:135], v[64:67]
    ds_read_b64_tr_b16 v[188:189], v223 offset:24576
    v_mfma_f32_16x16x32_bf16 v[88:91], v[152:155], v[136:139], v[88:91]
    ds_read_b64_tr_b16 v[190:191], v223 offset:30720
    v_add_f32 v24, v24, v22
    v_mfma_f32_16x16x32_bf16 v[112:115], v[152:155], v[140:143], v[112:115]
    ds_read_b64_tr_b16 v[192:193], v224 offset:24576
    v_add_f32 v25, v25, v23
    v_mfma_f32_16x16x32_bf16 v[44:47], v[156:159], v[128:131], v[44:47]
    v_fmac_f32 v26, v22, v22
    v_mfma_f32_16x16x32_bf16 v[68:71], v[156:159], v[132:135], v[68:71]
    ds_read_b64_tr_b16 v[194:195], v224 offset:30720
    v_fmac_f32 v27, v23, v23
    v_mfma_f32_16x16x32_bf16 v[92:95], v[156:159], v[136:139], v[92:95]
    ds_read_b64_tr_b16 v[196:197], v225 offset:24576
    v_lshlrev_b32 v20, 16, v130
    v_mfma_f32_16x16x32_bf16 v[116:119], v[156:159], v[140:143], v[116:119]
    ds_read_b64_tr_b16 v[198:199], v225 offset:30720
    v_and_b32 v21, s69, v130
    v_mfma_f32_16x16x32_bf16 v[48:51], v[160:163], v[128:131], v[48:51]
    v_add_f32 v24, v24, v20
    v_mfma_f32_16x16x32_bf16 v[72:75], v[160:163], v[132:135], v[72:75]
    ds_read_b64_tr_b16 v[200:201], v226 offset:24576
    v_add_f32 v25, v25, v21
    v_mfma_f32_16x16x32_bf16 v[96:99], v[160:163], v[136:139], v[96:99]
    ds_read_b64_tr_b16 v[202:203], v226 offset:30720
    v_mfma_f32_16x16x32_bf16 v[120:123], v[160:163], v[140:143], v[120:123]
    ds_read_b64_tr_b16 v[204:205], v227 offset:24576
    v_fmac_f32 v26, v20, v20
    v_mfma_f32_16x16x32_bf16 v[52:55], v[164:167], v[128:131], v[52:55]
    ds_read_b64_tr_b16 v[206:207], v227 offset:30720
    v_fmac_f32 v27, v21, v21
    v_mfma_f32_16x16x32_bf16 v[76:79], v[164:167], v[132:135], v[76:79]
    v_lshlrev_b32 v22, 16, v131
    v_mfma_f32_16x16x32_bf16 v[100:103], v[164:167], v[136:139], v[100:103]
    v_and_b32 v23, s69, v131
    v_mfma_f32_16x16x32_bf16 v[124:127], v[164:167], v[140:143], v[124:127]
    v_add_f32 v24, v24, v22
    v_mfma_f32_16x16x32_bf16 v[232:235], v[144:147], v[228:231], v[232:235]
    v_add_f32 v25, v25, v23
    v_mfma_f32_16x16x32_bf16 v[236:239], v[148:151], v[228:231], v[236:239]
    v_fmac_f32 v26, v22, v22
    v_mfma_f32_16x16x32_bf16 v[240:243], v[152:155], v[228:231], v[240:243]
    v_fmac_f32 v27, v23, v23
    s_waitcnt lgkmcnt(0)
    v_mfma_f32_16x16x32_bf16 v[32:35], v[184:187], v[168:171], v[32:35]
    v_mfma_f32_16x16x32_bf16 v[56:59], v[184:187], v[172:175], v[56:59]
    v_lshlrev_b32 v20, 16, v168
    v_mfma_f32_16x16x32_bf16 v[80:83], v[184:187], v[176:179], v[80:83]
    v_and_b32 v21, s69, v168
    v_mfma_f32_16x16x32_bf16 v[104:107], v[184:187], v[180:183], v[104:107]
    v_add_f32 v24, v24, v20
    v_mfma_f32_16x16x32_bf16 v[36:39], v[188:191], v[168:171], v[36:39]
    v_add_f32 v25, v25, v21
    v_mfma_f32_16x16x32_bf16 v[60:63], v[188:191], v[172:175], v[60:63]
    v_fmac_f32 v26, v20, v20
    v_mfma_f32_16x16x32_bf16 v[84:87], v[188:191], v[176:179], v[84:87]
    v_fmac_f32 v27, v21, v21
    v_mfma_f32_16x16x32_bf16 v[108:111], v[188:191], v[180:183], v[108:111]
    v_lshlrev_b32 v22, 16, v169
    v_mfma_f32_16x16x32_bf16 v[40:43], v[192:195], v[168:171], v[40:43]
    v_and_b32 v23, s69, v169
    v_mfma_f32_16x16x32_bf16 v[64:67], v[192:195], v[172:175], v[64:67]
    v_mfma_f32_16x16x32_bf16 v[88:91], v[192:195], v[176:179], v[88:91]
    v_add_f32 v24, v24, v22
    v_mfma_f32_16x16x32_bf16 v[112:115], v[192:195], v[180:183], v[112:115]
    v_add_f32 v25, v25, v23
    v_mfma_f32_16x16x32_bf16 v[44:47], v[196:199], v[168:171], v[44:47]
    v_fmac_f32 v26, v22, v22
    v_mfma_f32_16x16x32_bf16 v[68:71], v[196:199], v[172:175], v[68:71]
    v_fmac_f32 v27, v23, v23
    v_mfma_f32_16x16x32_bf16 v[92:95], v[196:199], v[176:179], v[92:95]
    v_lshlrev_b32 v20, 16, v170
    v_mfma_f32_16x16x32_bf16 v[116:119], v[196:199], v[180:183], v[116:119]
    v_and_b32 v21, s69, v170
    v_mfma_f32_16x16x32_bf16 v[48:51], v[200:203], v[168:171], v[48:51]
    v_add_f32 v24, v24, v20
    v_mfma_f32_16x16x32_bf16 v[72:75], v[200:203], v[172:175], v[72:75]
    v_add_f32 v25, v25, v21
    v_mfma_f32_16x16x32_bf16 v[96:99], v[200:203], v[176:179], v[96:99]
    v_mfma_f32_16x16x32_bf16 v[120:123], v[200:203], v[180:183], v[120:123]
    v_fmac_f32 v26, v20, v20
    v_mfma_f32_16x16x32_bf16 v[52:55], v[204:207], v[168:171], v[52:55]
    v_fmac_f32 v27, v21, v21
    v_mfma_f32_16x16x32_bf16 v[76:79], v[204:207], v[172:175], v[76:79]
    v_lshlrev_b32 v22, 16, v171
    v_mfma_f32_16x16x32_bf16 v[100:103], v[204:207], v[176:179], v[100:103]
    v_and_b32 v23, s69, v171
    v_mfma_f32_16x16x32_bf16 v[124:127], v[204:207], v[180:183], v[124:127]
    v_add_f32 v24, v24, v22
    v_mfma_f32_16x16x32_bf16 v[232:235], v[184:187], v[228:231], v[232:235]
    v_add_f32 v25, v25, v23
    v_mfma_f32_16x16x32_bf16 v[236:239], v[188:191], v[228:231], v[236:239]
    v_fmac_f32 v26, v22, v22
    v_mfma_f32_16x16x32_bf16 v[240:243], v[192:195], v[228:231], v[240:243]
    v_fmac_f32 v27, v23, v23
    s_mov_b32 s16, 0xffff0000
    s_mov_b32 s17, 0x3acccccd
    v_add_f32 v16, v24, v25
    v_add_f32 v17, v26, v27
    v_mov_b32 v20, v16
    s_nop 1
    v_permlane32_swap_b32 v16, v20
    s_nop 1
    v_add_f32 v16, v16, v20
    v_mov_b32 v20, v16
    s_nop 1
    v_permlane16_swap_b32 v16, v20
    s_nop 1
    v_add_f32 v16, v16, v20
    v_mov_b32 v20, v17
    s_nop 1
    v_permlane32_swap_b32 v17, v20
    s_nop 1
    v_add_f32 v17, v17, v20
    v_mov_b32 v20, v17
    s_nop 1
    v_permlane16_swap_b32 v17, v20
    s_nop 1
    v_add_f32 v17, v17, v20
    v_mul_f32 v16, s17, v16
    v_mul_f32 v17, s17, v17
    v_fma_f32 v17, -v16, v16, v17
    v_max_f32 v17, 0, v17
    v_cvt_pk_bf16_f32 v20, v16, v17
    v_lshlrev_b32 v16, 16, v20
    v_and_b32 v17, s16, v20
    v_add_f32 v17, 0x3727c5ac, v17
    v_cvt_pk_bf16_f32 v20, v17, v17
    v_and_b32 v17, s16, v20
    v_sqrt_f32 v17, v17
    s_nop 0
    v_cvt_pk_bf16_f32 v20, v17, v17
    v_and_b32 v19, s16, v20
    v_rcp_f32 v20, v19
    s_nop 0
    v_fma_f32 v17, -v19, v20, 1.0
    v_fma_f32 v17, v17, v20, v20
    v_mul_f32 v18, 0xbfb8aa3b, v17
    s_lshl_b32 s44, s36, 2
    s_add_u32 s44, s44, s37
    s_lshl_b32 s44, s44, 8
    s_add_u32 s44, s44, 159744
    v_lshl_add_u32 v20, v6, 4, s44
    ds_write_b128 v20, v[16:19]
    s_mul_i32 s44, s36, 12
    s_mul_i32 s46, s37, 3
    s_add_u32 s44, s44, s46
    s_lshl_b32 s44, s44, 6
    s_add_u32 s44, s44, 162304
    v_lshl_add_u32 v20, v2, 4, s44
    ds_write_b128 v20, v[232:235]
    ds_write_b128 v20, v[236:239] offset:64
    ds_write_b128 v20, v[240:243] offset:128
    s_waitcnt lgkmcnt(0)
    s_barrier
    s_add_u32 s44, s37, 0
    s_and_b32 s44, s44, 3
    s_lshl_b32 s46, s36, 2
    s_add_u32 s44, s44, s46
    s_lshl_b32 s44, s44, 8
    s_add_u32 s44, s44, 159744
    v_lshl_add_u32 v20, v6, 4, s44
    ds_read_b128 v[128:131], v20
    s_add_u32 s44, s37, 1
    s_and_b32 s44, s44, 3
    s_lshl_b32 s46, s36, 2
    s_add_u32 s44, s44, s46
    s_lshl_b32 s44, s44, 8
    s_add_u32 s44, s44, 159744
    v_lshl_add_u32 v20, v6, 4, s44
    ds_read_b128 v[132:135], v20
    s_add_u32 s44, s37, 2
    s_and_b32 s44, s44, 3
    s_lshl_b32 s46, s36, 2
    s_add_u32 s44, s44, s46
    s_lshl_b32 s44, s44, 8
    s_add_u32 s44, s44, 159744
    v_lshl_add_u32 v20, v6, 4, s44
    ds_read_b128 v[136:139], v20
    s_add_u32 s44, s37, 3
    s_and_b32 s44, s44, 3
    s_lshl_b32 s46, s36, 2
    s_add_u32 s44, s44, s46
    s_lshl_b32 s44, s44, 8
    s_add_u32 s44, s44, 159744
    v_lshl_add_u32 v20, v6, 4, s44
    ds_read_b128 v[140:143], v20
    s_mul_i32 s44, s37, 192
    s_add_u32 s44, s44, 162304
    v_lshl_add_u32 v20, v2, 4, s44
    ds_read_b128 v[144:147], v20 offset:0
    ds_read_b128 v[156:159], v20 offset:768
    ds_read_b128 v[148:151], v20 offset:64
    ds_read_b128 v[160:163], v20 offset:832
    ds_read_b128 v[152:155], v20 offset:128
    ds_read_b128 v[164:167], v20 offset:896
    v_lshrrev_b32 v21, 1, v2
    v_lshl_add_u32 v20, v21, 4, v6
    v_lshlrev_b32 v20, 4, v20
    v_and_b32 v21, 1, v2
    v_lshl_add_u32 v20, v21, 3, v20
    s_lshl_b32 s44, s33, 3
    s_lshl_b32 s45, s36, 2
    s_add_u32 s44, s44, s45
    s_mul_i32 s44, s44, 69632
    s_add_u32 s44, s44, 20480
    v_add_u32 v20, s44, v20
    s_mul_i32 s45, s34, 12
    s_mul_i32 s46, s37, 3
    s_add_u32 s45, s45, s46
    s_lshl_b32 s45, s45, 9
    s_add_u32 s46, s45, 512
    s_add_u32 s47, s45, 1024
    s_add_u32 s44, s37, 0
    s_and_b32 s44, s44, 3
    s_mul_i32 s44, s44, 69632
    v_add_u32 v24, s44, v20
    s_add_u32 s44, s37, 1
    s_and_b32 s44, s44, 3
    s_mul_i32 s44, s44, 69632
    v_add_u32 v25, s44, v20
    s_add_u32 s44, s37, 2
    s_and_b32 s44, s44, 3
    s_mul_i32 s44, s44, 69632
    v_add_u32 v26, s44, v20
    s_add_u32 s44, s37, 3
    s_and_b32 s44, s44, 3
    s_mul_i32 s44, s44, 69632
    v_add_u32 v27, s44, v20
    s_waitcnt lgkmcnt(0)
    s_cmp_eq_u32 s36, 0
    s_cbranch_scc0 L_g1_g_sw
    v_pk_fma_f32 v[32:33], v[144:145], v[128:129], v[32:33] op_sel_hi:[1,0,1] neg_lo:[0,1,0] neg_hi:[0,1,0]
    v_pk_fma_f32 v[34:35], v[146:147], v[128:129], v[34:35] op_sel_hi:[1,0,1] neg_lo:[0,1,0] neg_hi:[0,1,0]
    v_pk_mul_f32 v[32:33], v[32:33], v[130:131] op_sel_hi:[1,0]
    v_pk_mul_f32 v[34:35], v[34:35], v[130:131] op_sel_hi:[1,0]
    v_exp_f32 v32, v32
    v_exp_f32 v33, v33
    v_exp_f32 v34, v34
    v_exp_f32 v35, v35
    v_pk_fma_f32 v[44:45], v[156:157], v[128:129], v[44:45] op_sel_hi:[1,0,1] neg_lo:[0,1,0] neg_hi:[0,1,0]
    v_pk_fma_f32 v[46:47], v[158:159], v[128:129], v[46:47] op_sel_hi:[1,0,1] neg_lo:[0,1,0] neg_hi:[0,1,0]
    v_pk_fma_f32 v[32:33], v[32:33], v[130:131], v[130:131] op_sel:[0,1,1] op_sel_hi:[1,1,1]
    v_pk_fma_f32 v[34:35], v[34:35], v[130:131], v[130:131] op_sel:[0,1,1] op_sel_hi:[1,1,1]
    v_rcp_f32 v32, v32
    v_rcp_f32 v33, v33
    v_rcp_f32 v34, v34
    v_rcp_f32 v35, v35
    s_nop 0
    v_pk_mul_f32 v[32:33], v[32:33], v[44:45]
    v_pk_mul_f32 v[34:35], v[34:35], v[46:47]
    v_cvt_pk_bf16_f32 v44, v32, v33
    v_cvt_pk_bf16_f32 v45, v34, v35
    buffer_store_dwordx2 v[44:45], v24, s[12:15], s45 offen
    v_pk_fma_f32 v[36:37], v[148:149], v[128:129], v[36:37] op_sel_hi:[1,0,1] neg_lo:[0,1,0] neg_hi:[0,1,0]
    v_pk_fma_f32 v[38:39], v[150:151], v[128:129], v[38:39] op_sel_hi:[1,0,1] neg_lo:[0,1,0] neg_hi:[0,1,0]
    v_pk_mul_f32 v[36:37], v[36:37], v[130:131] op_sel_hi:[1,0]
    v_pk_mul_f32 v[38:39], v[38:39], v[130:131] op_sel_hi:[1,0]
    v_exp_f32 v36, v36
    v_exp_f32 v37, v37
    v_exp_f32 v38, v38
    v_exp_f32 v39, v39
    v_pk_fma_f32 v[48:49], v[160:161], v[128:129], v[48:49] op_sel_hi:[1,0,1] neg_lo:[0,1,0] neg_hi:[0,1,0]
    v_pk_fma_f32 v[50:51], v[162:163], v[128:129], v[50:51] op_sel_hi:[1,0,1] neg_lo:[0,1,0] neg_hi:[0,1,0]
    v_pk_fma_f32 v[36:37], v[36:37], v[130:131], v[130:131] op_sel:[0,1,1] op_sel_hi:[1,1,1]
    v_pk_fma_f32 v[38:39], v[38:39], v[130:131], v[130:131] op_sel:[0,1,1] op_sel_hi:[1,1,1]
    v_rcp_f32 v36, v36
    v_rcp_f32 v37, v37
    v_rcp_f32 v38, v38
    v_rcp_f32 v39, v39
    s_nop 0
    v_pk_mul_f32 v[36:37], v[36:37], v[48:49]
    v_pk_mul_f32 v[38:39], v[38:39], v[50:51]
    v_cvt_pk_bf16_f32 v48, v36, v37
    v_cvt_pk_bf16_f32 v49, v38, v39
    buffer_store_dwordx2 v[48:49], v24, s[12:15], s46 offen
    v_pk_fma_f32 v[40:41], v[152:153], v[128:129], v[40:41] op_sel_hi:[1,0,1] neg_lo:[0,1,0] neg_hi:[0,1,0]
    v_pk_fma_f32 v[42:43], v[154:155], v[128:129], v[42:43] op_sel_hi:[1,0,1] neg_lo:[0,1,0] neg_hi:[0,1,0]
    v_pk_mul_f32 v[40:41], v[40:41], v[130:131] op_sel_hi:[1,0]
    v_pk_mul_f32 v[42:43], v[42:43], v[130:131] op_sel_hi:[1,0]
    v_exp_f32 v40, v40
    v_exp_f32 v41, v41
    v_exp_f32 v42, v42
    v_exp_f32 v43, v43
    v_pk_fma_f32 v[52:53], v[164:165], v[128:129], v[52:53] op_sel_hi:[1,0,1] neg_lo:[0,1,0] neg_hi:[0,1,0]
    v_pk_fma_f32 v[54:55], v[166:167], v[128:129], v[54:55] op_sel_hi:[1,0,1] neg_lo:[0,1,0] neg_hi:[0,1,0]
    v_pk_fma_f32 v[40:41], v[40:41], v[130:131], v[130:131] op_sel:[0,1,1] op_sel_hi:[1,1,1]
    v_pk_fma_f32 v[42:43], v[42:43], v[130:131], v[130:131] op_sel:[0,1,1] op_sel_hi:[1,1,1]
    v_rcp_f32 v40, v40
    v_rcp_f32 v41, v41
    v_rcp_f32 v42, v42
    v_rcp_f32 v43, v43
    s_nop 0
    v_pk_mul_f32 v[40:41], v[40:41], v[52:53]
    v_pk_mul_f32 v[42:43], v[42:43], v[54:55]
    v_cvt_pk_bf16_f32 v52, v40, v41
    v_cvt_pk_bf16_f32 v53, v42, v43
    buffer_store_dwordx2 v[52:53], v24, s[12:15], s47 offen
    v_pk_fma_f32 v[56:57], v[144:145], v[132:133], v[56:57] op_sel_hi:[1,0,1] neg_lo:[0,1,0] neg_hi:[0,1,0]
    v_pk_fma_f32 v[58:59], v[146:147], v[132:133], v[58:59] op_sel_hi:[1,0,1] neg_lo:[0,1,0] neg_hi:[0,1,0]
    v_pk_mul_f32 v[56:57], v[56:57], v[134:135] op_sel_hi:[1,0]
    v_pk_mul_f32 v[58:59], v[58:59], v[134:135] op_sel_hi:[1,0]
    v_exp_f32 v56, v56
    v_exp_f32 v57, v57
    v_exp_f32 v58, v58
    v_exp_f32 v59, v59
    v_pk_fma_f32 v[68:69], v[156:157], v[132:133], v[68:69] op_sel_hi:[1,0,1] neg_lo:[0,1,0] neg_hi:[0,1,0]
    v_pk_fma_f32 v[70:71], v[158:159], v[132:133], v[70:71] op_sel_hi:[1,0,1] neg_lo:[0,1,0] neg_hi:[0,1,0]
    v_pk_fma_f32 v[56:57], v[56:57], v[134:135], v[134:135] op_sel:[0,1,1] op_sel_hi:[1,1,1]
    v_pk_fma_f32 v[58:59], v[58:59], v[134:135], v[134:135] op_sel:[0,1,1] op_sel_hi:[1,1,1]
    v_rcp_f32 v56, v56
    v_rcp_f32 v57, v57
    v_rcp_f32 v58, v58
    v_rcp_f32 v59, v59
    s_nop 0
    v_pk_mul_f32 v[56:57], v[56:57], v[68:69]
    v_pk_mul_f32 v[58:59], v[58:59], v[70:71]
    v_cvt_pk_bf16_f32 v68, v56, v57
    v_cvt_pk_bf16_f32 v69, v58, v59
    buffer_store_dwordx2 v[68:69], v25, s[12:15], s45 offen
    v_pk_fma_f32 v[60:61], v[148:149], v[132:133], v[60:61] op_sel_hi:[1,0,1] neg_lo:[0,1,0] neg_hi:[0,1,0]
    v_pk_fma_f32 v[62:63], v[150:151], v[132:133], v[62:63] op_sel_hi:[1,0,1] neg_lo:[0,1,0] neg_hi:[0,1,0]
    v_pk_mul_f32 v[60:61], v[60:61], v[134:135] op_sel_hi:[1,0]
    v_pk_mul_f32 v[62:63], v[62:63], v[134:135] op_sel_hi:[1,0]
    v_exp_f32 v60, v60
    v_exp_f32 v61, v61
    v_exp_f32 v62, v62
    v_exp_f32 v63, v63
    v_pk_fma_f32 v[72:73], v[160:161], v[132:133], v[72:73] op_sel_hi:[1,0,1] neg_lo:[0,1,0] neg_hi:[0,1,0]
    v_pk_fma_f32 v[74:75], v[162:163], v[132:133], v[74:75] op_sel_hi:[1,0,1] neg_lo:[0,1,0] neg_hi:[0,1,0]
    v_pk_fma_f32 v[60:61], v[60:61], v[134:135], v[134:135] op_sel:[0,1,1] op_sel_hi:[1,1,1]
    v_pk_fma_f32 v[62:63], v[62:63], v[134:135], v[134:135] op_sel:[0,1,1] op_sel_hi:[1,1,1]
    v_rcp_f32 v60, v60
    v_rcp_f32 v61, v61
    v_rcp_f32 v62, v62
    v_rcp_f32 v63, v63
    s_nop 0
    v_pk_mul_f32 v[60:61], v[60:61], v[72:73]
    v_pk_mul_f32 v[62:63], v[62:63], v[74:75]
    v_cvt_pk_bf16_f32 v72, v60, v61
    v_cvt_pk_bf16_f32 v73, v62, v63
    buffer_store_dwordx2 v[72:73], v25, s[12:15], s46 offen
    v_pk_fma_f32 v[64:65], v[152:153], v[132:133], v[64:65] op_sel_hi:[1,0,1] neg_lo:[0,1,0] neg_hi:[0,1,0]
    v_pk_fma_f32 v[66:67], v[154:155], v[132:133], v[66:67] op_sel_hi:[1,0,1] neg_lo:[0,1,0] neg_hi:[0,1,0]
    v_pk_mul_f32 v[64:65], v[64:65], v[134:135] op_sel_hi:[1,0]
    v_pk_mul_f32 v[66:67], v[66:67], v[134:135] op_sel_hi:[1,0]
    v_exp_f32 v64, v64
    v_exp_f32 v65, v65
    v_exp_f32 v66, v66
    v_exp_f32 v67, v67
    v_pk_fma_f32 v[76:77], v[164:165], v[132:133], v[76:77] op_sel_hi:[1,0,1] neg_lo:[0,1,0] neg_hi:[0,1,0]
    v_pk_fma_f32 v[78:79], v[166:167], v[132:133], v[78:79] op_sel_hi:[1,0,1] neg_lo:[0,1,0] neg_hi:[0,1,0]
    v_pk_fma_f32 v[64:65], v[64:65], v[134:135], v[134:135] op_sel:[0,1,1] op_sel_hi:[1,1,1]
    v_pk_fma_f32 v[66:67], v[66:67], v[134:135], v[134:135] op_sel:[0,1,1] op_sel_hi:[1,1,1]
    v_rcp_f32 v64, v64
    v_rcp_f32 v65, v65
    v_rcp_f32 v66, v66
    v_rcp_f32 v67, v67
    s_nop 0
    v_pk_mul_f32 v[64:65], v[64:65], v[76:77]
    v_pk_mul_f32 v[66:67], v[66:67], v[78:79]
    v_cvt_pk_bf16_f32 v76, v64, v65
    v_cvt_pk_bf16_f32 v77, v66, v67
    buffer_store_dwordx2 v[76:77], v25, s[12:15], s47 offen
    v_pk_fma_f32 v[80:81], v[144:145], v[136:137], v[80:81] op_sel_hi:[1,0,1] neg_lo:[0,1,0] neg_hi:[0,1,0]
    v_pk_fma_f32 v[82:83], v[146:147], v[136:137], v[82:83] op_sel_hi:[1,0,1] neg_lo:[0,1,0] neg_hi:[0,1,0]
    v_pk_mul_f32 v[80:81], v[80:81], v[138:139] op_sel_hi:[1,0]
    v_pk_mul_f32 v[82:83], v[82:83], v[138:139] op_sel_hi:[1,0]
    v_exp_f32 v80, v80
    v_exp_f32 v81, v81
    v_exp_f32 v82, v82
    v_exp_f32 v83, v83
    v_pk_fma_f32 v[92:93], v[156:157], v[136:137], v[92:93] op_sel_hi:[1,0,1] neg_lo:[0,1,0] neg_hi:[0,1,0]
    v_pk_fma_f32 v[94:95], v[158:159], v[136:137], v[94:95] op_sel_hi:[1,0,1] neg_lo:[0,1,0] neg_hi:[0,1,0]
    v_pk_fma_f32 v[80:81], v[80:81], v[138:139], v[138:139] op_sel:[0,1,1] op_sel_hi:[1,1,1]
    v_pk_fma_f32 v[82:83], v[82:83], v[138:139], v[138:139] op_sel:[0,1,1] op_sel_hi:[1,1,1]
    v_rcp_f32 v80, v80
    v_rcp_f32 v81, v81
    v_rcp_f32 v82, v82
    v_rcp_f32 v83, v83
    s_nop 0
    v_pk_mul_f32 v[80:81], v[80:81], v[92:93]
    v_pk_mul_f32 v[82:83], v[82:83], v[94:95]
    v_cvt_pk_bf16_f32 v92, v80, v81
    v_cvt_pk_bf16_f32 v93, v82, v83
    buffer_store_dwordx2 v[92:93], v26, s[12:15], s45 offen
    v_pk_fma_f32 v[84:85], v[148:149], v[136:137], v[84:85] op_sel_hi:[1,0,1] neg_lo:[0,1,0] neg_hi:[0,1,0]
    v_pk_fma_f32 v[86:87], v[150:151], v[136:137], v[86:87] op_sel_hi:[1,0,1] neg_lo:[0,1,0] neg_hi:[0,1,0]
    v_pk_mul_f32 v[84:85], v[84:85], v[138:139] op_sel_hi:[1,0]
    v_pk_mul_f32 v[86:87], v[86:87], v[138:139] op_sel_hi:[1,0]
    v_exp_f32 v84, v84
    v_exp_f32 v85, v85
    v_exp_f32 v86, v86
    v_exp_f32 v87, v87
    v_pk_fma_f32 v[96:97], v[160:161], v[136:137], v[96:97] op_sel_hi:[1,0,1] neg_lo:[0,1,0] neg_hi:[0,1,0]
    v_pk_fma_f32 v[98:99], v[162:163], v[136:137], v[98:99] op_sel_hi:[1,0,1] neg_lo:[0,1,0] neg_hi:[0,1,0]
    v_pk_fma_f32 v[84:85], v[84:85], v[138:139], v[138:139] op_sel:[0,1,1] op_sel_hi:[1,1,1]
    v_pk_fma_f32 v[86:87], v[86:87], v[138:139], v[138:139] op_sel:[0,1,1] op_sel_hi:[1,1,1]
    v_rcp_f32 v84, v84
    v_rcp_f32 v85, v85
    v_rcp_f32 v86, v86
    v_rcp_f32 v87, v87
    s_nop 0
    v_pk_mul_f32 v[84:85], v[84:85], v[96:97]
    v_pk_mul_f32 v[86:87], v[86:87], v[98:99]
    v_cvt_pk_bf16_f32 v96, v84, v85
    v_cvt_pk_bf16_f32 v97, v86, v87
    buffer_store_dwordx2 v[96:97], v26, s[12:15], s46 offen
    v_pk_fma_f32 v[88:89], v[152:153], v[136:137], v[88:89] op_sel_hi:[1,0,1] neg_lo:[0,1,0] neg_hi:[0,1,0]
    v_pk_fma_f32 v[90:91], v[154:155], v[136:137], v[90:91] op_sel_hi:[1,0,1] neg_lo:[0,1,0] neg_hi:[0,1,0]
    v_pk_mul_f32 v[88:89], v[88:89], v[138:139] op_sel_hi:[1,0]
    v_pk_mul_f32 v[90:91], v[90:91], v[138:139] op_sel_hi:[1,0]
    v_exp_f32 v88, v88
    v_exp_f32 v89, v89
    v_exp_f32 v90, v90
    v_exp_f32 v91, v91
    v_pk_fma_f32 v[100:101], v[164:165], v[136:137], v[100:101] op_sel_hi:[1,0,1] neg_lo:[0,1,0] neg_hi:[0,1,0]
    v_pk_fma_f32 v[102:103], v[166:167], v[136:137], v[102:103] op_sel_hi:[1,0,1] neg_lo:[0,1,0] neg_hi:[0,1,0]
    v_pk_fma_f32 v[88:89], v[88:89], v[138:139], v[138:139] op_sel:[0,1,1] op_sel_hi:[1,1,1]
    v_pk_fma_f32 v[90:91], v[90:91], v[138:139], v[138:139] op_sel:[0,1,1] op_sel_hi:[1,1,1]
    v_rcp_f32 v88, v88
    v_rcp_f32 v89, v89
    v_rcp_f32 v90, v90
    v_rcp_f32 v91, v91
    s_nop 0
    v_pk_mul_f32 v[88:89], v[88:89], v[100:101]
    v_pk_mul_f32 v[90:91], v[90:91], v[102:103]
    v_cvt_pk_bf16_f32 v100, v88, v89
    v_cvt_pk_bf16_f32 v101, v90, v91
    buffer_store_dwordx2 v[100:101], v26, s[12:15], s47 offen
    v_pk_fma_f32 v[104:105], v[144:145], v[140:141], v[104:105] op_sel_hi:[1,0,1] neg_lo:[0,1,0] neg_hi:[0,1,0]
    v_pk_fma_f32 v[106:107], v[146:147], v[140:141], v[106:107] op_sel_hi:[1,0,1] neg_lo:[0,1,0] neg_hi:[0,1,0]
    v_pk_mul_f32 v[104:105], v[104:105], v[142:143] op_sel_hi:[1,0]
    v_pk_mul_f32 v[106:107], v[106:107], v[142:143] op_sel_hi:[1,0]
    v_exp_f32 v104, v104
    v_exp_f32 v105, v105
    v_exp_f32 v106, v106
    v_exp_f32 v107, v107
    v_pk_fma_f32 v[116:117], v[156:157], v[140:141], v[116:117] op_sel_hi:[1,0,1] neg_lo:[0,1,0] neg_hi:[0,1,0]
    v_pk_fma_f32 v[118:119], v[158:159], v[140:141], v[118:119] op_sel_hi:[1,0,1] neg_lo:[0,1,0] neg_hi:[0,1,0]
    v_pk_fma_f32 v[104:105], v[104:105], v[142:143], v[142:143] op_sel:[0,1,1] op_sel_hi:[1,1,1]
    v_pk_fma_f32 v[106:107], v[106:107], v[142:143], v[142:143] op_sel:[0,1,1] op_sel_hi:[1,1,1]
    v_rcp_f32 v104, v104
    v_rcp_f32 v105, v105
    v_rcp_f32 v106, v106
    v_rcp_f32 v107, v107
    s_nop 0
    v_pk_mul_f32 v[104:105], v[104:105], v[116:117]
    v_pk_mul_f32 v[106:107], v[106:107], v[118:119]
    v_cvt_pk_bf16_f32 v116, v104, v105
    v_cvt_pk_bf16_f32 v117, v106, v107
    buffer_store_dwordx2 v[116:117], v27, s[12:15], s45 offen
    v_pk_fma_f32 v[108:109], v[148:149], v[140:141], v[108:109] op_sel_hi:[1,0,1] neg_lo:[0,1,0] neg_hi:[0,1,0]
    v_pk_fma_f32 v[110:111], v[150:151], v[140:141], v[110:111] op_sel_hi:[1,0,1] neg_lo:[0,1,0] neg_hi:[0,1,0]
    v_pk_mul_f32 v[108:109], v[108:109], v[142:143] op_sel_hi:[1,0]
    v_pk_mul_f32 v[110:111], v[110:111], v[142:143] op_sel_hi:[1,0]
    v_exp_f32 v108, v108
    v_exp_f32 v109, v109
    v_exp_f32 v110, v110
    v_exp_f32 v111, v111
    v_pk_fma_f32 v[120:121], v[160:161], v[140:141], v[120:121] op_sel_hi:[1,0,1] neg_lo:[0,1,0] neg_hi:[0,1,0]
    v_pk_fma_f32 v[122:123], v[162:163], v[140:141], v[122:123] op_sel_hi:[1,0,1] neg_lo:[0,1,0] neg_hi:[0,1,0]
    v_pk_fma_f32 v[108:109], v[108:109], v[142:143], v[142:143] op_sel:[0,1,1] op_sel_hi:[1,1,1]
    v_pk_fma_f32 v[110:111], v[110:111], v[142:143], v[142:143] op_sel:[0,1,1] op_sel_hi:[1,1,1]
    v_rcp_f32 v108, v108
    v_rcp_f32 v109, v109
    v_rcp_f32 v110, v110
    v_rcp_f32 v111, v111
    s_nop 0
    v_pk_mul_f32 v[108:109], v[108:109], v[120:121]
    v_pk_mul_f32 v[110:111], v[110:111], v[122:123]
    v_cvt_pk_bf16_f32 v120, v108, v109
    v_cvt_pk_bf16_f32 v121, v110, v111
    buffer_store_dwordx2 v[120:121], v27, s[12:15], s46 offen
    v_pk_fma_f32 v[112:113], v[152:153], v[140:141], v[112:113] op_sel_hi:[1,0,1] neg_lo:[0,1,0] neg_hi:[0,1,0]
    v_pk_fma_f32 v[114:115], v[154:155], v[140:141], v[114:115] op_sel_hi:[1,0,1] neg_lo:[0,1,0] neg_hi:[0,1,0]
    v_pk_mul_f32 v[112:113], v[112:113], v[142:143] op_sel_hi:[1,0]
    v_pk_mul_f32 v[114:115], v[114:115], v[142:143] op_sel_hi:[1,0]
    v_exp_f32 v112, v112
    v_exp_f32 v113, v113
    v_exp_f32 v114, v114
    v_exp_f32 v115, v115
    v_pk_fma_f32 v[124:125], v[164:165], v[140:141], v[124:125] op_sel_hi:[1,0,1] neg_lo:[0,1,0] neg_hi:[0,1,0]
    v_pk_fma_f32 v[126:127], v[166:167], v[140:141], v[126:127] op_sel_hi:[1,0,1] neg_lo:[0,1,0] neg_hi:[0,1,0]
    v_pk_fma_f32 v[112:113], v[112:113], v[142:143], v[142:143] op_sel:[0,1,1] op_sel_hi:[1,1,1]
    v_pk_fma_f32 v[114:115], v[114:115], v[142:143], v[142:143] op_sel:[0,1,1] op_sel_hi:[1,1,1]
    v_rcp_f32 v112, v112
    v_rcp_f32 v113, v113
    v_rcp_f32 v114, v114
    v_rcp_f32 v115, v115
    s_nop 0
    v_pk_mul_f32 v[112:113], v[112:113], v[124:125]
    v_pk_mul_f32 v[114:115], v[114:115], v[126:127]
    v_cvt_pk_bf16_f32 v124, v112, v113
    v_cvt_pk_bf16_f32 v125, v114, v115
    buffer_store_dwordx2 v[124:125], v27, s[12:15], s47 offen
    s_branch L_g1_g_end
L_g1_g_sw:
    v_pk_fma_f32 v[44:45], v[144:145], v[128:129], v[44:45] op_sel_hi:[1,0,1] neg_lo:[0,1,0] neg_hi:[0,1,0]
    v_pk_fma_f32 v[46:47], v[146:147], v[128:129], v[46:47] op_sel_hi:[1,0,1] neg_lo:[0,1,0] neg_hi:[0,1,0]
    v_pk_mul_f32 v[44:45], v[44:45], v[130:131] op_sel_hi:[1,0]
    v_pk_mul_f32 v[46:47], v[46:47], v[130:131] op_sel_hi:[1,0]
    v_exp_f32 v44, v44
    v_exp_f32 v45, v45
    v_exp_f32 v46, v46
    v_exp_f32 v47, v47
    v_pk_fma_f32 v[32:33], v[156:157], v[128:129], v[32:33] op_sel_hi:[1,0,1] neg_lo:[0,1,0] neg_hi:[0,1,0]
    v_pk_fma_f32 v[34:35], v[158:159], v[128:129], v[34:35] op_sel_hi:[1,0,1] neg_lo:[0,1,0] neg_hi:[0,1,0]
    v_pk_fma_f32 v[44:45], v[44:45], v[130:131], v[130:131] op_sel:[0,1,1] op_sel_hi:[1,1,1]
    v_pk_fma_f32 v[46:47], v[46:47], v[130:131], v[130:131] op_sel:[0,1,1] op_sel_hi:[1,1,1]
    v_rcp_f32 v44, v44
    v_rcp_f32 v45, v45
    v_rcp_f32 v46, v46
    v_rcp_f32 v47, v47
    s_nop 0
    v_pk_mul_f32 v[44:45], v[44:45], v[32:33]
    v_pk_mul_f32 v[46:47], v[46:47], v[34:35]
    v_cvt_pk_bf16_f32 v32, v44, v45
    v_cvt_pk_bf16_f32 v33, v46, v47
    buffer_store_dwordx2 v[32:33], v24, s[12:15], s45 offen
    v_pk_fma_f32 v[48:49], v[148:149], v[128:129], v[48:49] op_sel_hi:[1,0,1] neg_lo:[0,1,0] neg_hi:[0,1,0]
    v_pk_fma_f32 v[50:51], v[150:151], v[128:129], v[50:51] op_sel_hi:[1,0,1] neg_lo:[0,1,0] neg_hi:[0,1,0]
    v_pk_mul_f32 v[48:49], v[48:49], v[130:131] op_sel_hi:[1,0]
    v_pk_mul_f32 v[50:51], v[50:51], v[130:131] op_sel_hi:[1,0]
    v_exp_f32 v48, v48
    v_exp_f32 v49, v49
    v_exp_f32 v50, v50
    v_exp_f32 v51, v51
    v_pk_fma_f32 v[36:37], v[160:161], v[128:129], v[36:37] op_sel_hi:[1,0,1] neg_lo:[0,1,0] neg_hi:[0,1,0]
    v_pk_fma_f32 v[38:39], v[162:163], v[128:129], v[38:39] op_sel_hi:[1,0,1] neg_lo:[0,1,0] neg_hi:[0,1,0]
    v_pk_fma_f32 v[48:49], v[48:49], v[130:131], v[130:131] op_sel:[0,1,1] op_sel_hi:[1,1,1]
    v_pk_fma_f32 v[50:51], v[50:51], v[130:131], v[130:131] op_sel:[0,1,1] op_sel_hi:[1,1,1]
    v_rcp_f32 v48, v48
    v_rcp_f32 v49, v49
    v_rcp_f32 v50, v50
    v_rcp_f32 v51, v51
    s_nop 0
    v_pk_mul_f32 v[48:49], v[48:49], v[36:37]
    v_pk_mul_f32 v[50:51], v[50:51], v[38:39]
    v_cvt_pk_bf16_f32 v36, v48, v49
    v_cvt_pk_bf16_f32 v37, v50, v51
    buffer_store_dwordx2 v[36:37], v24, s[12:15], s46 offen
    v_pk_fma_f32 v[52:53], v[152:153], v[128:129], v[52:53] op_sel_hi:[1,0,1] neg_lo:[0,1,0] neg_hi:[0,1,0]
    v_pk_fma_f32 v[54:55], v[154:155], v[128:129], v[54:55] op_sel_hi:[1,0,1] neg_lo:[0,1,0] neg_hi:[0,1,0]
    v_pk_mul_f32 v[52:53], v[52:53], v[130:131] op_sel_hi:[1,0]
    v_pk_mul_f32 v[54:55], v[54:55], v[130:131] op_sel_hi:[1,0]
    v_exp_f32 v52, v52
    v_exp_f32 v53, v53
    v_exp_f32 v54, v54
    v_exp_f32 v55, v55
    v_pk_fma_f32 v[40:41], v[164:165], v[128:129], v[40:41] op_sel_hi:[1,0,1] neg_lo:[0,1,0] neg_hi:[0,1,0]
    v_pk_fma_f32 v[42:43], v[166:167], v[128:129], v[42:43] op_sel_hi:[1,0,1] neg_lo:[0,1,0] neg_hi:[0,1,0]
    v_pk_fma_f32 v[52:53], v[52:53], v[130:131], v[130:131] op_sel:[0,1,1] op_sel_hi:[1,1,1]
    v_pk_fma_f32 v[54:55], v[54:55], v[130:131], v[130:131] op_sel:[0,1,1] op_sel_hi:[1,1,1]
    v_rcp_f32 v52, v52
    v_rcp_f32 v53, v53
    v_rcp_f32 v54, v54
    v_rcp_f32 v55, v55
    s_nop 0
    v_pk_mul_f32 v[52:53], v[52:53], v[40:41]
    v_pk_mul_f32 v[54:55], v[54:55], v[42:43]
    v_cvt_pk_bf16_f32 v40, v52, v53
    v_cvt_pk_bf16_f32 v41, v54, v55
    buffer_store_dwordx2 v[40:41], v24, s[12:15], s47 offen
    v_pk_fma_f32 v[68:69], v[144:145], v[132:133], v[68:69] op_sel_hi:[1,0,1] neg_lo:[0,1,0] neg_hi:[0,1,0]
    v_pk_fma_f32 v[70:71], v[146:147], v[132:133], v[70:71] op_sel_hi:[1,0,1] neg_lo:[0,1,0] neg_hi:[0,1,0]
    v_pk_mul_f32 v[68:69], v[68:69], v[134:135] op_sel_hi:[1,0]
    v_pk_mul_f32 v[70:71], v[70:71], v[134:135] op_sel_hi:[1,0]
    v_exp_f32 v68, v68
    v_exp_f32 v69, v69
    v_exp_f32 v70, v70
    v_exp_f32 v71, v71
    v_pk_fma_f32 v[56:57], v[156:157], v[132:133], v[56:57] op_sel_hi:[1,0,1] neg_lo:[0,1,0] neg_hi:[0,1,0]
    v_pk_fma_f32 v[58:59], v[158:159], v[132:133], v[58:59] op_sel_hi:[1,0,1] neg_lo:[0,1,0] neg_hi:[0,1,0]
    v_pk_fma_f32 v[68:69], v[68:69], v[134:135], v[134:135] op_sel:[0,1,1] op_sel_hi:[1,1,1]
    v_pk_fma_f32 v[70:71], v[70:71], v[134:135], v[134:135] op_sel:[0,1,1] op_sel_hi:[1,1,1]
    v_rcp_f32 v68, v68
    v_rcp_f32 v69, v69
    v_rcp_f32 v70, v70
    v_rcp_f32 v71, v71
    s_nop 0
    v_pk_mul_f32 v[68:69], v[68:69], v[56:57]
    v_pk_mul_f32 v[70:71], v[70:71], v[58:59]
    v_cvt_pk_bf16_f32 v56, v68, v69
    v_cvt_pk_bf16_f32 v57, v70, v71
    buffer_store_dwordx2 v[56:57], v25, s[12:15], s45 offen
    v_pk_fma_f32 v[72:73], v[148:149], v[132:133], v[72:73] op_sel_hi:[1,0,1] neg_lo:[0,1,0] neg_hi:[0,1,0]
    v_pk_fma_f32 v[74:75], v[150:151], v[132:133], v[74:75] op_sel_hi:[1,0,1] neg_lo:[0,1,0] neg_hi:[0,1,0]
    v_pk_mul_f32 v[72:73], v[72:73], v[134:135] op_sel_hi:[1,0]
    v_pk_mul_f32 v[74:75], v[74:75], v[134:135] op_sel_hi:[1,0]
    v_exp_f32 v72, v72
    v_exp_f32 v73, v73
    v_exp_f32 v74, v74
    v_exp_f32 v75, v75
    v_pk_fma_f32 v[60:61], v[160:161], v[132:133], v[60:61] op_sel_hi:[1,0,1] neg_lo:[0,1,0] neg_hi:[0,1,0]
    v_pk_fma_f32 v[62:63], v[162:163], v[132:133], v[62:63] op_sel_hi:[1,0,1] neg_lo:[0,1,0] neg_hi:[0,1,0]
    v_pk_fma_f32 v[72:73], v[72:73], v[134:135], v[134:135] op_sel:[0,1,1] op_sel_hi:[1,1,1]
    v_pk_fma_f32 v[74:75], v[74:75], v[134:135], v[134:135] op_sel:[0,1,1] op_sel_hi:[1,1,1]
    v_rcp_f32 v72, v72
    v_rcp_f32 v73, v73
    v_rcp_f32 v74, v74
    v_rcp_f32 v75, v75
    s_nop 0
    v_pk_mul_f32 v[72:73], v[72:73], v[60:61]
    v_pk_mul_f32 v[74:75], v[74:75], v[62:63]
    v_cvt_pk_bf16_f32 v60, v72, v73
    v_cvt_pk_bf16_f32 v61, v74, v75
    buffer_store_dwordx2 v[60:61], v25, s[12:15], s46 offen
    v_pk_fma_f32 v[76:77], v[152:153], v[132:133], v[76:77] op_sel_hi:[1,0,1] neg_lo:[0,1,0] neg_hi:[0,1,0]
    v_pk_fma_f32 v[78:79], v[154:155], v[132:133], v[78:79] op_sel_hi:[1,0,1] neg_lo:[0,1,0] neg_hi:[0,1,0]
    v_pk_mul_f32 v[76:77], v[76:77], v[134:135] op_sel_hi:[1,0]
    v_pk_mul_f32 v[78:79], v[78:79], v[134:135] op_sel_hi:[1,0]
    v_exp_f32 v76, v76
    v_exp_f32 v77, v77
    v_exp_f32 v78, v78
    v_exp_f32 v79, v79
    v_pk_fma_f32 v[64:65], v[164:165], v[132:133], v[64:65] op_sel_hi:[1,0,1] neg_lo:[0,1,0] neg_hi:[0,1,0]
    v_pk_fma_f32 v[66:67], v[166:167], v[132:133], v[66:67] op_sel_hi:[1,0,1] neg_lo:[0,1,0] neg_hi:[0,1,0]
    v_pk_fma_f32 v[76:77], v[76:77], v[134:135], v[134:135] op_sel:[0,1,1] op_sel_hi:[1,1,1]
    v_pk_fma_f32 v[78:79], v[78:79], v[134:135], v[134:135] op_sel:[0,1,1] op_sel_hi:[1,1,1]
    v_rcp_f32 v76, v76
    v_rcp_f32 v77, v77
    v_rcp_f32 v78, v78
    v_rcp_f32 v79, v79
    s_nop 0
    v_pk_mul_f32 v[76:77], v[76:77], v[64:65]
    v_pk_mul_f32 v[78:79], v[78:79], v[66:67]
    v_cvt_pk_bf16_f32 v64, v76, v77
    v_cvt_pk_bf16_f32 v65, v78, v79
    buffer_store_dwordx2 v[64:65], v25, s[12:15], s47 offen
    v_pk_fma_f32 v[92:93], v[144:145], v[136:137], v[92:93] op_sel_hi:[1,0,1] neg_lo:[0,1,0] neg_hi:[0,1,0]
    v_pk_fma_f32 v[94:95], v[146:147], v[136:137], v[94:95] op_sel_hi:[1,0,1] neg_lo:[0,1,0] neg_hi:[0,1,0]
    v_pk_mul_f32 v[92:93], v[92:93], v[138:139] op_sel_hi:[1,0]
    v_pk_mul_f32 v[94:95], v[94:95], v[138:139] op_sel_hi:[1,0]
    v_exp_f32 v92, v92
    v_exp_f32 v93, v93
    v_exp_f32 v94, v94
    v_exp_f32 v95, v95
    v_pk_fma_f32 v[80:81], v[156:157], v[136:137], v[80:81] op_sel_hi:[1,0,1] neg_lo:[0,1,0] neg_hi:[0,1,0]
    v_pk_fma_f32 v[82:83], v[158:159], v[136:137], v[82:83] op_sel_hi:[1,0,1] neg_lo:[0,1,0] neg_hi:[0,1,0]
    v_pk_fma_f32 v[92:93], v[92:93], v[138:139], v[138:139] op_sel:[0,1,1] op_sel_hi:[1,1,1]
    v_pk_fma_f32 v[94:95], v[94:95], v[138:139], v[138:139] op_sel:[0,1,1] op_sel_hi:[1,1,1]
    v_rcp_f32 v92, v92
    v_rcp_f32 v93, v93
    v_rcp_f32 v94, v94
    v_rcp_f32 v95, v95
    s_nop 0
    v_pk_mul_f32 v[92:93], v[92:93], v[80:81]
    v_pk_mul_f32 v[94:95], v[94:95], v[82:83]
    v_cvt_pk_bf16_f32 v80, v92, v93
    v_cvt_pk_bf16_f32 v81, v94, v95
    buffer_store_dwordx2 v[80:81], v26, s[12:15], s45 offen
    v_pk_fma_f32 v[96:97], v[148:149], v[136:137], v[96:97] op_sel_hi:[1,0,1] neg_lo:[0,1,0] neg_hi:[0,1,0]
    v_pk_fma_f32 v[98:99], v[150:151], v[136:137], v[98:99] op_sel_hi:[1,0,1] neg_lo:[0,1,0] neg_hi:[0,1,0]
    v_pk_mul_f32 v[96:97], v[96:97], v[138:139] op_sel_hi:[1,0]
    v_pk_mul_f32 v[98:99], v[98:99], v[138:139] op_sel_hi:[1,0]
    v_exp_f32 v96, v96
    v_exp_f32 v97, v97
    v_exp_f32 v98, v98
    v_exp_f32 v99, v99
    v_pk_fma_f32 v[84:85], v[160:161], v[136:137], v[84:85] op_sel_hi:[1,0,1] neg_lo:[0,1,0] neg_hi:[0,1,0]
    v_pk_fma_f32 v[86:87], v[162:163], v[136:137], v[86:87] op_sel_hi:[1,0,1] neg_lo:[0,1,0] neg_hi:[0,1,0]
    v_pk_fma_f32 v[96:97], v[96:97], v[138:139], v[138:139] op_sel:[0,1,1] op_sel_hi:[1,1,1]
    v_pk_fma_f32 v[98:99], v[98:99], v[138:139], v[138:139] op_sel:[0,1,1] op_sel_hi:[1,1,1]
    v_rcp_f32 v96, v96
    v_rcp_f32 v97, v97
    v_rcp_f32 v98, v98
    v_rcp_f32 v99, v99
    s_nop 0
    v_pk_mul_f32 v[96:97], v[96:97], v[84:85]
    v_pk_mul_f32 v[98:99], v[98:99], v[86:87]
    v_cvt_pk_bf16_f32 v84, v96, v97
    v_cvt_pk_bf16_f32 v85, v98, v99
    buffer_store_dwordx2 v[84:85], v26, s[12:15], s46 offen
    v_pk_fma_f32 v[100:101], v[152:153], v[136:137], v[100:101] op_sel_hi:[1,0,1] neg_lo:[0,1,0] neg_hi:[0,1,0]
    v_pk_fma_f32 v[102:103], v[154:155], v[136:137], v[102:103] op_sel_hi:[1,0,1] neg_lo:[0,1,0] neg_hi:[0,1,0]
    v_pk_mul_f32 v[100:101], v[100:101], v[138:139] op_sel_hi:[1,0]
    v_pk_mul_f32 v[102:103], v[102:103], v[138:139] op_sel_hi:[1,0]
    v_exp_f32 v100, v100
    v_exp_f32 v101, v101
    v_exp_f32 v102, v102
    v_exp_f32 v103, v103
    v_pk_fma_f32 v[88:89], v[164:165], v[136:137], v[88:89] op_sel_hi:[1,0,1] neg_lo:[0,1,0] neg_hi:[0,1,0]
    v_pk_fma_f32 v[90:91], v[166:167], v[136:137], v[90:91] op_sel_hi:[1,0,1] neg_lo:[0,1,0] neg_hi:[0,1,0]
    v_pk_fma_f32 v[100:101], v[100:101], v[138:139], v[138:139] op_sel:[0,1,1] op_sel_hi:[1,1,1]
    v_pk_fma_f32 v[102:103], v[102:103], v[138:139], v[138:139] op_sel:[0,1,1] op_sel_hi:[1,1,1]
    v_rcp_f32 v100, v100
    v_rcp_f32 v101, v101
    v_rcp_f32 v102, v102
    v_rcp_f32 v103, v103
    s_nop 0
    v_pk_mul_f32 v[100:101], v[100:101], v[88:89]
    v_pk_mul_f32 v[102:103], v[102:103], v[90:91]
    v_cvt_pk_bf16_f32 v88, v100, v101
    v_cvt_pk_bf16_f32 v89, v102, v103
    buffer_store_dwordx2 v[88:89], v26, s[12:15], s47 offen
    v_pk_fma_f32 v[116:117], v[144:145], v[140:141], v[116:117] op_sel_hi:[1,0,1] neg_lo:[0,1,0] neg_hi:[0,1,0]
    v_pk_fma_f32 v[118:119], v[146:147], v[140:141], v[118:119] op_sel_hi:[1,0,1] neg_lo:[0,1,0] neg_hi:[0,1,0]
    v_pk_mul_f32 v[116:117], v[116:117], v[142:143] op_sel_hi:[1,0]
    v_pk_mul_f32 v[118:119], v[118:119], v[142:143] op_sel_hi:[1,0]
    v_exp_f32 v116, v116
    v_exp_f32 v117, v117
    v_exp_f32 v118, v118
    v_exp_f32 v119, v119
    v_pk_fma_f32 v[104:105], v[156:157], v[140:141], v[104:105] op_sel_hi:[1,0,1] neg_lo:[0,1,0] neg_hi:[0,1,0]
    v_pk_fma_f32 v[106:107], v[158:159], v[140:141], v[106:107] op_sel_hi:[1,0,1] neg_lo:[0,1,0] neg_hi:[0,1,0]
    v_pk_fma_f32 v[116:117], v[116:117], v[142:143], v[142:143] op_sel:[0,1,1] op_sel_hi:[1,1,1]
    v_pk_fma_f32 v[118:119], v[118:119], v[142:143], v[142:143] op_sel:[0,1,1] op_sel_hi:[1,1,1]
    v_rcp_f32 v116, v116
    v_rcp_f32 v117, v117
    v_rcp_f32 v118, v118
    v_rcp_f32 v119, v119
    s_nop 0
    v_pk_mul_f32 v[116:117], v[116:117], v[104:105]
    v_pk_mul_f32 v[118:119], v[118:119], v[106:107]
    v_cvt_pk_bf16_f32 v104, v116, v117
    v_cvt_pk_bf16_f32 v105, v118, v119
    buffer_store_dwordx2 v[104:105], v27, s[12:15], s45 offen
    v_pk_fma_f32 v[120:121], v[148:149], v[140:141], v[120:121] op_sel_hi:[1,0,1] neg_lo:[0,1,0] neg_hi:[0,1,0]
    v_pk_fma_f32 v[122:123], v[150:151], v[140:141], v[122:123] op_sel_hi:[1,0,1] neg_lo:[0,1,0] neg_hi:[0,1,0]
    v_pk_mul_f32 v[120:121], v[120:121], v[142:143] op_sel_hi:[1,0]
    v_pk_mul_f32 v[122:123], v[122:123], v[142:143] op_sel_hi:[1,0]
    v_exp_f32 v120, v120
    v_exp_f32 v121, v121
    v_exp_f32 v122, v122
    v_exp_f32 v123, v123
    v_pk_fma_f32 v[108:109], v[160:161], v[140:141], v[108:109] op_sel_hi:[1,0,1] neg_lo:[0,1,0] neg_hi:[0,1,0]
    v_pk_fma_f32 v[110:111], v[162:163], v[140:141], v[110:111] op_sel_hi:[1,0,1] neg_lo:[0,1,0] neg_hi:[0,1,0]
    v_pk_fma_f32 v[120:121], v[120:121], v[142:143], v[142:143] op_sel:[0,1,1] op_sel_hi:[1,1,1]
    v_pk_fma_f32 v[122:123], v[122:123], v[142:143], v[142:143] op_sel:[0,1,1] op_sel_hi:[1,1,1]
    v_rcp_f32 v120, v120
    v_rcp_f32 v121, v121
    v_rcp_f32 v122, v122
    v_rcp_f32 v123, v123
    s_nop 0
    v_pk_mul_f32 v[120:121], v[120:121], v[108:109]
    v_pk_mul_f32 v[122:123], v[122:123], v[110:111]
    v_cvt_pk_bf16_f32 v108, v120, v121
    v_cvt_pk_bf16_f32 v109, v122, v123
    buffer_store_dwordx2 v[108:109], v27, s[12:15], s46 offen
    v_pk_fma_f32 v[124:125], v[152:153], v[140:141], v[124:125] op_sel_hi:[1,0,1] neg_lo:[0,1,0] neg_hi:[0,1,0]
    v_pk_fma_f32 v[126:127], v[154:155], v[140:141], v[126:127] op_sel_hi:[1,0,1] neg_lo:[0,1,0] neg_hi:[0,1,0]
    v_pk_mul_f32 v[124:125], v[124:125], v[142:143] op_sel_hi:[1,0]
    v_pk_mul_f32 v[126:127], v[126:127], v[142:143] op_sel_hi:[1,0]
    v_exp_f32 v124, v124
    v_exp_f32 v125, v125
    v_exp_f32 v126, v126
    v_exp_f32 v127, v127
    v_pk_fma_f32 v[112:113], v[164:165], v[140:141], v[112:113] op_sel_hi:[1,0,1] neg_lo:[0,1,0] neg_hi:[0,1,0]
    v_pk_fma_f32 v[114:115], v[166:167], v[140:141], v[114:115] op_sel_hi:[1,0,1] neg_lo:[0,1,0] neg_hi:[0,1,0]
    v_pk_fma_f32 v[124:125], v[124:125], v[142:143], v[142:143] op_sel:[0,1,1] op_sel_hi:[1,1,1]
    v_pk_fma_f32 v[126:127], v[126:127], v[142:143], v[142:143] op_sel:[0,1,1] op_sel_hi:[1,1,1]
    v_rcp_f32 v124, v124
    v_rcp_f32 v125, v125
    v_rcp_f32 v126, v126
    v_rcp_f32 v127, v127
    s_nop 0
    v_pk_mul_f32 v[124:125], v[124:125], v[112:113]
    v_pk_mul_f32 v[126:127], v[126:127], v[114:115]
    v_cvt_pk_bf16_f32 v112, v124, v125
    v_cvt_pk_bf16_f32 v113, v126, v127
    buffer_store_dwordx2 v[112:113], v27, s[12:15], s47 offen
L_g1_g_end:
    s_endpgm
.p2align 8
g2_kernel:
    s_cmp_ge_u32 s2, 256
    s_cbranch_scc1 L_g2_done
    s_load_dwordx2 s[4:5], s[0:1], 0
    s_load_dwordx2 s[10:11], s[0:1], 56
    s_load_dwordx2 s[28:29], s[0:1], 72
    v_lshrrev_b32 v1, 6, v0
    v_and_b32 v0, 63, v0
    s_nop 0
    v_readfirstlane_b32 s32, v1
    s_and_b32 s33, s2, 7
    s_lshr_b32 s3, s2, 3
    s_and_b32 s34, s3, 7
    s_lshr_b32 s3, s3, 3
    s_lshl_b32 s33, s33, 2
    s_add_u32 s33, s33, s3
    v_lshrrev_b32 v2, 4, v0
    v_lshlrev_b32 v5, 4, v0
    s_mul_i32 s40, s32, 10
    s_lshl_b32 s41, s32, 3
    s_add_u32 s41, s41, 4
    s_cmp_lt_u32 s32, 2
    s_cselect_b32 s40, s40, s41
    s_lshl_b32 s47, s40, 10
    s_mul_i32 s48, s34, 68
    s_add_u32 s48, s48, s40
    s_mul_i32 s48, s48, 5120
    s_add_u32 s48, s48, 9437184
    s_mul_i32 s42, s32, 20480
    s_mul_i32 s45, s34, 160
    s_lshl_b32 s44, s33, 2
    s_add_u32 s44, s44, 0
    s_mul_i32 s44, s44, 69632
    v_add_u32 v10, s44, v5
    s_lshl_b32 s44, s33, 2
    s_add_u32 s44, s44, 1
    s_mul_i32 s44, s44, 69632
    v_add_u32 v11, s44, v5
    s_lshl_b32 s44, s33, 2
    s_add_u32 s44, s44, 2
    s_mul_i32 s44, s44, 69632
    v_add_u32 v12, s44, v5
    s_lshl_b32 s44, s33, 2
    s_add_u32 s44, s44, 3
    s_mul_i32 s44, s44, 69632
    v_add_u32 v13, s44, v5
    v_add_u32 v14, 4096, v5
    s_waitcnt lgkmcnt(0)
    s_mov_b32 s12, s28
    s_mov_b32 s13, s29
    s_mov_b32 s14, 16777216
    s_mov_b32 s15, 0x00020000
    s_mov_b32 s20, s4
    s_mov_b32 s21, s5
    s_mov_b32 s22, 2621440
    s_mov_b32 s23, 0x00020000
    s_mov_b32 s24, s10
    s_mov_b32 s25, s11
    s_mov_b32 s26, 2621440
    s_mov_b32 s27, 0x00020000
    s_cmp_lt_u32 s32, 2
    s_cbranch_scc0 L_g2_h
    buffer_load_dwordx4 v[112:115], v10, s[12:15], s47 offen
    buffer_load_dwordx4 v[116:119], v11, s[12:15], s47 offen
    buffer_load_dwordx4 v[120:123], v12, s[12:15], s47 offen
    buffer_load_dwordx4 v[124:127], v13, s[12:15], s47 offen
    buffer_load_dwordx4 v[128:131], v5, s[12:15], s48 offen offset:0
    buffer_load_dwordx4 v[132:135], v5, s[12:15], s48 offen offset:1024
    buffer_load_dwordx4 v[136:139], v5, s[12:15], s48 offen offset:2048
    buffer_load_dwordx4 v[140:143], v5, s[12:15], s48 offen offset:3072
    buffer_load_dwordx4 v[144:147], v14, s[12:15], s48 offen
    s_add_u32 s47, s47, 1024
    s_add_u32 s48, s48, 5120
    buffer_load_dwordx4 v[148:151], v10, s[12:15], s47 offen
    buffer_load_dwordx4 v[152:155], v11, s[12:15], s47 offen
    buffer_load_dwordx4 v[156:159], v12, s[12:15], s47 offen
    buffer_load_dwordx4 v[160:163], v13, s[12:15], s47 offen
    buffer_load_dwordx4 v[164:167], v5, s[12:15], s48 offen offset:0
    buffer_load_dwordx4 v[168:171], v5, s[12:15], s48 offen offset:1024
    buffer_load_dwordx4 v[172:175], v5, s[12:15], s48 offen offset:2048
    buffer_load_dwordx4 v[176:179], v5, s[12:15], s48 offen offset:3072
    buffer_load_dwordx4 v[180:183], v14, s[12:15], s48 offen
    s_add_u32 s47, s47, 1024
    s_add_u32 s48, s48, 5120
    buffer_load_dwordx4 v[184:187], v10, s[12:15], s47 offen
    buffer_load_dwordx4 v[188:191], v11, s[12:15], s47 offen
    buffer_load_dwordx4 v[192:195], v12, s[12:15], s47 offen
    buffer_load_dwordx4 v[196:199], v13, s[12:15], s47 offen
    buffer_load_dwordx4 v[200:203], v5, s[12:15], s48 offen offset:0
    buffer_load_dwordx4 v[204:207], v5, s[12:15], s48 offen offset:1024
    buffer_load_dwordx4 v[208:211], v5, s[12:15], s48 offen offset:2048
    buffer_load_dwordx4 v[212:215], v5, s[12:15], s48 offen offset:3072
    buffer_load_dwordx4 v[216:219], v14, s[12:15], s48 offen
    s_add_u32 s47, s47, 1024
    s_add_u32 s48, s48, 5120
    buffer_load_dwordx4 v[220:223], v10, s[12:15], s47 offen
    buffer_load_dwordx4 v[224:227], v11, s[12:15], s47 offen
    buffer_load_dwordx4 v[228:231], v12, s[12:15], s47 offen
    buffer_load_dwordx4 v[232:235], v13, s[12:15], s47 offen
    buffer_load_dwordx4 v[236:239], v5, s[12:15], s48 offen offset:0
    buffer_load_dwordx4 v[240:243], v5, s[12:15], s48 offen offset:1024
    buffer_load_dwordx4 v[244:247], v5, s[12:15], s48 offen offset:2048
    buffer_load_dwordx4 v[248:251], v5, s[12:15], s48 offen offset:3072
    buffer_load_dwordx4 v[252:255], v14, s[12:15], s48 offen
    s_add_u32 s47, s47, 1024
    s_add_u32 s48, s48, 5120
    s_waitcnt vmcnt(27)
    v_mfma_f32_16x16x32_bf16 v[32:35], v[128:131], v[112:115], 0
    v_mfma_f32_16x16x32_bf16 v[52:55], v[128:131], v[116:119], 0
    v_mfma_f32_16x16x32_bf16 v[72:75], v[128:131], v[120:123], 0
    v_mfma_f32_16x16x32_bf16 v[92:95], v[128:131], v[124:127], 0
    v_mfma_f32_16x16x32_bf16 v[36:39], v[132:135], v[112:115], 0
    v_mfma_f32_16x16x32_bf16 v[56:59], v[132:135], v[116:119], 0
    v_mfma_f32_16x16x32_bf16 v[76:79], v[132:135], v[120:123], 0
    v_mfma_f32_16x16x32_bf16 v[96:99], v[132:135], v[124:127], 0
    v_mfma_f32_16x16x32_bf16 v[40:43], v[136:139], v[112:115], 0
    v_mfma_f32_16x16x32_bf16 v[60:63], v[136:139], v[116:119], 0
    v_mfma_f32_16x16x32_bf16 v[80:83], v[136:139], v[120:123], 0
    v_mfma_f32_16x16x32_bf16 v[100:103], v[136:139], v[124:127], 0
    v_mfma_f32_16x16x32_bf16 v[44:47], v[140:143], v[112:115], 0
    v_mfma_f32_16x16x32_bf16 v[64:67], v[140:143], v[116:119], 0
    v_mfma_f32_16x16x32_bf16 v[84:87], v[140:143], v[120:123], 0
    v_mfma_f32_16x16x32_bf16 v[104:107], v[140:143], v[124:127], 0
    v_mfma_f32_16x16x32_bf16 v[48:51], v[144:147], v[112:115], 0
    v_mfma_f32_16x16x32_bf16 v[68:71], v[144:147], v[116:119], 0
    v_mfma_f32_16x16x32_bf16 v[88:91], v[144:147], v[120:123], 0
    v_mfma_f32_16x16x32_bf16 v[108:111], v[144:147], v[124:127], 0
    buffer_load_dwordx4 v[112:115], v10, s[12:15], s47 offen
    buffer_load_dwordx4 v[116:119], v11, s[12:15], s47 offen
    buffer_load_dwordx4 v[120:123], v12, s[12:15], s47 offen
    buffer_load_dwordx4 v[124:127], v13, s[12:15], s47 offen
    buffer_load_dwordx4 v[128:131], v5, s[12:15], s48 offen offset:0
    buffer_load_dwordx4 v[132:135], v5, s[12:15], s48 offen offset:1024
    buffer_load_dwordx4 v[136:139], v5, s[12:15], s48 offen offset:2048
    buffer_load_dwordx4 v[140:143], v5, s[12:15], s48 offen offset:3072
    buffer_load_dwordx4 v[144:147], v14, s[12:15], s48 offen
    s_add_u32 s47, s47, 1024
    s_add_u32 s48, s48, 5120
    s_waitcnt vmcnt(27)
    v_mfma_f32_16x16x32_bf16 v[32:35], v[164:167], v[148:151], v[32:35]
    v_mfma_f32_16x16x32_bf16 v[52:55], v[164:167], v[152:155], v[52:55]
    v_mfma_f32_16x16x32_bf16 v[72:75], v[164:167], v[156:159], v[72:75]
    v_mfma_f32_16x16x32_bf16 v[92:95], v[164:167], v[160:163], v[92:95]
    v_mfma_f32_16x16x32_bf16 v[36:39], v[168:171], v[148:151], v[36:39]
    v_mfma_f32_16x16x32_bf16 v[56:59], v[168:171], v[152:155], v[56:59]
    v_mfma_f32_16x16x32_bf16 v[76:79], v[168:171], v[156:159], v[76:79]
    v_mfma_f32_16x16x32_bf16 v[96:99], v[168:171], v[160:163], v[96:99]
    v_mfma_f32_16x16x32_bf16 v[40:43], v[172:175], v[148:151], v[40:43]
    v_mfma_f32_16x16x32_bf16 v[60:63], v[172:175], v[152:155], v[60:63]
    v_mfma_f32_16x16x32_bf16 v[80:83], v[172:175], v[156:159], v[80:83]
    v_mfma_f32_16x16x32_bf16 v[100:103], v[172:175], v[160:163], v[100:103]
    v_mfma_f32_16x16x32_bf16 v[44:47], v[176:179], v[148:151], v[44:47]
    v_mfma_f32_16x16x32_bf16 v[64:67], v[176:179], v[152:155], v[64:67]
    v_mfma_f32_16x16x32_bf16 v[84:87], v[176:179], v[156:159], v[84:87]
    v_mfma_f32_16x16x32_bf16 v[104:107], v[176:179], v[160:163], v[104:107]
    v_mfma_f32_16x16x32_bf16 v[48:51], v[180:183], v[148:151], v[48:51]
    v_mfma_f32_16x16x32_bf16 v[68:71], v[180:183], v[152:155], v[68:71]
    v_mfma_f32_16x16x32_bf16 v[88:91], v[180:183], v[156:159], v[88:91]
    v_mfma_f32_16x16x32_bf16 v[108:111], v[180:183], v[160:163], v[108:111]
    buffer_load_dwordx4 v[148:151], v10, s[12:15], s47 offen
    buffer_load_dwordx4 v[152:155], v11, s[12:15], s47 offen
    buffer_load_dwordx4 v[156:159], v12, s[12:15], s47 offen
    buffer_load_dwordx4 v[160:163], v13, s[12:15], s47 offen
    buffer_load_dwordx4 v[164:167], v5, s[12:15], s48 offen offset:0
    buffer_load_dwordx4 v[168:171], v5, s[12:15], s48 offen offset:1024
    buffer_load_dwordx4 v[172:175], v5, s[12:15], s48 offen offset:2048
    buffer_load_dwordx4 v[176:179], v5, s[12:15], s48 offen offset:3072
    buffer_load_dwordx4 v[180:183], v14, s[12:15], s48 offen
    s_add_u32 s47, s47, 1024
    s_add_u32 s48, s48, 5120
    s_waitcnt vmcnt(27)
    v_mfma_f32_16x16x32_bf16 v[32:35], v[200:203], v[184:187], v[32:35]
    v_mfma_f32_16x16x32_bf16 v[52:55], v[200:203], v[188:191], v[52:55]
    v_mfma_f32_16x16x32_bf16 v[72:75], v[200:203], v[192:195], v[72:75]
    v_mfma_f32_16x16x32_bf16 v[92:95], v[200:203], v[196:199], v[92:95]
    v_mfma_f32_16x16x32_bf16 v[36:39], v[204:207], v[184:187], v[36:39]
    v_mfma_f32_16x16x32_bf16 v[56:59], v[204:207], v[188:191], v[56:59]
    v_mfma_f32_16x16x32_bf16 v[76:79], v[204:207], v[192:195], v[76:79]
    v_mfma_f32_16x16x32_bf16 v[96:99], v[204:207], v[196:199], v[96:99]
    v_mfma_f32_16x16x32_bf16 v[40:43], v[208:211], v[184:187], v[40:43]
    v_mfma_f32_16x16x32_bf16 v[60:63], v[208:211], v[188:191], v[60:63]
    v_mfma_f32_16x16x32_bf16 v[80:83], v[208:211], v[192:195], v[80:83]
    v_mfma_f32_16x16x32_bf16 v[100:103], v[208:211], v[196:199], v[100:103]
    v_mfma_f32_16x16x32_bf16 v[44:47], v[212:215], v[184:187], v[44:47]
    v_mfma_f32_16x16x32_bf16 v[64:67], v[212:215], v[188:191], v[64:67]
    v_mfma_f32_16x16x32_bf16 v[84:87], v[212:215], v[192:195], v[84:87]
    v_mfma_f32_16x16x32_bf16 v[104:107], v[212:215], v[196:199], v[104:107]
    v_mfma_f32_16x16x32_bf16 v[48:51], v[216:219], v[184:187], v[48:51]
    v_mfma_f32_16x16x32_bf16 v[68:71], v[216:219], v[188:191], v[68:71]
    v_mfma_f32_16x16x32_bf16 v[88:91], v[216:219], v[192:195], v[88:91]
    v_mfma_f32_16x16x32_bf16 v[108:111], v[216:219], v[196:199], v[108:111]
    buffer_load_dwordx4 v[184:187], v10, s[12:15], s47 offen
    buffer_load_dwordx4 v[188:191], v11, s[12:15], s47 offen
    buffer_load_dwordx4 v[192:195], v12, s[12:15], s47 offen
    buffer_load_dwordx4 v[196:199], v13, s[12:15], s47 offen
    buffer_load_dwordx4 v[200:203], v5, s[12:15], s48 offen offset:0
    buffer_load_dwordx4 v[204:207], v5, s[12:15], s48 offen offset:1024
    buffer_load_dwordx4 v[208:211], v5, s[12:15], s48 offen offset:2048
    buffer_load_dwordx4 v[212:215], v5, s[12:15], s48 offen offset:3072
    buffer_load_dwordx4 v[216:219], v14, s[12:15], s48 offen
    s_add_u32 s47, s47, 1024
    s_add_u32 s48, s48, 5120
    s_waitcnt vmcnt(27)
    v_mfma_f32_16x16x32_bf16 v[32:35], v[236:239], v[220:223], v[32:35]
    v_mfma_f32_16x16x32_bf16 v[52:55], v[236:239], v[224:227], v[52:55]
    v_mfma_f32_16x16x32_bf16 v[72:75], v[236:239], v[228:231], v[72:75]
    v_mfma_f32_16x16x32_bf16 v[92:95], v[236:239], v[232:235], v[92:95]
    v_mfma_f32_16x16x32_bf16 v[36:39], v[240:243], v[220:223], v[36:39]
    v_mfma_f32_16x16x32_bf16 v[56:59], v[240:243], v[224:227], v[56:59]
    v_mfma_f32_16x16x32_bf16 v[76:79], v[240:243], v[228:231], v[76:79]
    v_mfma_f32_16x16x32_bf16 v[96:99], v[240:243], v[232:235], v[96:99]
    v_mfma_f32_16x16x32_bf16 v[40:43], v[244:247], v[220:223], v[40:43]
    v_mfma_f32_16x16x32_bf16 v[60:63], v[244:247], v[224:227], v[60:63]
    v_mfma_f32_16x16x32_bf16 v[80:83], v[244:247], v[228:231], v[80:83]
    v_mfma_f32_16x16x32_bf16 v[100:103], v[244:247], v[232:235], v[100:103]
    v_mfma_f32_16x16x32_bf16 v[44:47], v[248:251], v[220:223], v[44:47]
    v_mfma_f32_16x16x32_bf16 v[64:67], v[248:251], v[224:227], v[64:67]
    v_mfma_f32_16x16x32_bf16 v[84:87], v[248:251], v[228:231], v[84:87]
    v_mfma_f32_16x16x32_bf16 v[104:107], v[248:251], v[232:235], v[104:107]
    v_mfma_f32_16x16x32_bf16 v[48:51], v[252:255], v[220:223], v[48:51]
    v_mfma_f32_16x16x32_bf16 v[68:71], v[252:255], v[224:227], v[68:71]
    v_mfma_f32_16x16x32_bf16 v[88:91], v[252:255], v[228:231], v[88:91]
    v_mfma_f32_16x16x32_bf16 v[108:111], v[252:255], v[232:235], v[108:111]
    buffer_load_dwordx4 v[220:223], v10, s[12:15], s47 offen
    buffer_load_dwordx4 v[224:227], v11, s[12:15], s47 offen
    buffer_load_dwordx4 v[228:231], v12, s[12:15], s47 offen
    buffer_load_dwordx4 v[232:235], v13, s[12:15], s47 offen
    buffer_load_dwordx4 v[236:239], v5, s[12:15], s48 offen offset:0
    buffer_load_dwordx4 v[240:243], v5, s[12:15], s48 offen offset:1024
    buffer_load_dwordx4 v[244:247], v5, s[12:15], s48 offen offset:2048
    buffer_load_dwordx4 v[248:251], v5, s[12:15], s48 offen offset:3072
    buffer_load_dwordx4 v[252:255], v14, s[12:15], s48 offen
    s_add_u32 s47, s47, 1024
    s_add_u32 s48, s48, 5120
    s_waitcnt vmcnt(27)
    v_mfma_f32_16x16x32_bf16 v[32:35], v[128:131], v[112:115], v[32:35]
    v_mfma_f32_16x16x32_bf16 v[52:55], v[128:131], v[116:119], v[52:55]
    v_mfma_f32_16x16x32_bf16 v[72:75], v[128:131], v[120:123], v[72:75]
    v_mfma_f32_16x16x32_bf16 v[92:95], v[128:131], v[124:127], v[92:95]
    v_mfma_f32_16x16x32_bf16 v[36:39], v[132:135], v[112:115], v[36:39]
    v_mfma_f32_16x16x32_bf16 v[56:59], v[132:135], v[116:119], v[56:59]
    v_mfma_f32_16x16x32_bf16 v[76:79], v[132:135], v[120:123], v[76:79]
    v_mfma_f32_16x16x32_bf16 v[96:99], v[132:135], v[124:127], v[96:99]
    v_mfma_f32_16x16x32_bf16 v[40:43], v[136:139], v[112:115], v[40:43]
    v_mfma_f32_16x16x32_bf16 v[60:63], v[136:139], v[116:119], v[60:63]
    v_mfma_f32_16x16x32_bf16 v[80:83], v[136:139], v[120:123], v[80:83]
    v_mfma_f32_16x16x32_bf16 v[100:103], v[136:139], v[124:127], v[100:103]
    v_mfma_f32_16x16x32_bf16 v[44:47], v[140:143], v[112:115], v[44:47]
    v_mfma_f32_16x16x32_bf16 v[64:67], v[140:143], v[116:119], v[64:67]
    v_mfma_f32_16x16x32_bf16 v[84:87], v[140:143], v[120:123], v[84:87]
    v_mfma_f32_16x16x32_bf16 v[104:107], v[140:143], v[124:127], v[104:107]
    v_mfma_f32_16x16x32_bf16 v[48:51], v[144:147], v[112:115], v[48:51]
    v_mfma_f32_16x16x32_bf16 v[68:71], v[144:147], v[116:119], v[68:71]
    v_mfma_f32_16x16x32_bf16 v[88:91], v[144:147], v[120:123], v[88:91]
    v_mfma_f32_16x16x32_bf16 v[108:111], v[144:147], v[124:127], v[108:111]
    buffer_load_dwordx4 v[112:115], v10, s[12:15], s47 offen
    buffer_load_dwordx4 v[116:119], v11, s[12:15], s47 offen
    buffer_load_dwordx4 v[120:123], v12, s[12:15], s47 offen
    buffer_load_dwordx4 v[124:127], v13, s[12:15], s47 offen
    buffer_load_dwordx4 v[128:131], v5, s[12:15], s48 offen offset:0
    buffer_load_dwordx4 v[132:135], v5, s[12:15], s48 offen offset:1024
    buffer_load_dwordx4 v[136:139], v5, s[12:15], s48 offen offset:2048
    buffer_load_dwordx4 v[140:143], v5, s[12:15], s48 offen offset:3072
    buffer_load_dwordx4 v[144:147], v14, s[12:15], s48 offen
    s_add_u32 s47, s47, 1024
    s_add_u32 s48, s48, 5120
    s_waitcnt vmcnt(27)
    v_mfma_f32_16x16x32_bf16 v[32:35], v[164:167], v[148:151], v[32:35]
    v_mfma_f32_16x16x32_bf16 v[52:55], v[164:167], v[152:155], v[52:55]
    v_mfma_f32_16x16x32_bf16 v[72:75], v[164:167], v[156:159], v[72:75]
    v_mfma_f32_16x16x32_bf16 v[92:95], v[164:167], v[160:163], v[92:95]
    v_mfma_f32_16x16x32_bf16 v[36:39], v[168:171], v[148:151], v[36:39]
    v_mfma_f32_16x16x32_bf16 v[56:59], v[168:171], v[152:155], v[56:59]
    v_mfma_f32_16x16x32_bf16 v[76:79], v[168:171], v[156:159], v[76:79]
    v_mfma_f32_16x16x32_bf16 v[96:99], v[168:171], v[160:163], v[96:99]
    v_mfma_f32_16x16x32_bf16 v[40:43], v[172:175], v[148:151], v[40:43]
    v_mfma_f32_16x16x32_bf16 v[60:63], v[172:175], v[152:155], v[60:63]
    v_mfma_f32_16x16x32_bf16 v[80:83], v[172:175], v[156:159], v[80:83]
    v_mfma_f32_16x16x32_bf16 v[100:103], v[172:175], v[160:163], v[100:103]
    v_mfma_f32_16x16x32_bf16 v[44:47], v[176:179], v[148:151], v[44:47]
    v_mfma_f32_16x16x32_bf16 v[64:67], v[176:179], v[152:155], v[64:67]
    v_mfma_f32_16x16x32_bf16 v[84:87], v[176:179], v[156:159], v[84:87]
    v_mfma_f32_16x16x32_bf16 v[104:107], v[176:179], v[160:163], v[104:107]
    v_mfma_f32_16x16x32_bf16 v[48:51], v[180:183], v[148:151], v[48:51]
    v_mfma_f32_16x16x32_bf16 v[68:71], v[180:183], v[152:155], v[68:71]
    v_mfma_f32_16x16x32_bf16 v[88:91], v[180:183], v[156:159], v[88:91]
    v_mfma_f32_16x16x32_bf16 v[108:111], v[180:183], v[160:163], v[108:111]
    buffer_load_dwordx4 v[148:151], v10, s[12:15], s47 offen
    buffer_load_dwordx4 v[152:155], v11, s[12:15], s47 offen
    buffer_load_dwordx4 v[156:159], v12, s[12:15], s47 offen
    buffer_load_dwordx4 v[160:163], v13, s[12:15], s47 offen
    buffer_load_dwordx4 v[164:167], v5, s[12:15], s48 offen offset:0
    buffer_load_dwordx4 v[168:171], v5, s[12:15], s48 offen offset:1024
    buffer_load_dwordx4 v[172:175], v5, s[12:15], s48 offen offset:2048
    buffer_load_dwordx4 v[176:179], v5, s[12:15], s48 offen offset:3072
    buffer_load_dwordx4 v[180:183], v14, s[12:15], s48 offen
    s_add_u32 s47, s47, 1024
    s_add_u32 s48, s48, 5120
    s_waitcnt vmcnt(27)
    v_mfma_f32_16x16x32_bf16 v[32:35], v[200:203], v[184:187], v[32:35]
    v_mfma_f32_16x16x32_bf16 v[52:55], v[200:203], v[188:191], v[52:55]
    v_mfma_f32_16x16x32_bf16 v[72:75], v[200:203], v[192:195], v[72:75]
    v_mfma_f32_16x16x32_bf16 v[92:95], v[200:203], v[196:199], v[92:95]
    v_mfma_f32_16x16x32_bf16 v[36:39], v[204:207], v[184:187], v[36:39]
    v_mfma_f32_16x16x32_bf16 v[56:59], v[204:207], v[188:191], v[56:59]
    v_mfma_f32_16x16x32_bf16 v[76:79], v[204:207], v[192:195], v[76:79]
    v_mfma_f32_16x16x32_bf16 v[96:99], v[204:207], v[196:199], v[96:99]
    v_mfma_f32_16x16x32_bf16 v[40:43], v[208:211], v[184:187], v[40:43]
    v_mfma_f32_16x16x32_bf16 v[60:63], v[208:211], v[188:191], v[60:63]
    v_mfma_f32_16x16x32_bf16 v[80:83], v[208:211], v[192:195], v[80:83]
    v_mfma_f32_16x16x32_bf16 v[100:103], v[208:211], v[196:199], v[100:103]
    v_mfma_f32_16x16x32_bf16 v[44:47], v[212:215], v[184:187], v[44:47]
    v_mfma_f32_16x16x32_bf16 v[64:67], v[212:215], v[188:191], v[64:67]
    v_mfma_f32_16x16x32_bf16 v[84:87], v[212:215], v[192:195], v[84:87]
    v_mfma_f32_16x16x32_bf16 v[104:107], v[212:215], v[196:199], v[104:107]
    v_mfma_f32_16x16x32_bf16 v[48:51], v[216:219], v[184:187], v[48:51]
    v_mfma_f32_16x16x32_bf16 v[68:71], v[216:219], v[188:191], v[68:71]
    v_mfma_f32_16x16x32_bf16 v[88:91], v[216:219], v[192:195], v[88:91]
    v_mfma_f32_16x16x32_bf16 v[108:111], v[216:219], v[196:199], v[108:111]
    s_waitcnt vmcnt(18)
    v_mfma_f32_16x16x32_bf16 v[32:35], v[236:239], v[220:223], v[32:35]
    v_mfma_f32_16x16x32_bf16 v[52:55], v[236:239], v[224:227], v[52:55]
    v_mfma_f32_16x16x32_bf16 v[72:75], v[236:239], v[228:231], v[72:75]
    v_mfma_f32_16x16x32_bf16 v[92:95], v[236:239], v[232:235], v[92:95]
    v_mfma_f32_16x16x32_bf16 v[36:39], v[240:243], v[220:223], v[36:39]
    v_mfma_f32_16x16x32_bf16 v[56:59], v[240:243], v[224:227], v[56:59]
    v_mfma_f32_16x16x32_bf16 v[76:79], v[240:243], v[228:231], v[76:79]
    v_mfma_f32_16x16x32_bf16 v[96:99], v[240:243], v[232:235], v[96:99]
    v_mfma_f32_16x16x32_bf16 v[40:43], v[244:247], v[220:223], v[40:43]
    v_mfma_f32_16x16x32_bf16 v[60:63], v[244:247], v[224:227], v[60:63]
    v_mfma_f32_16x16x32_bf16 v[80:83], v[244:247], v[228:231], v[80:83]
    v_mfma_f32_16x16x32_bf16 v[100:103], v[244:247], v[232:235], v[100:103]
    v_mfma_f32_16x16x32_bf16 v[44:47], v[248:251], v[220:223], v[44:47]
    v_mfma_f32_16x16x32_bf16 v[64:67], v[248:251], v[224:227], v[64:67]
    v_mfma_f32_16x16x32_bf16 v[84:87], v[248:251], v[228:231], v[84:87]
    v_mfma_f32_16x16x32_bf16 v[104:107], v[248:251], v[232:235], v[104:107]
    v_mfma_f32_16x16x32_bf16 v[48:51], v[252:255], v[220:223], v[48:51]
    v_mfma_f32_16x16x32_bf16 v[68:71], v[252:255], v[224:227], v[68:71]
    v_mfma_f32_16x16x32_bf16 v[88:91], v[252:255], v[228:231], v[88:91]
    v_mfma_f32_16x16x32_bf16 v[108:111], v[252:255], v[232:235], v[108:111]
    s_waitcnt vmcnt(9)
    v_mfma_f32_16x16x32_bf16 v[32:35], v[128:131], v[112:115], v[32:35]
    v_mfma_f32_16x16x32_bf16 v[52:55], v[128:131], v[116:119], v[52:55]
    v_mfma_f32_16x16x32_bf16 v[72:75], v[128:131], v[120:123], v[72:75]
    v_mfma_f32_16x16x32_bf16 v[92:95], v[128:131], v[124:127], v[92:95]
    v_mfma_f32_16x16x32_bf16 v[36:39], v[132:135], v[112:115], v[36:39]
    v_mfma_f32_16x16x32_bf16 v[56:59], v[132:135], v[116:119], v[56:59]
    v_mfma_f32_16x16x32_bf16 v[76:79], v[132:135], v[120:123], v[76:79]
    v_mfma_f32_16x16x32_bf16 v[96:99], v[132:135], v[124:127], v[96:99]
    v_mfma_f32_16x16x32_bf16 v[40:43], v[136:139], v[112:115], v[40:43]
    v_mfma_f32_16x16x32_bf16 v[60:63], v[136:139], v[116:119], v[60:63]
    v_mfma_f32_16x16x32_bf16 v[80:83], v[136:139], v[120:123], v[80:83]
    v_mfma_f32_16x16x32_bf16 v[100:103], v[136:139], v[124:127], v[100:103]
    v_mfma_f32_16x16x32_bf16 v[44:47], v[140:143], v[112:115], v[44:47]
    v_mfma_f32_16x16x32_bf16 v[64:67], v[140:143], v[116:119], v[64:67]
    v_mfma_f32_16x16x32_bf16 v[84:87], v[140:143], v[120:123], v[84:87]
    v_mfma_f32_16x16x32_bf16 v[104:107], v[140:143], v[124:127], v[104:107]
    v_mfma_f32_16x16x32_bf16 v[48:51], v[144:147], v[112:115], v[48:51]
    v_mfma_f32_16x16x32_bf16 v[68:71], v[144:147], v[116:119], v[68:71]
    v_mfma_f32_16x16x32_bf16 v[88:91], v[144:147], v[120:123], v[88:91]
    v_mfma_f32_16x16x32_bf16 v[108:111], v[144:147], v[124:127], v[108:111]
    s_waitcnt vmcnt(0)
    v_mfma_f32_16x16x32_bf16 v[32:35], v[164:167], v[148:151], v[32:35]
    v_mfma_f32_16x16x32_bf16 v[52:55], v[164:167], v[152:155], v[52:55]
    v_mfma_f32_16x16x32_bf16 v[72:75], v[164:167], v[156:159], v[72:75]
    v_mfma_f32_16x16x32_bf16 v[92:95], v[164:167], v[160:163], v[92:95]
    v_mfma_f32_16x16x32_bf16 v[36:39], v[168:171], v[148:151], v[36:39]
    v_mfma_f32_16x16x32_bf16 v[56:59], v[168:171], v[152:155], v[56:59]
    v_mfma_f32_16x16x32_bf16 v[76:79], v[168:171], v[156:159], v[76:79]
    v_mfma_f32_16x16x32_bf16 v[96:99], v[168:171], v[160:163], v[96:99]
    v_mfma_f32_16x16x32_bf16 v[40:43], v[172:175], v[148:151], v[40:43]
    v_mfma_f32_16x16x32_bf16 v[60:63], v[172:175], v[152:155], v[60:63]
    v_mfma_f32_16x16x32_bf16 v[80:83], v[172:175], v[156:159], v[80:83]
    v_mfma_f32_16x16x32_bf16 v[100:103], v[172:175], v[160:163], v[100:103]
    v_mfma_f32_16x16x32_bf16 v[44:47], v[176:179], v[148:151], v[44:47]
    v_mfma_f32_16x16x32_bf16 v[64:67], v[176:179], v[152:155], v[64:67]
    v_mfma_f32_16x16x32_bf16 v[84:87], v[176:179], v[156:159], v[84:87]
    v_mfma_f32_16x16x32_bf16 v[104:107], v[176:179], v[160:163], v[104:107]
    v_mfma_f32_16x16x32_bf16 v[48:51], v[180:183], v[148:151], v[48:51]
    v_mfma_f32_16x16x32_bf16 v[68:71], v[180:183], v[152:155], v[68:71]
    v_mfma_f32_16x16x32_bf16 v[88:91], v[180:183], v[156:159], v[88:91]
    v_mfma_f32_16x16x32_bf16 v[108:111], v[180:183], v[160:163], v[108:111]
    s_branch L_g2_red
L_g2_h:
    buffer_load_dwordx4 v[112:115], v10, s[12:15], s47 offen
    buffer_load_dwordx4 v[116:119], v11, s[12:15], s47 offen
    buffer_load_dwordx4 v[120:123], v12, s[12:15], s47 offen
    buffer_load_dwordx4 v[124:127], v13, s[12:15], s47 offen
    buffer_load_dwordx4 v[128:131], v5, s[12:15], s48 offen offset:0
    buffer_load_dwordx4 v[132:135], v5, s[12:15], s48 offen offset:1024
    buffer_load_dwordx4 v[136:139], v5, s[12:15], s48 offen offset:2048
    buffer_load_dwordx4 v[140:143], v5, s[12:15], s48 offen offset:3072
    buffer_load_dwordx4 v[144:147], v14, s[12:15], s48 offen
    s_add_u32 s47, s47, 1024
    s_add_u32 s48, s48, 5120
    buffer_load_dwordx4 v[148:151], v10, s[12:15], s47 offen
    buffer_load_dwordx4 v[152:155], v11, s[12:15], s47 offen
    buffer_load_dwordx4 v[156:159], v12, s[12:15], s47 offen
    buffer_load_dwordx4 v[160:163], v13, s[12:15], s47 offen
    buffer_load_dwordx4 v[164:167], v5, s[12:15], s48 offen offset:0
    buffer_load_dwordx4 v[168:171], v5, s[12:15], s48 offen offset:1024
    buffer_load_dwordx4 v[172:175], v5, s[12:15], s48 offen offset:2048
    buffer_load_dwordx4 v[176:179], v5, s[12:15], s48 offen offset:3072
    buffer_load_dwordx4 v[180:183], v14, s[12:15], s48 offen
    s_add_u32 s47, s47, 1024
    s_add_u32 s48, s48, 5120
    buffer_load_dwordx4 v[184:187], v10, s[12:15], s47 offen
    buffer_load_dwordx4 v[188:191], v11, s[12:15], s47 offen
    buffer_load_dwordx4 v[192:195], v12, s[12:15], s47 offen
    buffer_load_dwordx4 v[196:199], v13, s[12:15], s47 offen
    buffer_load_dwordx4 v[200:203], v5, s[12:15], s48 offen offset:0
    buffer_load_dwordx4 v[204:207], v5, s[12:15], s48 offen offset:1024
    buffer_load_dwordx4 v[208:211], v5, s[12:15], s48 offen offset:2048
    buffer_load_dwordx4 v[212:215], v5, s[12:15], s48 offen offset:3072
    buffer_load_dwordx4 v[216:219], v14, s[12:15], s48 offen
    s_add_u32 s47, s47, 1024
    s_add_u32 s48, s48, 5120
    buffer_load_dwordx4 v[220:223], v10, s[12:15], s47 offen
    buffer_load_dwordx4 v[224:227], v11, s[12:15], s47 offen
    buffer_load_dwordx4 v[228:231], v12, s[12:15], s47 offen
    buffer_load_dwordx4 v[232:235], v13, s[12:15], s47 offen
    buffer_load_dwordx4 v[236:239], v5, s[12:15], s48 offen offset:0
    buffer_load_dwordx4 v[240:243], v5, s[12:15], s48 offen offset:1024
    buffer_load_dwordx4 v[244:247], v5, s[12:15], s48 offen offset:2048
    buffer_load_dwordx4 v[248:251], v5, s[12:15], s48 offen offset:3072
    buffer_load_dwordx4 v[252:255], v14, s[12:15], s48 offen
    s_add_u32 s47, s47, 1024
    s_add_u32 s48, s48, 5120
    s_waitcnt vmcnt(27)
    v_mfma_f32_16x16x32_bf16 v[32:35], v[128:131], v[112:115], 0
    v_mfma_f32_16x16x32_bf16 v[52:55], v[128:131], v[116:119], 0
    v_mfma_f32_16x16x32_bf16 v[72:75], v[128:131], v[120:123], 0
    v_mfma_f32_16x16x32_bf16 v[92:95], v[128:131], v[124:127], 0
    v_mfma_f32_16x16x32_bf16 v[36:39], v[132:135], v[112:115], 0
    v_mfma_f32_16x16x32_bf16 v[56:59], v[132:135], v[116:119], 0
    v_mfma_f32_16x16x32_bf16 v[76:79], v[132:135], v[120:123], 0
    v_mfma_f32_16x16x32_bf16 v[96:99], v[132:135], v[124:127], 0
    v_mfma_f32_16x16x32_bf16 v[40:43], v[136:139], v[112:115], 0
    v_mfma_f32_16x16x32_bf16 v[60:63], v[136:139], v[116:119], 0
    v_mfma_f32_16x16x32_bf16 v[80:83], v[136:139], v[120:123], 0
    v_mfma_f32_16x16x32_bf16 v[100:103], v[136:139], v[124:127], 0
    v_mfma_f32_16x16x32_bf16 v[44:47], v[140:143], v[112:115], 0
    v_mfma_f32_16x16x32_bf16 v[64:67], v[140:143], v[116:119], 0
    v_mfma_f32_16x16x32_bf16 v[84:87], v[140:143], v[120:123], 0
    v_mfma_f32_16x16x32_bf16 v[104:107], v[140:143], v[124:127], 0
    v_mfma_f32_16x16x32_bf16 v[48:51], v[144:147], v[112:115], 0
    v_mfma_f32_16x16x32_bf16 v[68:71], v[144:147], v[116:119], 0
    v_mfma_f32_16x16x32_bf16 v[88:91], v[144:147], v[120:123], 0
    v_mfma_f32_16x16x32_bf16 v[108:111], v[144:147], v[124:127], 0
    buffer_load_dwordx4 v[112:115], v10, s[12:15], s47 offen
    buffer_load_dwordx4 v[116:119], v11, s[12:15], s47 offen
    buffer_load_dwordx4 v[120:123], v12, s[12:15], s47 offen
    buffer_load_dwordx4 v[124:127], v13, s[12:15], s47 offen
    buffer_load_dwordx4 v[128:131], v5, s[12:15], s48 offen offset:0
    buffer_load_dwordx4 v[132:135], v5, s[12:15], s48 offen offset:1024
    buffer_load_dwordx4 v[136:139], v5, s[12:15], s48 offen offset:2048
    buffer_load_dwordx4 v[140:143], v5, s[12:15], s48 offen offset:3072
    buffer_load_dwordx4 v[144:147], v14, s[12:15], s48 offen
    s_add_u32 s47, s47, 1024
    s_add_u32 s48, s48, 5120
    s_waitcnt vmcnt(27)
    v_mfma_f32_16x16x32_bf16 v[32:35], v[164:167], v[148:151], v[32:35]
    v_mfma_f32_16x16x32_bf16 v[52:55], v[164:167], v[152:155], v[52:55]
    v_mfma_f32_16x16x32_bf16 v[72:75], v[164:167], v[156:159], v[72:75]
    v_mfma_f32_16x16x32_bf16 v[92:95], v[164:167], v[160:163], v[92:95]
    v_mfma_f32_16x16x32_bf16 v[36:39], v[168:171], v[148:151], v[36:39]
    v_mfma_f32_16x16x32_bf16 v[56:59], v[168:171], v[152:155], v[56:59]
    v_mfma_f32_16x16x32_bf16 v[76:79], v[168:171], v[156:159], v[76:79]
    v_mfma_f32_16x16x32_bf16 v[96:99], v[168:171], v[160:163], v[96:99]
    v_mfma_f32_16x16x32_bf16 v[40:43], v[172:175], v[148:151], v[40:43]
    v_mfma_f32_16x16x32_bf16 v[60:63], v[172:175], v[152:155], v[60:63]
    v_mfma_f32_16x16x32_bf16 v[80:83], v[172:175], v[156:159], v[80:83]
    v_mfma_f32_16x16x32_bf16 v[100:103], v[172:175], v[160:163], v[100:103]
    v_mfma_f32_16x16x32_bf16 v[44:47], v[176:179], v[148:151], v[44:47]
    v_mfma_f32_16x16x32_bf16 v[64:67], v[176:179], v[152:155], v[64:67]
    v_mfma_f32_16x16x32_bf16 v[84:87], v[176:179], v[156:159], v[84:87]
    v_mfma_f32_16x16x32_bf16 v[104:107], v[176:179], v[160:163], v[104:107]
    v_mfma_f32_16x16x32_bf16 v[48:51], v[180:183], v[148:151], v[48:51]
    v_mfma_f32_16x16x32_bf16 v[68:71], v[180:183], v[152:155], v[68:71]
    v_mfma_f32_16x16x32_bf16 v[88:91], v[180:183], v[156:159], v[88:91]
    v_mfma_f32_16x16x32_bf16 v[108:111], v[180:183], v[160:163], v[108:111]
    buffer_load_dwordx4 v[148:151], v10, s[12:15], s47 offen
    buffer_load_dwordx4 v[152:155], v11, s[12:15], s47 offen
    buffer_load_dwordx4 v[156:159], v12, s[12:15], s47 offen
    buffer_load_dwordx4 v[160:163], v13, s[12:15], s47 offen
    buffer_load_dwordx4 v[164:167], v5, s[12:15], s48 offen offset:0
    buffer_load_dwordx4 v[168:171], v5, s[12:15], s48 offen offset:1024
    buffer_load_dwordx4 v[172:175], v5, s[12:15], s48 offen offset:2048
    buffer_load_dwordx4 v[176:179], v5, s[12:15], s48 offen offset:3072
    buffer_load_dwordx4 v[180:183], v14, s[12:15], s48 offen
    s_add_u32 s47, s47, 1024
    s_add_u32 s48, s48, 5120
    s_waitcnt vmcnt(27)
    v_mfma_f32_16x16x32_bf16 v[32:35], v[200:203], v[184:187], v[32:35]
    v_mfma_f32_16x16x32_bf16 v[52:55], v[200:203], v[188:191], v[52:55]
    v_mfma_f32_16x16x32_bf16 v[72:75], v[200:203], v[192:195], v[72:75]
    v_mfma_f32_16x16x32_bf16 v[92:95], v[200:203], v[196:199], v[92:95]
    v_mfma_f32_16x16x32_bf16 v[36:39], v[204:207], v[184:187], v[36:39]
    v_mfma_f32_16x16x32_bf16 v[56:59], v[204:207], v[188:191], v[56:59]
    v_mfma_f32_16x16x32_bf16 v[76:79], v[204:207], v[192:195], v[76:79]
    v_mfma_f32_16x16x32_bf16 v[96:99], v[204:207], v[196:199], v[96:99]
    v_mfma_f32_16x16x32_bf16 v[40:43], v[208:211], v[184:187], v[40:43]
    v_mfma_f32_16x16x32_bf16 v[60:63], v[208:211], v[188:191], v[60:63]
    v_mfma_f32_16x16x32_bf16 v[80:83], v[208:211], v[192:195], v[80:83]
    v_mfma_f32_16x16x32_bf16 v[100:103], v[208:211], v[196:199], v[100:103]
    v_mfma_f32_16x16x32_bf16 v[44:47], v[212:215], v[184:187], v[44:47]
    v_mfma_f32_16x16x32_bf16 v[64:67], v[212:215], v[188:191], v[64:67]
    v_mfma_f32_16x16x32_bf16 v[84:87], v[212:215], v[192:195], v[84:87]
    v_mfma_f32_16x16x32_bf16 v[104:107], v[212:215], v[196:199], v[104:107]
    v_mfma_f32_16x16x32_bf16 v[48:51], v[216:219], v[184:187], v[48:51]
    v_mfma_f32_16x16x32_bf16 v[68:71], v[216:219], v[188:191], v[68:71]
    v_mfma_f32_16x16x32_bf16 v[88:91], v[216:219], v[192:195], v[88:91]
    v_mfma_f32_16x16x32_bf16 v[108:111], v[216:219], v[196:199], v[108:111]
    buffer_load_dwordx4 v[184:187], v10, s[12:15], s47 offen
    buffer_load_dwordx4 v[188:191], v11, s[12:15], s47 offen
    buffer_load_dwordx4 v[192:195], v12, s[12:15], s47 offen
    buffer_load_dwordx4 v[196:199], v13, s[12:15], s47 offen
    buffer_load_dwordx4 v[200:203], v5, s[12:15], s48 offen offset:0
    buffer_load_dwordx4 v[204:207], v5, s[12:15], s48 offen offset:1024
    buffer_load_dwordx4 v[208:211], v5, s[12:15], s48 offen offset:2048
    buffer_load_dwordx4 v[212:215], v5, s[12:15], s48 offen offset:3072
    buffer_load_dwordx4 v[216:219], v14, s[12:15], s48 offen
    s_add_u32 s47, s47, 1024
    s_add_u32 s48, s48, 5120
    s_waitcnt vmcnt(27)
    v_mfma_f32_16x16x32_bf16 v[32:35], v[236:239], v[220:223], v[32:35]
    v_mfma_f32_16x16x32_bf16 v[52:55], v[236:239], v[224:227], v[52:55]
    v_mfma_f32_16x16x32_bf16 v[72:75], v[236:239], v[228:231], v[72:75]
    v_mfma_f32_16x16x32_bf16 v[92:95], v[236:239], v[232:235], v[92:95]
    v_mfma_f32_16x16x32_bf16 v[36:39], v[240:243], v[220:223], v[36:39]
    v_mfma_f32_16x16x32_bf16 v[56:59], v[240:243], v[224:227], v[56:59]
    v_mfma_f32_16x16x32_bf16 v[76:79], v[240:243], v[228:231], v[76:79]
    v_mfma_f32_16x16x32_bf16 v[96:99], v[240:243], v[232:235], v[96:99]
    v_mfma_f32_16x16x32_bf16 v[40:43], v[244:247], v[220:223], v[40:43]
    v_mfma_f32_16x16x32_bf16 v[60:63], v[244:247], v[224:227], v[60:63]
    v_mfma_f32_16x16x32_bf16 v[80:83], v[244:247], v[228:231], v[80:83]
    v_mfma_f32_16x16x32_bf16 v[100:103], v[244:247], v[232:235], v[100:103]
    v_mfma_f32_16x16x32_bf16 v[44:47], v[248:251], v[220:223], v[44:47]
    v_mfma_f32_16x16x32_bf16 v[64:67], v[248:251], v[224:227], v[64:67]
    v_mfma_f32_16x16x32_bf16 v[84:87], v[248:251], v[228:231], v[84:87]
    v_mfma_f32_16x16x32_bf16 v[104:107], v[248:251], v[232:235], v[104:107]
    v_mfma_f32_16x16x32_bf16 v[48:51], v[252:255], v[220:223], v[48:51]
    v_mfma_f32_16x16x32_bf16 v[68:71], v[252:255], v[224:227], v[68:71]
    v_mfma_f32_16x16x32_bf16 v[88:91], v[252:255], v[228:231], v[88:91]
    v_mfma_f32_16x16x32_bf16 v[108:111], v[252:255], v[232:235], v[108:111]
    buffer_load_dwordx4 v[220:223], v10, s[12:15], s47 offen
    buffer_load_dwordx4 v[224:227], v11, s[12:15], s47 offen
    buffer_load_dwordx4 v[228:231], v12, s[12:15], s47 offen
    buffer_load_dwordx4 v[232:235], v13, s[12:15], s47 offen
    buffer_load_dwordx4 v[236:239], v5, s[12:15], s48 offen offset:0
    buffer_load_dwordx4 v[240:243], v5, s[12:15], s48 offen offset:1024
    buffer_load_dwordx4 v[244:247], v5, s[12:15], s48 offen offset:2048
    buffer_load_dwordx4 v[248:251], v5, s[12:15], s48 offen offset:3072
    buffer_load_dwordx4 v[252:255], v14, s[12:15], s48 offen
    s_add_u32 s47, s47, 1024
    s_add_u32 s48, s48, 5120
    s_waitcnt vmcnt(27)
    v_mfma_f32_16x16x32_bf16 v[32:35], v[128:131], v[112:115], v[32:35]
    v_mfma_f32_16x16x32_bf16 v[52:55], v[128:131], v[116:119], v[52:55]
    v_mfma_f32_16x16x32_bf16 v[72:75], v[128:131], v[120:123], v[72:75]
    v_mfma_f32_16x16x32_bf16 v[92:95], v[128:131], v[124:127], v[92:95]
    v_mfma_f32_16x16x32_bf16 v[36:39], v[132:135], v[112:115], v[36:39]
    v_mfma_f32_16x16x32_bf16 v[56:59], v[132:135], v[116:119], v[56:59]
    v_mfma_f32_16x16x32_bf16 v[76:79], v[132:135], v[120:123], v[76:79]
    v_mfma_f32_16x16x32_bf16 v[96:99], v[132:135], v[124:127], v[96:99]
    v_mfma_f32_16x16x32_bf16 v[40:43], v[136:139], v[112:115], v[40:43]
    v_mfma_f32_16x16x32_bf16 v[60:63], v[136:139], v[116:119], v[60:63]
    v_mfma_f32_16x16x32_bf16 v[80:83], v[136:139], v[120:123], v[80:83]
    v_mfma_f32_16x16x32_bf16 v[100:103], v[136:139], v[124:127], v[100:103]
    v_mfma_f32_16x16x32_bf16 v[44:47], v[140:143], v[112:115], v[44:47]
    v_mfma_f32_16x16x32_bf16 v[64:67], v[140:143], v[116:119], v[64:67]
    v_mfma_f32_16x16x32_bf16 v[84:87], v[140:143], v[120:123], v[84:87]
    v_mfma_f32_16x16x32_bf16 v[104:107], v[140:143], v[124:127], v[104:107]
    v_mfma_f32_16x16x32_bf16 v[48:51], v[144:147], v[112:115], v[48:51]
    v_mfma_f32_16x16x32_bf16 v[68:71], v[144:147], v[116:119], v[68:71]
    v_mfma_f32_16x16x32_bf16 v[88:91], v[144:147], v[120:123], v[88:91]
    v_mfma_f32_16x16x32_bf16 v[108:111], v[144:147], v[124:127], v[108:111]
    s_waitcnt vmcnt(18)
    v_mfma_f32_16x16x32_bf16 v[32:35], v[164:167], v[148:151], v[32:35]
    v_mfma_f32_16x16x32_bf16 v[52:55], v[164:167], v[152:155], v[52:55]
    v_mfma_f32_16x16x32_bf16 v[72:75], v[164:167], v[156:159], v[72:75]
    v_mfma_f32_16x16x32_bf16 v[92:95], v[164:167], v[160:163], v[92:95]
    v_mfma_f32_16x16x32_bf16 v[36:39], v[168:171], v[148:151], v[36:39]
    v_mfma_f32_16x16x32_bf16 v[56:59], v[168:171], v[152:155], v[56:59]
    v_mfma_f32_16x16x32_bf16 v[76:79], v[168:171], v[156:159], v[76:79]
    v_mfma_f32_16x16x32_bf16 v[96:99], v[168:171], v[160:163], v[96:99]
    v_mfma_f32_16x16x32_bf16 v[40:43], v[172:175], v[148:151], v[40:43]
    v_mfma_f32_16x16x32_bf16 v[60:63], v[172:175], v[152:155], v[60:63]
    v_mfma_f32_16x16x32_bf16 v[80:83], v[172:175], v[156:159], v[80:83]
    v_mfma_f32_16x16x32_bf16 v[100:103], v[172:175], v[160:163], v[100:103]
    v_mfma_f32_16x16x32_bf16 v[44:47], v[176:179], v[148:151], v[44:47]
    v_mfma_f32_16x16x32_bf16 v[64:67], v[176:179], v[152:155], v[64:67]
    v_mfma_f32_16x16x32_bf16 v[84:87], v[176:179], v[156:159], v[84:87]
    v_mfma_f32_16x16x32_bf16 v[104:107], v[176:179], v[160:163], v[104:107]
    v_mfma_f32_16x16x32_bf16 v[48:51], v[180:183], v[148:151], v[48:51]
    v_mfma_f32_16x16x32_bf16 v[68:71], v[180:183], v[152:155], v[68:71]
    v_mfma_f32_16x16x32_bf16 v[88:91], v[180:183], v[156:159], v[88:91]
    v_mfma_f32_16x16x32_bf16 v[108:111], v[180:183], v[160:163], v[108:111]
    s_waitcnt vmcnt(9)
    v_mfma_f32_16x16x32_bf16 v[32:35], v[200:203], v[184:187], v[32:35]
    v_mfma_f32_16x16x32_bf16 v[52:55], v[200:203], v[188:191], v[52:55]
    v_mfma_f32_16x16x32_bf16 v[72:75], v[200:203], v[192:195], v[72:75]
    v_mfma_f32_16x16x32_bf16 v[92:95], v[200:203], v[196:199], v[92:95]
    v_mfma_f32_16x16x32_bf16 v[36:39], v[204:207], v[184:187], v[36:39]
    v_mfma_f32_16x16x32_bf16 v[56:59], v[204:207], v[188:191], v[56:59]
    v_mfma_f32_16x16x32_bf16 v[76:79], v[204:207], v[192:195], v[76:79]
    v_mfma_f32_16x16x32_bf16 v[96:99], v[204:207], v[196:199], v[96:99]
    v_mfma_f32_16x16x32_bf16 v[40:43], v[208:211], v[184:187], v[40:43]
    v_mfma_f32_16x16x32_bf16 v[60:63], v[208:211], v[188:191], v[60:63]
    v_mfma_f32_16x16x32_bf16 v[80:83], v[208:211], v[192:195], v[80:83]
    v_mfma_f32_16x16x32_bf16 v[100:103], v[208:211], v[196:199], v[100:103]
    v_mfma_f32_16x16x32_bf16 v[44:47], v[212:215], v[184:187], v[44:47]
    v_mfma_f32_16x16x32_bf16 v[64:67], v[212:215], v[188:191], v[64:67]
    v_mfma_f32_16x16x32_bf16 v[84:87], v[212:215], v[192:195], v[84:87]
    v_mfma_f32_16x16x32_bf16 v[104:107], v[212:215], v[196:199], v[104:107]
    v_mfma_f32_16x16x32_bf16 v[48:51], v[216:219], v[184:187], v[48:51]
    v_mfma_f32_16x16x32_bf16 v[68:71], v[216:219], v[188:191], v[68:71]
    v_mfma_f32_16x16x32_bf16 v[88:91], v[216:219], v[192:195], v[88:91]
    v_mfma_f32_16x16x32_bf16 v[108:111], v[216:219], v[196:199], v[108:111]
    s_waitcnt vmcnt(0)
    v_mfma_f32_16x16x32_bf16 v[32:35], v[236:239], v[220:223], v[32:35]
    v_mfma_f32_16x16x32_bf16 v[52:55], v[236:239], v[224:227], v[52:55]
    v_mfma_f32_16x16x32_bf16 v[72:75], v[236:239], v[228:231], v[72:75]
    v_mfma_f32_16x16x32_bf16 v[92:95], v[236:239], v[232:235], v[92:95]
    v_mfma_f32_16x16x32_bf16 v[36:39], v[240:243], v[220:223], v[36:39]
    v_mfma_f32_16x16x32_bf16 v[56:59], v[240:243], v[224:227], v[56:59]
    v_mfma_f32_16x16x32_bf16 v[76:79], v[240:243], v[228:231], v[76:79]
    v_mfma_f32_16x16x32_bf16 v[96:99], v[240:243], v[232:235], v[96:99]
    v_mfma_f32_16x16x32_bf16 v[40:43], v[244:247], v[220:223], v[40:43]
    v_mfma_f32_16x16x32_bf16 v[60:63], v[244:247], v[224:227], v[60:63]
    v_mfma_f32_16x16x32_bf16 v[80:83], v[244:247], v[228:231], v[80:83]
    v_mfma_f32_16x16x32_bf16 v[100:103], v[244:247], v[232:235], v[100:103]
    v_mfma_f32_16x16x32_bf16 v[44:47], v[248:251], v[220:223], v[44:47]
    v_mfma_f32_16x16x32_bf16 v[64:67], v[248:251], v[224:227], v[64:67]
    v_mfma_f32_16x16x32_bf16 v[84:87], v[248:251], v[228:231], v[84:87]
    v_mfma_f32_16x16x32_bf16 v[104:107], v[248:251], v[232:235], v[104:107]
    v_mfma_f32_16x16x32_bf16 v[48:51], v[252:255], v[220:223], v[48:51]
    v_mfma_f32_16x16x32_bf16 v[68:71], v[252:255], v[224:227], v[68:71]
    v_mfma_f32_16x16x32_bf16 v[88:91], v[252:255], v[228:231], v[88:91]
    v_mfma_f32_16x16x32_bf16 v[108:111], v[252:255], v[232:235], v[108:111]
L_g2_red:
    s_add_u32 s40, s32, 0
    s_min_u32 s40, s40, 19
    s_mul_i32 s41, s40, 52
    s_lshr_b32 s41, s41, 8
    s_mul_i32 s43, s41, 5
    s_sub_u32 s43, s40, s43
    s_lshl_b32 s44, s33, 6
    s_lshl_b32 s41, s41, 4
    s_add_u32 s44, s44, s41
    v_and_b32 v21, 15, v0
    v_add_u32 v21, s44, v21
    v_mul_u32_u24 v21, 1280, v21
    v_lshl_add_u32 v21, v2, 3, v21
    s_lshl_b32 s43, s43, 5
    s_add_u32 s43, s43, s45
    v_add_u32 v112, s43, v21
    buffer_load_dwordx2 v[116:117], v112, s[20:23], 0 offen
    s_add_u32 s40, s32, 8
    s_min_u32 s40, s40, 19
    s_mul_i32 s41, s40, 52
    s_lshr_b32 s41, s41, 8
    s_mul_i32 s43, s41, 5
    s_sub_u32 s43, s40, s43
    s_lshl_b32 s44, s33, 6
    s_lshl_b32 s41, s41, 4
    s_add_u32 s44, s44, s41
    v_and_b32 v21, 15, v0
    v_add_u32 v21, s44, v21
    v_mul_u32_u24 v21, 1280, v21
    v_lshl_add_u32 v21, v2, 3, v21
    s_lshl_b32 s43, s43, 5
    s_add_u32 s43, s43, s45
    v_add_u32 v113, s43, v21
    buffer_load_dwordx2 v[118:119], v113, s[20:23], 0 offen
    s_add_u32 s40, s32, 16
    s_min_u32 s40, s40, 19
    s_mul_i32 s41, s40, 52
    s_lshr_b32 s41, s41, 8
    s_mul_i32 s43, s41, 5
    s_sub_u32 s43, s40, s43
    s_lshl_b32 s44, s33, 6
    s_lshl_b32 s41, s41, 4
    s_add_u32 s44, s44, s41
    v_and_b32 v21, 15, v0
    v_add_u32 v21, s44, v21
    v_mul_u32_u24 v21, 1280, v21
    v_lshl_add_u32 v21, v2, 3, v21
    s_lshl_b32 s43, s43, 5
    s_add_u32 s43, s43, s45
    v_add_u32 v114, s43, v21
    buffer_load_dwordx2 v[120:121], v114, s[20:23], 0 offen
    v_add_u32 v20, s42, v5
    ds_write_b128 v20, v[32:35] offset:0
    ds_write_b128 v20, v[36:39] offset:1024
    ds_write_b128 v20, v[40:43] offset:2048
    ds_write_b128 v20, v[44:47] offset:3072
    ds_write_b128 v20, v[48:51] offset:4096
    ds_write_b128 v20, v[52:55] offset:5120
    ds_write_b128 v20, v[56:59] offset:6144
    ds_write_b128 v20, v[60:63] offset:7168
    ds_write_b128 v20, v[64:67] offset:8192
    ds_write_b128 v20, v[68:71] offset:9216
    ds_write_b128 v20, v[72:75] offset:10240
    ds_write_b128 v20, v[76:79] offset:11264
    ds_write_b128 v20, v[80:83] offset:12288
    ds_write_b128 v20, v[84:87] offset:13312
    ds_write_b128 v20, v[88:91] offset:14336
    ds_write_b128 v20, v[92:95] offset:15360
    ds_write_b128 v20, v[96:99] offset:16384
    ds_write_b128 v20, v[100:103] offset:17408
    ds_write_b128 v20, v[104:107] offset:18432
    ds_write_b128 v20, v[108:111] offset:19456
    s_waitcnt lgkmcnt(0)
    s_barrier
    s_mov_b32 s16, 0xffff0000
    s_lshl_b32 s40, s32, 10
    v_add_u32 v20, s40, v5
    v_add_u32 v21, 40960, v20
    v_add_u32 v22, 81920, v20
    v_add_u32 v23, 122880, v20
    ds_read_b128 v[128:131], v20 offset:0
    ds_read_b128 v[132:135], v20 offset:20480
    ds_read_b128 v[136:139], v21 offset:0
    ds_read_b128 v[140:143], v21 offset:20480
    ds_read_b128 v[144:147], v22 offset:0
    ds_read_b128 v[148:151], v22 offset:20480
    ds_read_b128 v[152:155], v23 offset:0
    ds_read_b128 v[156:159], v23 offset:20480
    ds_read_b128 v[160:163], v20 offset:8192
    ds_read_b128 v[164:167], v20 offset:28672
    ds_read_b128 v[168:171], v21 offset:8192
    ds_read_b128 v[172:175], v21 offset:28672
    ds_read_b128 v[176:179], v22 offset:8192
    ds_read_b128 v[180:183], v22 offset:28672
    ds_read_b128 v[184:187], v23 offset:8192
    ds_read_b128 v[188:191], v23 offset:28672
    s_cmp_ge_u32 s32, 4
    s_cbranch_scc1 L_g2_r2skip
    ds_read_b128 v[192:195], v20 offset:16384
    ds_read_b128 v[196:199], v20 offset:36864
    ds_read_b128 v[200:203], v21 offset:16384
    ds_read_b128 v[204:207], v21 offset:36864
    ds_read_b128 v[208:211], v22 offset:16384
    ds_read_b128 v[212:215], v22 offset:36864
    ds_read_b128 v[216:219], v23 offset:16384
    ds_read_b128 v[220:223], v23 offset:36864
L_g2_r2skip:
    s_waitcnt vmcnt(0) lgkmcnt(0)
    v_pk_add_f32 v[128:129], v[128:129], v[132:133]
    v_pk_add_f32 v[136:137], v[136:137], v[140:141]
    v_pk_add_f32 v[144:145], v[144:145], v[148:149]
    v_pk_add_f32 v[152:153], v[152:153], v[156:157]
    v_pk_add_f32 v[136:137], v[136:137], v[144:145]
    v_pk_add_f32 v[136:137], v[136:137], v[152:153]
    v_pk_add_f32 v[130:131], v[130:131], v[134:135]
    v_pk_add_f32 v[138:139], v[138:139], v[142:143]
    v_pk_add_f32 v[146:147], v[146:147], v[150:151]
    v_pk_add_f32 v[154:155], v[154:155], v[158:159]
    v_pk_add_f32 v[138:139], v[138:139], v[146:147]
    v_pk_add_f32 v[138:139], v[138:139], v[154:155]
    v_cvt_pk_bf16_f32 v25, v128, v129
    v_cvt_pk_bf16_f32 v26, v136, v137
    v_lshlrev_b32 v128, 16, v25
    v_and_b32 v129, s16, v25
    v_lshlrev_b32 v136, 16, v26
    v_and_b32 v137, s16, v26
    v_lshlrev_b32 v26, 16, v116
    v_and_b32 v27, s16, v116
    v_pk_add_f32 v[128:129], v[128:129], v[26:27]
    v_cvt_pk_bf16_f32 v25, v128, v129
    v_lshlrev_b32 v128, 16, v25
    v_and_b32 v129, s16, v25
    v_pk_add_f32 v[128:129], v[128:129], v[136:137]
    v_cvt_pk_bf16_f32 v144, v128, v129
    v_cvt_pk_bf16_f32 v25, v130, v131
    v_cvt_pk_bf16_f32 v26, v138, v139
    v_lshlrev_b32 v130, 16, v25
    v_and_b32 v131, s16, v25
    v_lshlrev_b32 v138, 16, v26
    v_and_b32 v139, s16, v26
    v_lshlrev_b32 v26, 16, v117
    v_and_b32 v27, s16, v117
    v_pk_add_f32 v[130:131], v[130:131], v[26:27]
    v_cvt_pk_bf16_f32 v25, v130, v131
    v_lshlrev_b32 v130, 16, v25
    v_and_b32 v131, s16, v25
    v_pk_add_f32 v[130:131], v[130:131], v[138:139]
    v_cvt_pk_bf16_f32 v145, v130, v131
    buffer_store_dwordx2 v[144:145], v112, s[24:27], 0 offen
    v_pk_add_f32 v[160:161], v[160:161], v[164:165]
    v_pk_add_f32 v[168:169], v[168:169], v[172:173]
    v_pk_add_f32 v[176:177], v[176:177], v[180:181]
    v_pk_add_f32 v[184:185], v[184:185], v[188:189]
    v_pk_add_f32 v[168:169], v[168:169], v[176:177]
    v_pk_add_f32 v[168:169], v[168:169], v[184:185]
    v_pk_add_f32 v[162:163], v[162:163], v[166:167]
    v_pk_add_f32 v[170:171], v[170:171], v[174:175]
    v_pk_add_f32 v[178:179], v[178:179], v[182:183]
    v_pk_add_f32 v[186:187], v[186:187], v[190:191]
    v_pk_add_f32 v[170:171], v[170:171], v[178:179]
    v_pk_add_f32 v[170:171], v[170:171], v[186:187]
    v_cvt_pk_bf16_f32 v25, v160, v161
    v_cvt_pk_bf16_f32 v26, v168, v169
    v_lshlrev_b32 v160, 16, v25
    v_and_b32 v161, s16, v25
    v_lshlrev_b32 v168, 16, v26
    v_and_b32 v169, s16, v26
    v_lshlrev_b32 v26, 16, v118
    v_and_b32 v27, s16, v118
    v_pk_add_f32 v[160:161], v[160:161], v[26:27]
    v_cvt_pk_bf16_f32 v25, v160, v161
    v_lshlrev_b32 v160, 16, v25
    v_and_b32 v161, s16, v25
    v_pk_add_f32 v[160:161], v[160:161], v[168:169]
    v_cvt_pk_bf16_f32 v176, v160, v161
    v_cvt_pk_bf16_f32 v25, v162, v163
    v_cvt_pk_bf16_f32 v26, v170, v171
    v_lshlrev_b32 v162, 16, v25
    v_and_b32 v163, s16, v25
    v_lshlrev_b32 v170, 16, v26
    v_and_b32 v171, s16, v26
    v_lshlrev_b32 v26, 16, v119
    v_and_b32 v27, s16, v119
    v_pk_add_f32 v[162:163], v[162:163], v[26:27]
    v_cvt_pk_bf16_f32 v25, v162, v163
    v_lshlrev_b32 v162, 16, v25
    v_and_b32 v163, s16, v25
    v_pk_add_f32 v[162:163], v[162:163], v[170:171]
    v_cvt_pk_bf16_f32 v177, v162, v163
    buffer_store_dwordx2 v[176:177], v113, s[24:27], 0 offen
    s_cmp_ge_u32 s32, 4
    s_cbranch_scc1 L_g2_done
    v_pk_add_f32 v[192:193], v[192:193], v[196:197]
    v_pk_add_f32 v[200:201], v[200:201], v[204:205]
    v_pk_add_f32 v[208:209], v[208:209], v[212:213]
    v_pk_add_f32 v[216:217], v[216:217], v[220:221]
    v_pk_add_f32 v[200:201], v[200:201], v[208:209]
    v_pk_add_f32 v[200:201], v[200:201], v[216:217]
    v_pk_add_f32 v[194:195], v[194:195], v[198:199]
    v_pk_add_f32 v[202:203], v[202:203], v[206:207]
    v_pk_add_f32 v[210:211], v[210:211], v[214:215]
    v_pk_add_f32 v[218:219], v[218:219], v[222:223]
    v_pk_add_f32 v[202:203], v[202:203], v[210:211]
    v_pk_add_f32 v[202:203], v[202:203], v[218:219]
    v_cvt_pk_bf16_f32 v25, v192, v193
    v_cvt_pk_bf16_f32 v26, v200, v201
    v_lshlrev_b32 v192, 16, v25
    v_and_b32 v193, s16, v25
    v_lshlrev_b32 v200, 16, v26
    v_and_b32 v201, s16, v26
    v_lshlrev_b32 v26, 16, v120
    v_and_b32 v27, s16, v120
    v_pk_add_f32 v[192:193], v[192:193], v[26:27]
    v_cvt_pk_bf16_f32 v25, v192, v193
    v_lshlrev_b32 v192, 16, v25
    v_and_b32 v193, s16, v25
    v_pk_add_f32 v[192:193], v[192:193], v[200:201]
    v_cvt_pk_bf16_f32 v208, v192, v193
    v_cvt_pk_bf16_f32 v25, v194, v195
    v_cvt_pk_bf16_f32 v26, v202, v203
    v_lshlrev_b32 v194, 16, v25
    v_and_b32 v195, s16, v25
    v_lshlrev_b32 v202, 16, v26
    v_and_b32 v203, s16, v26
    v_lshlrev_b32 v26, 16, v121
    v_and_b32 v27, s16, v121
    v_pk_add_f32 v[194:195], v[194:195], v[26:27]
    v_cvt_pk_bf16_f32 v25, v194, v195
    v_lshlrev_b32 v194, 16, v25
    v_and_b32 v195, s16, v25
    v_pk_add_f32 v[194:195], v[194:195], v[202:203]
    v_cvt_pk_bf16_f32 v209, v194, v195
    buffer_store_dwordx2 v[208:209], v114, s[24:27], 0 offen
L_g2_done:
    s_endpgm
L_code_end:
.section .rodata,"a"
.p2align 6
.amdhsa_kernel g1_kernel
  .amdhsa_next_free_vgpr 256
  .amdhsa_next_free_sgpr 102
  .amdhsa_accum_offset 256
  .amdhsa_group_segment_fixed_size 0
  .amdhsa_kernarg_size 80
  .amdhsa_user_sgpr_count 2
  .amdhsa_user_sgpr_kernarg_segment_ptr 1
  .amdhsa_system_sgpr_workgroup_id_x 1
.end_amdhsa_kernel

.p2align 6
.amdhsa_kernel g2_kernel
  .amdhsa_next_free_vgpr 256
  .amdhsa_next_free_sgpr 102
  .amdhsa_accum_offset 256
  .amdhsa_group_segment_fixed_size 0
  .amdhsa_kernarg_size 80
  .amdhsa_user_sgpr_count 2
  .amdhsa_user_sgpr_kernarg_segment_ptr 1
  .amdhsa_system_sgpr_workgroup_id_x 1
.end_amdhsa_kernel
```
